```python
import torch

def _softmax(x, axis=-1):
    return torch.softmax(x, dim=axis)
def _gelu(x):
    return torch.nn.functional.gelu(x, approximate="tanh")
def _silu(x):
    return torch.nn.functional.silu(x)
def _sigmoid(x):
    return torch.sigmoid(x)
def _layernorm(x, axis=-1, eps=1e-5):
    m = x.mean(dim=axis, keepdim=True)
    v = x.var(dim=axis, keepdim=True, unbiased=False)
    return (x - m) / torch.sqrt(v + eps)
def _scatter_add(tgt, idx, src, axis=0):
    return tgt.clone().index_add_(axis, idx, src)
def _segment_sum(src, seg, n):
    out = torch.zeros((n,) + src.shape[1:], dtype=src.dtype)
    return out.index_add_(0, seg, src)
def _pad(x, pw):
    flat = tuple(v for pair in reversed(pw) for v in pair)
    return torch.nn.functional.pad(x, flat)

kernel_name = 'parallel_sum__linear_attn_block__glu_gated_bilinear__prompt'

def setup_inputs():

    _w = (lambda a: (lambda t: t.to(torch.bfloat16) if t.is_floating_point() else t)(torch.as_tensor(a)))
    def _A_setup():
        B, S, D = 1, 2048, 640
        return {
            "x": _w((lambda *s: torch.randn(*s, dtype=torch.bfloat16) * 0.05)(B, S, D)),
            "wqkv": _w((lambda *s: torch.randn(*s, dtype=torch.bfloat16) * 0.05)(D, 3 * D)),
            "wo": _w((lambda *s: torch.randn(*s, dtype=torch.bfloat16) * 0.05)(D, D)),
        }
    _A_in = _A_setup()

    def _B_setup():
        B, S, D, F = 1, 2048, 640, 1536
        return {
            "x": _w((lambda *s: torch.randn(*s, dtype=torch.bfloat16) * 0.05)(B, S, D)),
            "w_gate": _w((lambda *s: torch.randn(*s, dtype=torch.bfloat16) * 0.2)(D, F) * (D ** -0.5)),
            "w_up": _w((lambda *s: torch.randn(*s, dtype=torch.bfloat16) * 0.2)(D, F) * (D ** -0.5)),
            "w_down": _w((lambda *s: torch.randn(*s, dtype=torch.bfloat16) * 0.2)(F, D) * (F ** -0.5)),
        }
    _B_in = _B_setup()

    return {
        "A_x": _A_in["x"],
        "A_wqkv": _A_in["wqkv"],
        "A_wo": _A_in["wo"],
        "B_x": _B_in["x"],
        "B_w_gate": _B_in["w_gate"],
        "B_w_up": _B_in["w_up"],
        "B_w_down": _B_in["w_down"],
    }

def reference(A_x, A_wqkv, A_wo, B_x, B_w_gate, B_w_up, B_w_down):
    def _A_ref(x, wqkv, wo):
        B, S, D = x.shape
        H = 32; Dh = D // H
        qkv = (lambda x, *d: x.permute(*d))((x @ wqkv).reshape(B, S, 3, H, Dh), 2, 0, 3, 1, 4)
        q, k, v = qkv[0], qkv[1], qkv[2]
        phi = lambda t: torch.where(t > 0, t + 1, torch.exp(t)) + 1e-6
        pq, pk = phi(q), phi(k)
        kv = torch.einsum("bhsd,bhse->bhde", pk, v)
        z = torch.einsum("bhsd->bhd", pk)
        num = torch.einsum("bhqd,bhde->bhqe", pq, kv)
        den = torch.einsum("bhqd,bhd->bhq", pq, z)[..., None] + 1e-6
        o = num / den
        return (lambda x, *d: x.permute(*d))(o, 0, 2, 1, 3).reshape(B, S, D) @ wo

    def _B_ref(x, w_gate, w_up, w_down):
        g = torch.einsum("bsd,df->bsf", x, w_gate)
        u = torch.einsum("bsd,df->bsf", x, w_up)
        h = g * u
        return torch.einsum("bsf,fd->bsd", h, w_down)

    x = A_x
    xn = _layernorm(x, axis=-1)
    return x + _A_ref(xn, A_wqkv, A_wo) + _B_ref(xn, B_w_gate, B_w_up, B_w_down)
```

```asm
; @launch grid=(256,1,1) block=(256,1,1) lds=163840
.amdgcn_target "amdgcn-amd-amdhsa--gfx950"
.text
.p2align 8
.type LTAB,@object
LTAB:
.long 32768,32800,32832,32864,32896,32928,32960,32992,33040,33072,33104,33136,33168,33200,33232,33264
.long 33312,33280,33376,33344,33440,33408,33504,33472,33584,33552,33648,33616,33712,33680,33776,33744
.long 33856,33888,33792,33824,33984,34016,33920,33952,34128,34160,34064,34096,34256,34288,34192,34224
.long 34400,34368,34336,34304,34528,34496,34464,34432,34672,34640,34608,34576,34800,34768,34736,34704
.long 34816,34848,34880,34912,34944,34976,35008,35040,35088,35120,35152,35184,35216,35248,35280,35312
.long 35360,35328,35424,35392,35488,35456,35552,35520,35632,35600,35696,35664,35760,35728,35824,35792
.long 35904,35936,35840,35872,36032,36064,35968,36000,36176,36208,36112,36144,36304,36336,36240,36272
.long 36448,36416,36384,36352,36576,36544,36512,36480,36720,36688,36656,36624,36848,36816,36784,36752
.long 32784,32816,32848,32880,32912,32944,32976,33008,33024,33056,33088,33120,33152,33184,33216,33248
.long 33328,33296,33392,33360,33456,33424,33520,33488,33568,33536,33632,33600,33696,33664,33760,33728
.long 33872,33904,33808,33840,34000,34032,33936,33968,34112,34144,34048,34080,34240,34272,34176,34208
.long 34416,34384,34352,34320,34544,34512,34480,34448,34656,34624,34592,34560,34784,34752,34720,34688
.long 34832,34864,34896,34928,34960,34992,35024,35056,35072,35104,35136,35168,35200,35232,35264,35296
.long 35376,35344,35440,35408,35504,35472,35568,35536,35616,35584,35680,35648,35744,35712,35808,35776
.long 35920,35952,35856,35888,36048,36080,35984,36016,36160,36192,36096,36128,36288,36320,36224,36256
.long 36464,36432,36400,36368,36592,36560,36528,36496,36704,36672,36640,36608,36832,36800,36768,36736
.long 0,0,64,0,8,8,72,16,16,16,80,32,24,24,88,48
.long 320,128,192,64,328,136,200,80,336,144,208,96,344,152,216,112
.long 640,320,256,128,648,328,264,144,656,336,272,160,664,344,280,176
.long 960,448,384,192,968,456,392,208,976,464,400,224,984,472,408,240
.long 32,32,96,1024,40,40,104,1040,48,48,112,1056,56,56,120,1072
.long 352,160,224,1088,360,168,232,1104,368,176,240,1120,376,184,248,1136
.long 672,352,288,1152,680,360,296,1168,688,368,304,1184,696,376,312,1200
.long 992,480,416,1216,1000,488,424,1232,1008,496,432,1248,1016,504,440,1264
.long 2560,1024,1088,256,2568,1032,1096,272,2576,1040,1104,288,2584,1048,1112,304
.long 2880,1152,1216,320,2888,1160,1224,336,2896,1168,1232,352,2904,1176,1240,368
.long 3200,1344,1280,384,3208,1352,1288,400,3216,1360,1296,416,3224,1368,1304,432
.long 3520,1472,1408,448,3528,1480,1416,464,3536,1488,1424,480,3544,1496,1432,496
.long 2592,1056,1120,1280,2600,1064,1128,1296,2608,1072,1136,1312,2616,1080,1144,1328
.long 2912,1184,1248,1344,2920,1192,1256,1360,2928,1200,1264,1376,2936,1208,1272,1392
.long 3232,1376,1312,1408,3240,1384,1320,1424,3248,1392,1328,1440,3256,1400,1336,1456
.long 3552,1504,1440,1472,3560,1512,1448,1488,3568,1520,1456,1504,3576,1528,1464,1520
.long 28672,0,0,0,28680,16,0,8192,28688,32,0,16384,28696,48,0,24576
.long 28800,64,0,32768,28808,80,0,40960,28816,96,0,49152,28824,112,0,57344
.long 28928,1280,0,0,28936,1296,0,8192,28944,1312,0,16384,28952,1328,0,24576
.long 29056,1344,0,32768,29064,1360,0,40960,29072,1376,0,49152,29080,1392,0,57344
.long 29184,2560,0,0,29192,2576,0,8192,29200,2592,0,16384,29208,2608,0,24576
.long 29312,2624,0,32768,29320,2640,0,40960,29328,2656,0,49152,29336,2672,0,57344
.long 29440,3840,0,0,29448,3856,0,8192,29456,3872,0,16384,29464,3888,0,24576
.long 29568,3904,0,32768,29576,3920,0,40960,29584,3936,0,49152,29592,3952,0,57344
.long 30720,5120,1,0,30728,5136,1,8192,30736,5152,1,16384,30744,5168,1,24576
.long 30848,5184,1,32768,30856,5200,1,40960,30864,5216,1,49152,30872,5232,1,57344
.long 30976,6400,1,0,30984,6416,1,8192,30992,6432,1,16384,31000,6448,1,24576
.long 31104,6464,1,32768,31112,6480,1,40960,31120,6496,1,49152,31128,6512,1,57344
.long 31232,7680,1,0,31240,7696,1,8192,31248,7712,1,16384,31256,7728,1,24576
.long 31360,7744,1,32768,31368,7760,1,40960,31376,7776,1,49152,31384,7792,1,57344
.long 31488,8960,1,0,31496,8976,1,8192,31504,8992,1,16384,31512,9008,1,24576
.long 31616,9024,1,32768,31624,9040,1,40960,31632,9056,1,49152,31640,9072,1,57344
.long 25600,25920,25600,0,25936,26256,25600,1,26272,26592,25600,2,26608,26928,25600,3
.long 26944,27264,25936,0,27280,27600,25936,1,27616,27936,25936,2,27952,28272,25936,3
.long 28288,28608,26272,0,28624,28944,26272,1,28960,29280,26272,2,29296,29616,26272,3
.long 29632,29952,26608,0,29968,30288,26608,1,30304,30624,26608,2,30640,30960,26608,3
.long 30976,31296,25600,4,31312,31632,25600,5,31648,31968,25600,6,31984,32304,25600,7
.long 32320,32640,25936,4,32656,32976,25936,5,32992,33312,25936,6,33328,33648,25936,7
.long 33664,33984,26272,4,34000,34320,26272,5,34336,34656,26272,6,34672,34992,26272,7
.long 35008,35328,26608,4,35344,35664,26608,5,35680,36000,26608,6,36016,36336,26608,7
.long 25616,25928,28288,0,25952,26264,28288,1,26288,26600,28288,2,26624,26936,28288,3
.long 26960,27272,28624,0,27296,27608,28624,1,27632,27944,28624,2,27968,28280,28624,3
.long 28304,28616,28960,0,28640,28952,28960,1,28976,29288,28960,2,29312,29624,28960,3
.long 29648,29960,29296,0,29984,30296,29296,1,30320,30632,29296,2,30656,30968,29296,3
.long 30992,31304,28288,4,31328,31640,28288,5,31664,31976,28288,6,32000,32312,28288,7
.long 32336,32648,28624,4,32672,32984,28624,5,33008,33320,28624,6,33344,33656,28624,7
.long 33680,33992,28960,4,34016,34328,28960,5,34352,34664,28960,6,34688,35000,28960,7
.long 35024,35336,29296,4,35360,35672,29296,5,35696,36008,29296,6,36032,36344,29296,7
.long 36864,1065369472,1065353216,0,36880,1065369472,1065353216,0,36896,1065369472,1065353216,0,36912,1065369472,1065353216,0
.long 36928,0,1065353216,0,36944,0,1065353216,0,36960,0,1065353216,0,36976,0,1065353216,0
.long 36992,1065369472,1065353216,0,37008,1065369472,1065353216,0,37024,1065369472,1065353216,0,37040,1065369472,1065353216,0
.long 37056,0,1065353216,0,37072,0,1065353216,0,37088,0,1065353216,0,37104,0,1065353216,0
.long 37120,0,0,0,37136,0,0,0,37152,0,0,0,37168,0,0,0
.long 37184,1065369472,0,0,38912,1065369472,0,0,38912,1065369472,0,0,38912,1065369472,0,0
.long 38912,0,0,0,38912,0,0,0,38912,0,0,0,38912,0,0,0
.long 38912,1065369472,0,0,38912,1065369472,0,0,38912,1065369472,0,0,38912,1065369472,0,0
.long 37200,1065369472,0,0,37216,1065369472,0,0,37232,1065369472,0,0,37248,1065369472,0,0
.long 37264,0,0,0,37280,0,0,0,37296,0,0,0,37312,0,0,0
.long 37328,1065369472,0,0,37344,1065369472,0,0,37360,1065369472,0,0,37376,1065369472,0,0
.long 37392,0,0,0,37408,0,0,0,37424,0,0,0,37440,0,0,0
.long 37456,0,0,0,37472,0,0,0,37488,0,0,0,37504,0,0,0
.long 37520,1065369472,0,0,38912,1065369472,0,0,38912,1065369472,0,0,38912,1065369472,0,0
.long 38912,0,0,0,38912,0,0,0,38912,0,0,0,38912,0,0,0
.long 38912,1065369472,0,0,38912,1065369472,0,0,38912,1065369472,0,0,38912,1065369472,0,0
.long 0,7744,15488,0,16,7760,15504,16,32,7776,16640,32,48,7792,16656,48
.long 64,7808,16672,64,80,7824,16688,80,96,8960,16704,96,112,8976,16720,112
.long 128,8992,16736,128,144,9008,16752,144,1280,9024,16768,160,1296,9040,16784,176
.long 1312,9056,17920,192,1328,9072,17936,208,1344,9088,17952,224,1360,9104,17968,240
.long 1376,10240,17984,256,1392,10256,18000,272,1408,10272,18016,288,1424,10288,18032,304
.long 2560,10304,18048,320,2576,10320,18064,336,2592,10336,19200,352,2608,10352,19216,368
.long 2624,10368,19232,384,2640,10384,19248,400,2656,11520,19264,416,2672,11536,19280,432
.long 2688,11552,19296,448,2704,11568,19312,464,3840,11584,19328,480,3856,11600,19344,496
.long 3872,11616,2146435072,512,3888,11632,2146435072,528,3904,11648,2146435072,544,3920,11664,2146435072,560
.long 3936,12800,2146435072,576,3952,12816,2146435072,592,3968,12832,2146435072,608,3984,12848,2146435072,624
.long 5120,12864,2146435072,640,5136,12880,2146435072,656,5152,12896,2146435072,672,5168,12912,2146435072,688
.long 5184,12928,2146435072,704,5200,12944,2146435072,720,5216,14080,2146435072,736,5232,14096,2146435072,752
.long 5248,14112,2146435072,768,5264,14128,2146435072,784,6400,14144,2146435072,800,6416,14160,2146435072,816
.long 6432,14176,2146435072,832,6448,14192,2146435072,848,6464,14208,2146435072,864,6480,14224,2146435072,880
.long 6496,15360,2146435072,896,6512,15376,2146435072,912,6528,15392,2146435072,928,6544,15408,2146435072,944
.long 7680,15424,2146435072,960,7696,15440,2146435072,976,7712,15456,2146435072,992,7728,15472,2146435072,1008
.long 1024,2048,0,0,1040,2064,160,16,1056,2080,320,32,1072,2096,480,48
.long 1088,2112,640,64,1104,2128,800,80,1120,2144,960,96,1136,2160,1120,112
.long 1152,2176,1280,128,1168,2192,1440,144,1184,2208,1600,160,1200,2224,1760,176
.long 1216,2240,1920,192,1232,2256,2080,208,1248,2272,2240,224,1264,2288,2400,240
.long 1280,2304,2576,256,1296,2320,2736,272,1312,2336,2896,288,1328,2352,3056,304
.long 1344,2368,3216,256,1360,2384,3376,272,1376,2400,3536,288,1392,2416,3696,304
.long 1408,2432,3856,320,1424,2448,4016,320,1440,2464,4176,320,1456,2480,4336,320
.long 1472,2496,4496,320,1488,2512,4656,320,1504,2528,4816,320,1520,2544,4976,320
.long 1536,2544,16,0,1552,2544,176,16,1568,2544,336,32,1584,2544,496,48
.long 1600,2544,656,64,1616,2544,816,80,1632,2544,976,96,1648,2544,1136,112
.long 1664,2544,1296,128,1680,2544,1456,144,1696,2544,1616,160,1712,2544,1776,176
.long 1728,2544,1936,192,1744,2544,2096,208,1760,2544,2256,224,1776,2544,2416,240
.long 1792,2544,2592,256,1808,2544,2752,272,1824,2544,2912,288,1840,2544,3072,304
.long 1856,2544,3232,256,1872,2544,3392,272,1888,2544,3552,288,1904,2544,3712,304
.long 1920,2544,3872,320,1936,2544,4032,320,1952,2544,4192,320,1968,2544,4352,320
.long 1984,2544,4512,320,2000,2544,4672,320,2016,2544,4832,320,2032,2544,4992,320
.long 0,0,0,0,0,0,0,0,0,0,0,0,0,0,0,0
.long 0,0,0,0,0,0,0,0,0,0,0,0,0,0,0,0
.long 0,0,0,0,0,0,0,0,0,0,0,0,0,0,0,0
.long 0,0,0,0,0,0,0,0,0,0,0,0,0,0,0,0
.long 0,0,0,0,0,0,0,0,0,0,0,0,0,0,0,0
.long 0,0,0,0,0,0,0,0,0,0,0,0,0,0,0,0
.long 0,0,0,0,0,0,0,0,0,0,0,0,0,0,0,0
.long 0,0,0,0,0,0,0,0,0,0,0,0,0,0,0,0
.long 1,0,0,0,1,0,0,0,1,0,0,0,1,0,0,0
.long 1,0,0,0,1,0,0,0,1,0,0,0,1,0,0,0
.long 1,0,0,0,1,0,0,0,1,0,0,0,1,0,0,0
.long 1,0,0,0,1,0,0,0,1,0,0,0,1,0,0,0
.long 1,0,0,0,1,0,0,0,1,0,0,0,1,0,0,0
.long 1,0,0,0,1,0,0,0,1,0,0,0,1,0,0,0
.long 1,0,0,0,1,0,0,0,1,0,0,0,1,0,0,0
.long 1,0,0,0,1,0,0,0,1,0,0,0,1,0,0,0
.long 32768,32800,32832,32864,32896,32928,32960,32992,33040,33072,33104,33136,33168,33200,33232,33264
.long 33312,33280,33376,33344,33440,33408,33504,33472,33584,33552,33648,33616,33712,33680,33776,33744
.long 33856,33888,33792,33824,33984,34016,33920,33952,34128,34160,34064,34096,34256,34288,34192,34224
.long 34400,34368,34336,34304,34528,34496,34464,34432,34672,34640,34608,34576,34800,34768,34736,34704
.long 34816,34848,34880,34912,34944,34976,35008,35040,35088,35120,35152,35184,35216,35248,35280,35312
.long 35360,35328,35424,35392,35488,35456,35552,35520,35632,35600,35696,35664,35760,35728,35824,35792
.long 35904,35936,35840,35872,36032,36064,35968,36000,36176,36208,36112,36144,36304,36336,36240,36272
.long 36448,36416,36384,36352,36576,36544,36512,36480,36720,36688,36656,36624,36848,36816,36784,36752
.long 32784,32816,32848,32880,32912,32944,32976,33008,33024,33056,33088,33120,33152,33184,33216,33248
.long 33328,33296,33392,33360,33456,33424,33520,33488,33568,33536,33632,33600,33696,33664,33760,33728
.long 33872,33904,33808,33840,34000,34032,33936,33968,34112,34144,34048,34080,34240,34272,34176,34208
.long 34416,34384,34352,34320,34544,34512,34480,34448,34656,34624,34592,34560,34784,34752,34720,34688
.long 34832,34864,34896,34928,34960,34992,35024,35056,35072,35104,35136,35168,35200,35232,35264,35296
.long 35376,35344,35440,35408,35504,35472,35568,35536,35616,35584,35680,35648,35744,35712,35808,35776
.long 35920,35952,35856,35888,36048,36080,35984,36016,36160,36192,36096,36128,36288,36320,36224,36256
.long 36464,36432,36400,36368,36592,36560,36528,36496,36704,36672,36640,36608,36832,36800,36768,36736
.long 0,0,64,0,8,8,72,16,16,16,80,32,24,24,88,48
.long 192,128,192,64,200,136,200,80,208,144,208,96,216,152,216,112
.long 384,320,256,128,392,328,264,144,400,336,272,160,408,344,280,176
.long 576,448,384,192,584,456,392,208,592,464,400,224,600,472,408,240
.long 32,32,96,1024,40,40,104,1040,48,48,112,1056,56,56,120,1072
.long 224,160,224,1088,232,168,232,1104,240,176,240,1120,248,184,248,1136
.long 416,352,288,1152,424,360,296,1168,432,368,304,1184,440,376,312,1200
.long 608,480,416,1216,616,488,424,1232,624,496,432,1248,632,504,440,1264
.long 1536,1024,1088,256,1544,1032,1096,272,1552,1040,1104,288,1560,1048,1112,304
.long 1728,1152,1216,320,1736,1160,1224,336,1744,1168,1232,352,1752,1176,1240,368
.long 1920,1344,1280,384,1928,1352,1288,400,1936,1360,1296,416,1944,1368,1304,432
.long 2112,1472,1408,448,2120,1480,1416,464,2128,1488,1424,480,2136,1496,1432,496
.long 1568,1056,1120,1280,1576,1064,1128,1296,1584,1072,1136,1312,1592,1080,1144,1328
.long 1760,1184,1248,1344,1768,1192,1256,1360,1776,1200,1264,1376,1784,1208,1272,1392
.long 1952,1376,1312,1408,1960,1384,1320,1424,1968,1392,1328,1440,1976,1400,1336,1456
.long 2144,1504,1440,1472,2152,1512,1448,1488,2160,1520,1456,1504,2168,1528,1464,1520
.long 24576,0,0,0,24584,16,0,8192,24592,32,0,16384,24600,48,0,24576
.long 24704,64,0,32768,24712,80,0,40960,24720,96,0,49152,24728,112,0,57344
.long 24832,1280,0,0,24840,1296,0,8192,24848,1312,0,16384,24856,1328,0,24576
.long 24960,1344,0,32768,24968,1360,0,40960,24976,1376,0,49152,24984,1392,0,57344
.long 25088,2560,0,0,25096,2576,0,8192,25104,2592,0,16384,25112,2608,0,24576
.long 25216,2624,0,32768,25224,2640,0,40960,25232,2656,0,49152,25240,2672,0,57344
.long 25344,3840,0,0,25352,3856,0,8192,25360,3872,0,16384,25368,3888,0,24576
.long 25472,3904,0,32768,25480,3920,0,40960,25488,3936,0,49152,25496,3952,0,57344
.long 26624,5120,1,0,26632,5136,1,8192,26640,5152,1,16384,26648,5168,1,24576
.long 26752,5184,1,32768,26760,5200,1,40960,26768,5216,1,49152,26776,5232,1,57344
.long 26880,6400,1,0,26888,6416,1,8192,26896,6432,1,16384,26904,6448,1,24576
.long 27008,6464,1,32768,27016,6480,1,40960,27024,6496,1,49152,27032,6512,1,57344
.long 27136,7680,1,0,27144,7696,1,8192,27152,7712,1,16384,27160,7728,1,24576
.long 27264,7744,1,32768,27272,7760,1,40960,27280,7776,1,49152,27288,7792,1,57344
.long 27392,8960,1,0,27400,8976,1,8192,27408,8992,1,16384,27416,9008,1,24576
.long 27520,9024,1,32768,27528,9040,1,40960,27536,9056,1,49152,27544,9072,1,57344
.long 25600,25920,25600,0,25936,26256,25600,1,26272,26592,25600,2,26608,26928,25600,3
.long 26944,27264,25936,0,27280,27600,25936,1,27616,27936,25936,2,27952,28272,25936,3
.long 28288,28608,26272,0,28624,28944,26272,1,28960,29280,26272,2,29296,29616,26272,3
.long 29632,29952,26608,0,29968,30288,26608,1,30304,30624,26608,2,30640,30960,26608,3
.long 30976,31296,25600,4,31312,31632,25600,5,31648,31968,25600,6,31984,32304,25600,7
.long 32320,32640,25936,4,32656,32976,25936,5,32992,33312,25936,6,33328,33648,25936,7
.long 33664,33984,26272,4,34000,34320,26272,5,34336,34656,26272,6,34672,34992,26272,7
.long 35008,35328,26608,4,35344,35664,26608,5,35680,36000,26608,6,36016,36336,26608,7
.long 25616,25928,28288,0,25952,26264,28288,1,26288,26600,28288,2,26624,26936,28288,3
.long 26960,27272,28624,0,27296,27608,28624,1,27632,27944,28624,2,27968,28280,28624,3
.long 28304,28616,28960,0,28640,28952,28960,1,28976,29288,28960,2,29312,29624,28960,3
.long 29648,29960,29296,0,29984,30296,29296,1,30320,30632,29296,2,30656,30968,29296,3
.long 30992,31304,28288,4,31328,31640,28288,5,31664,31976,28288,6,32000,32312,28288,7
.long 32336,32648,28624,4,32672,32984,28624,5,33008,33320,28624,6,33344,33656,28624,7
.long 33680,33992,28960,4,34016,34328,28960,5,34352,34664,28960,6,34688,35000,28960,7
.long 35024,35336,29296,4,35360,35672,29296,5,35696,36008,29296,6,36032,36344,29296,7
.long 36864,1065369472,1065353216,0,36880,1065369472,1065353216,0,36896,1065369472,1065353216,0,36912,1065369472,1065353216,0
.long 36928,0,1065353216,0,36944,0,1065353216,0,36960,0,1065353216,0,36976,0,1065353216,0
.long 36992,1065369472,1065353216,0,37008,1065369472,1065353216,0,37024,1065369472,1065353216,0,37040,1065369472,1065353216,0
.long 37056,0,1065353216,0,37072,0,1065353216,0,37088,0,1065353216,0,37104,0,1065353216,0
.long 37120,0,0,0,37136,0,0,0,37152,0,0,0,37168,0,0,0
.long 37184,1065369472,0,0,38912,1065369472,0,0,38912,1065369472,0,0,38912,1065369472,0,0
.long 38912,0,0,0,38912,0,0,0,38912,0,0,0,38912,0,0,0
.long 38912,1065369472,0,0,38912,1065369472,0,0,38912,1065369472,0,0,38912,1065369472,0,0
.long 37200,1065369472,0,0,37216,1065369472,0,0,37232,1065369472,0,0,37248,1065369472,0,0
.long 37264,0,0,0,37280,0,0,0,37296,0,0,0,37312,0,0,0
.long 37328,1065369472,0,0,37344,1065369472,0,0,37360,1065369472,0,0,37376,1065369472,0,0
.long 37392,0,0,0,37408,0,0,0,37424,0,0,0,37440,0,0,0
.long 37456,0,0,0,37472,0,0,0,37488,0,0,0,37504,0,0,0
.long 37520,1065369472,0,0,38912,1065369472,0,0,38912,1065369472,0,0,38912,1065369472,0,0
.long 38912,0,0,0,38912,0,0,0,38912,0,0,0,38912,0,0,0
.long 38912,1065369472,0,0,38912,1065369472,0,0,38912,1065369472,0,0,38912,1065369472,0,0
.long 0,7744,15488,0,16,7760,15504,16,32,7776,16640,32,48,7792,16656,48
.long 64,7808,16672,64,80,7824,16688,80,96,8960,16704,96,112,8976,16720,112
.long 128,8992,16736,128,144,9008,16752,144,1280,9024,16768,160,1296,9040,16784,176
.long 1312,9056,17920,192,1328,9072,17936,208,1344,9088,17952,224,1360,9104,17968,240
.long 1376,10240,17984,256,1392,10256,18000,272,1408,10272,18016,288,1424,10288,18032,304
.long 2560,10304,18048,320,2576,10320,18064,336,2592,10336,19200,352,2608,10352,19216,368
.long 2624,10368,19232,384,2640,10384,19248,400,2656,11520,19264,416,2672,11536,19280,432
.long 2688,11552,19296,448,2704,11568,19312,464,3840,11584,19328,480,3856,11600,19344,496
.long 3872,11616,2146435072,512,3888,11632,2146435072,528,3904,11648,2146435072,544,3920,11664,2146435072,560
.long 3936,12800,2146435072,576,3952,12816,2146435072,592,3968,12832,2146435072,608,3984,12848,2146435072,624
.long 5120,12864,2146435072,640,5136,12880,2146435072,656,5152,12896,2146435072,672,5168,12912,2146435072,688
.long 5184,12928,2146435072,704,5200,12944,2146435072,720,5216,14080,2146435072,736,5232,14096,2146435072,752
.long 5248,14112,2146435072,768,5264,14128,2146435072,784,6400,14144,2146435072,800,6416,14160,2146435072,816
.long 6432,14176,2146435072,832,6448,14192,2146435072,848,6464,14208,2146435072,864,6480,14224,2146435072,880
.long 6496,15360,2146435072,896,6512,15376,2146435072,912,6528,15392,2146435072,928,6544,15408,2146435072,944
.long 7680,15424,2146435072,960,7696,15440,2146435072,976,7712,15456,2146435072,992,7728,15472,2146435072,1008
.long 1024,2048,0,0,1040,2064,160,16,1056,2080,320,32,1072,2096,480,48
.long 1088,2112,640,64,1104,2128,800,80,1120,2144,960,96,1136,2160,1120,112
.long 1152,2176,1280,128,1168,2192,1440,144,1184,2208,1600,160,1200,2224,1760,176
.long 1216,2240,1920,192,1232,2256,2080,208,1248,2272,2240,224,1264,2288,2400,240
.long 1280,2304,2576,256,1296,2320,2736,272,1312,2336,2896,288,1328,2352,3056,304
.long 1344,2368,3216,256,1360,2384,3376,272,1376,2400,3536,288,1392,2416,3696,304
.long 1408,2432,3856,320,1424,2448,4016,320,1440,2464,4176,320,1456,2480,4336,320
.long 1472,2496,4496,320,1488,2512,4656,320,1504,2528,4816,320,1520,2544,4976,320
.long 1536,2544,16,0,1552,2544,176,16,1568,2544,336,32,1584,2544,496,48
.long 1600,2544,656,64,1616,2544,816,80,1632,2544,976,96,1648,2544,1136,112
.long 1664,2544,1296,128,1680,2544,1456,144,1696,2544,1616,160,1712,2544,1776,176
.long 1728,2544,1936,192,1744,2544,2096,208,1760,2544,2256,224,1776,2544,2416,240
.long 1792,2544,2592,256,1808,2544,2752,272,1824,2544,2912,288,1840,2544,3072,304
.long 1856,2544,3232,256,1872,2544,3392,272,1888,2544,3552,288,1904,2544,3712,304
.long 1920,2544,3872,320,1936,2544,4032,320,1952,2544,4192,320,1968,2544,4352,320
.long 1984,2544,4512,320,2000,2544,4672,320,2016,2544,4832,320,2032,2544,4992,320
.long 0,0,0,0,0,0,0,0,0,0,0,0,0,0,0,0
.long 0,0,0,0,0,0,0,0,0,0,0,0,0,0,0,0
.long 0,0,0,0,0,0,0,0,0,0,0,0,0,0,0,0
.long 0,0,0,0,0,0,0,0,0,0,0,0,0,0,0,0
.long 0,0,0,0,0,0,0,0,0,0,0,0,0,0,0,0
.long 0,0,0,0,0,0,0,0,0,0,0,0,0,0,0,0
.long 0,0,0,0,0,0,0,0,0,0,0,0,0,0,0,0
.long 0,0,0,0,0,0,0,0,0,0,0,0,0,0,0,0
.long 1,0,0,0,1,0,0,0,1,0,0,0,1,0,0,0
.long 1,0,0,0,1,0,0,0,1,0,0,0,1,0,0,0
.long 1,0,0,0,1,0,0,0,1,0,0,0,1,0,0,0
.long 1,0,0,0,1,0,0,0,1,0,0,0,1,0,0,0
.long 1,0,0,0,1,0,0,0,1,0,0,0,1,0,0,0
.long 1,0,0,0,1,0,0,0,1,0,0,0,1,0,0,0
.long 1,0,0,0,1,0,0,0,1,0,0,0,1,0,0,0
.long 1,0,0,0,1,0,0,0,1,0,0,0,1,0,0,0
.size LTAB, .-LTAB
.type STAB,@object
STAB:
.long 0,20480,40960,61440,81920,102400,122880,143360,163840,184320,204800,225280,245760,266240,286720,307200
.long 0,245760,491520,737280,983040,1228800,1474560,1720320,1966080,2211840,0,196608,393216,589824,786432,983040
.long 1179648,1376256,1572864,1769472,327680,13991936,13991936,0,0,13926400,13926400,13991936,11141120,0,0,14057472
.long 0,20480,40960,61440,81920,102400,122880,143360,163840,184320,204800,225280,245760,266240,286720,307200
.long 245760,0,737280,491520,1228800,983040,1720320,1474560,1966080,2211840,196608,0,589824,393216,983040,786432
.long 1376256,1179648,1572864,1769472,327680,13991936,13992960,4,0,13927424,13926400,13992960,12533760,0,640,14071808
.long 0,20480,40960,61440,81920,102400,122880,143360,163840,184320,204800,225280,245760,266240,286720,307200
.long 1966080,2211840,0,245760,491520,737280,983040,1228800,1474560,1720320,1572864,1769472,0,196608,393216,589824
.long 786432,983040,1179648,1376256,327680,13991936,13993984,8,0,13942784,13926400,13993984,11141120,2785280,655360,14086144
.long 0,20480,40960,61440,81920,102400,122880,143360,163840,184320,204800,225280,245760,266240,286720,307200
.long 1966080,2211840,245760,0,737280,491520,1228800,983040,1720320,1474560,1572864,1769472,196608,0,589824,393216
.long 983040,786432,1376256,1179648,327680,2146435072,13995008,12,0,13943808,13926400,13995008,12533760,2785280,656000,14100480
.long 0,20480,40960,61440,81920,102400,122880,143360,163840,184320,204800,225280,245760,266240,286720,307200
.long 1966080,2211840,0,245760,491520,737280,983040,1228800,1474560,1720320,1572864,1769472,0,196608,393216,589824
.long 786432,983040,1179648,1376256,327680,14024704,13991936,0,5570560,13959168,13959168,14024704,11141120,5570560,1310720,14057472
.long 0,20480,40960,61440,81920,102400,122880,143360,163840,184320,204800,225280,245760,266240,286720,307200
.long 1966080,2211840,245760,0,737280,491520,1228800,983040,1720320,1474560,1572864,1769472,196608,0,589824,393216
.long 983040,786432,1376256,1179648,327680,2146435072,13992960,4,5570560,13960192,13959168,14025728,12533760,5570560,1311360,14071808
.long 0,20480,40960,61440,81920,102400,122880,143360,163840,184320,204800,225280,245760,266240,286720,307200
.long 0,245760,491520,737280,983040,1228800,1474560,1720320,1966080,2211840,0,196608,393216,589824,786432,983040
.long 1179648,1376256,1572864,1769472,327680,14024704,13993984,8,5570560,13975552,13959168,14026752,11141120,8355840,1966080,14086144
.long 0,20480,40960,61440,81920,102400,122880,143360,163840,184320,204800,225280,245760,266240,286720,307200
.long 245760,0,737280,491520,1228800,983040,1720320,1474560,1966080,2211840,196608,0,589824,393216,983040,786432
.long 1376256,1179648,1572864,1769472,327680,14024704,13995008,12,5570560,13976576,13959168,14027776,12533760,8355840,1966720,14100480
.long 40960,61440,81920,102400,122880,143360,0,20480,184320,204800,225280,163840,266240,286720,307200,327680
.long 245760,0,737280,491520,1228800,983040,1720320,1474560,2211840,1966080,196608,0,589824,393216,983040,786432
.long 1376256,1179648,1769472,1572864,245760,13996032,13991936,0,696320,13926656,13930496,13996032,11489280,0,160,14057472
.long 40960,61440,81920,102400,122880,143360,0,20480,184320,204800,225280,163840,266240,286720,307200,327680
.long 0,245760,491520,737280,983040,1228800,1474560,1720320,2211840,1966080,0,196608,393216,589824,786432,983040
.long 1179648,1376256,1769472,1572864,245760,13996032,13992960,4,696320,13927680,13930496,13997056,12881920,0,800,14071808
.long 40960,61440,81920,102400,122880,143360,0,20480,184320,204800,225280,163840,266240,286720,307200,327680
.long 2211840,1966080,245760,0,737280,491520,1228800,983040,1720320,1474560,1769472,1572864,196608,0,589824,393216
.long 983040,786432,1376256,1179648,245760,13996032,13993984,8,696320,13943040,13930496,13998080,11489280,2785280,655520,14086144
.long 40960,61440,81920,102400,122880,143360,0,20480,184320,204800,225280,163840,266240,286720,307200,327680
.long 2211840,1966080,0,245760,491520,737280,983040,1228800,1474560,1720320,1769472,1572864,0,196608,393216,589824
.long 786432,983040,1179648,1376256,245760,2146435072,13995008,12,696320,13944064,13930496,13999104,12881920,2785280,656160,14100480
.long 40960,61440,81920,102400,122880,143360,0,20480,184320,204800,225280,163840,266240,286720,307200,327680
.long 2211840,1966080,245760,0,737280,491520,1228800,983040,1720320,1474560,1769472,1572864,196608,0,589824,393216
.long 983040,786432,1376256,1179648,245760,14028800,13991936,0,6266880,13959424,13963264,14028800,11489280,5570560,1310880,14057472
.long 40960,61440,81920,102400,122880,143360,0,20480,184320,204800,225280,163840,266240,286720,307200,327680
.long 2211840,1966080,0,245760,491520,737280,983040,1228800,1474560,1720320,1769472,1572864,0,196608,393216,589824
.long 786432,983040,1179648,1376256,245760,2146435072,13992960,4,6266880,13960448,13963264,14029824,12881920,5570560,1311520,14071808
.long 40960,61440,81920,102400,122880,143360,0,20480,184320,204800,225280,163840,266240,286720,307200,327680
.long 245760,0,737280,491520,1228800,983040,1720320,1474560,2211840,1966080,196608,0,589824,393216,983040,786432
.long 1376256,1179648,1769472,1572864,245760,14028800,13993984,8,6266880,13975808,13963264,14030848,11489280,8355840,1966240,14086144
.long 40960,61440,81920,102400,122880,143360,0,20480,184320,204800,225280,163840,266240,286720,307200,327680
.long 0,245760,491520,737280,983040,1228800,1474560,1720320,2211840,1966080,0,196608,393216,589824,786432,983040
.long 1179648,1376256,1769472,1572864,245760,14028800,13995008,12,6266880,13976832,13963264,14031872,12881920,8355840,1966880,14100480
.long 81920,102400,122880,143360,0,20480,40960,61440,204800,225280,163840,184320,286720,307200,327680,245760
.long 491520,737280,0,245760,1474560,1720320,983040,1228800,1966080,2211840,393216,589824,0,196608,1179648,1376256
.long 786432,983040,1572864,1769472,266240,14000128,13991936,0,1392640,13926912,13934592,14000128,11837440,0,320,14057472
.long 81920,102400,122880,143360,0,20480,40960,61440,204800,225280,163840,184320,286720,307200,327680,245760
.long 737280,491520,245760,0,1720320,1474560,1228800,983040,1966080,2211840,589824,393216,196608,0,1376256,1179648
.long 983040,786432,1572864,1769472,266240,14000128,13992960,4,1392640,13927936,13934592,14001152,13230080,0,960,14071808
.long 81920,102400,122880,143360,0,20480,40960,61440,204800,225280,163840,184320,286720,307200,327680,245760
.long 1966080,2211840,491520,737280,0,245760,1474560,1720320,983040,1228800,1572864,1769472,393216,589824,0,196608
.long 1179648,1376256,786432,983040,266240,14000128,2146435072,8,1392640,13943296,13934592,14002176,11837440,2785280,655680,14086144
.long 81920,102400,122880,143360,0,20480,40960,61440,204800,225280,163840,184320,286720,307200,327680,245760
.long 1966080,2211840,737280,491520,245760,0,1720320,1474560,1228800,983040,1572864,1769472,589824,393216,196608,0
.long 1376256,1179648,983040,786432,266240,2146435072,2146435072,12,1392640,13944320,13934592,14003200,13230080,2785280,656320,14100480
.long 81920,102400,122880,143360,0,20480,40960,61440,204800,225280,163840,184320,286720,307200,327680,245760
.long 1966080,2211840,491520,737280,0,245760,1474560,1720320,983040,1228800,1572864,1769472,393216,589824,0,196608
.long 1179648,1376256,786432,983040,266240,14032896,2146435072,0,6963200,13959680,13967360,14032896,11837440,5570560,1311040,14057472
.long 81920,102400,122880,143360,0,20480,40960,61440,204800,225280,163840,184320,286720,307200,327680,245760
.long 1966080,2211840,737280,491520,245760,0,1720320,1474560,1228800,983040,1572864,1769472,589824,393216,196608,0
.long 1376256,1179648,983040,786432,266240,2146435072,2146435072,4,6963200,13960704,13967360,14033920,13230080,5570560,1311680,14071808
.long 81920,102400,122880,143360,0,20480,40960,61440,204800,225280,163840,184320,286720,307200,327680,245760
.long 491520,737280,0,245760,1474560,1720320,983040,1228800,1966080,2211840,393216,589824,0,196608,1179648,1376256
.long 786432,983040,1572864,1769472,266240,14032896,13993984,8,6963200,13976064,13967360,14034944,11837440,8355840,1966400,14086144
.long 81920,102400,122880,143360,0,20480,40960,61440,204800,225280,163840,184320,286720,307200,327680,245760
.long 737280,491520,245760,0,1720320,1474560,1228800,983040,1966080,2211840,589824,393216,196608,0,1376256,1179648
.long 983040,786432,1572864,1769472,266240,14032896,13995008,12,6963200,13977088,13967360,14035968,13230080,8355840,1967040,14100480
.long 122880,143360,0,20480,40960,61440,81920,102400,225280,163840,184320,204800,307200,327680,245760,266240
.long 737280,491520,245760,0,1720320,1474560,1228800,983040,2211840,1966080,589824,393216,196608,0,1376256,1179648
.long 983040,786432,1769472,1572864,286720,14004224,13991936,0,2088960,13927168,13938688,14004224,12185600,0,480,14057472
.long 122880,143360,0,20480,40960,61440,81920,102400,225280,163840,184320,204800,307200,327680,245760,266240
.long 491520,737280,0,245760,1474560,1720320,983040,1228800,2211840,1966080,393216,589824,0,196608,1179648,1376256
.long 786432,983040,1769472,1572864,286720,14004224,13992960,4,2088960,13928192,13938688,14005248,13578240,0,1120,14071808
.long 122880,143360,0,20480,40960,61440,81920,102400,225280,163840,184320,204800,307200,327680,245760,266240
.long 2211840,1966080,737280,491520,245760,0,1720320,1474560,1228800,983040,1769472,1572864,589824,393216,196608,0
.long 1376256,1179648,983040,786432,286720,14004224,2146435072,8,2088960,13943552,13938688,14006272,12185600,2785280,655840,14086144
.long 122880,143360,0,20480,40960,61440,81920,102400,225280,163840,184320,204800,307200,327680,245760,266240
.long 2211840,1966080,491520,737280,0,245760,1474560,1720320,983040,1228800,1769472,1572864,393216,589824,0,196608
.long 1179648,1376256,786432,983040,286720,2146435072,2146435072,12,2088960,13944576,13938688,14007296,13578240,2785280,656480,14100480
.long 122880,143360,0,20480,40960,61440,81920,102400,225280,163840,184320,204800,307200,327680,245760,266240
.long 2211840,1966080,737280,491520,245760,0,1720320,1474560,1228800,983040,1769472,1572864,589824,393216,196608,0
.long 1376256,1179648,983040,786432,286720,14036992,2146435072,0,7659520,13959936,13971456,14036992,12185600,5570560,1311200,14057472
.long 122880,143360,0,20480,40960,61440,81920,102400,225280,163840,184320,204800,307200,327680,245760,266240
.long 2211840,1966080,491520,737280,0,245760,1474560,1720320,983040,1228800,1769472,1572864,393216,589824,0,196608
.long 1179648,1376256,786432,983040,286720,2146435072,2146435072,4,7659520,13960960,13971456,14038016,13578240,5570560,1311840,14071808
.long 122880,143360,0,20480,40960,61440,81920,102400,225280,163840,184320,204800,307200,327680,245760,266240
.long 737280,491520,245760,0,1720320,1474560,1228800,983040,2211840,1966080,589824,393216,196608,0,1376256,1179648
.long 983040,786432,1769472,1572864,286720,14036992,13993984,8,7659520,13976320,13971456,14039040,12185600,8355840,1966560,14086144
.long 122880,143360,0,20480,40960,61440,81920,102400,225280,163840,184320,204800,307200,327680,245760,266240
.long 491520,737280,0,245760,1474560,1720320,983040,1228800,2211840,1966080,393216,589824,0,196608,1179648,1376256
.long 786432,983040,1769472,1572864,286720,14036992,13995008,12,7659520,13977344,13971456,14040064,13578240,8355840,1967200,14100480
.long 40960,61440,81920,102400,122880,143360,0,20480,184320,204800,225280,163840,266240,286720,307200,327680
.long 983040,1228800,1474560,1720320,0,245760,491520,737280,1966080,2211840,786432,983040,1179648,1376256,0,196608
.long 393216,589824,1572864,1769472,245760,14008320,13991936,0,2785280,13928448,13942784,14008320,11141120,348160,81920,14057472
.long 40960,61440,81920,102400,122880,143360,0,20480,184320,204800,225280,163840,266240,286720,307200,327680
.long 1228800,983040,1720320,1474560,245760,0,737280,491520,1966080,2211840,983040,786432,1376256,1179648,196608,0
.long 589824,393216,1572864,1769472,245760,14008320,13992960,4,2785280,13929472,13942784,14009344,12533760,348160,82560,14071808
.long 40960,61440,81920,102400,122880,143360,0,20480,184320,204800,225280,163840,266240,286720,307200,327680
.long 1966080,2211840,983040,1228800,1474560,1720320,0,245760,491520,737280,1572864,1769472,786432,983040,1179648,1376256
.long 0,196608,393216,589824,245760,14008320,2146435072,8,2785280,13944832,13942784,14010368,11141120,3133440,737280,14086144
.long 40960,61440,81920,102400,122880,143360,0,20480,184320,204800,225280,163840,266240,286720,307200,327680
.long 1966080,2211840,1228800,983040,1720320,1474560,245760,0,737280,491520,1572864,1769472,983040,786432,1376256,1179648
.long 196608,0,589824,393216,245760,2146435072,2146435072,12,2785280,13945856,13942784,14011392,12533760,3133440,737920,14100480
.long 40960,61440,81920,102400,122880,143360,0,20480,184320,204800,225280,163840,266240,286720,307200,327680
.long 1966080,2211840,983040,1228800,1474560,1720320,0,245760,491520,737280,1572864,1769472,786432,983040,1179648,1376256
.long 0,196608,393216,589824,245760,14041088,2146435072,0,8355840,13961216,13975552,14041088,11141120,5918720,1392640,14057472
.long 40960,61440,81920,102400,122880,143360,0,20480,184320,204800,225280,163840,266240,286720,307200,327680
.long 1966080,2211840,1228800,983040,1720320,1474560,245760,0,737280,491520,1572864,1769472,983040,786432,1376256,1179648
.long 196608,0,589824,393216,245760,2146435072,2146435072,4,8355840,13962240,13975552,14042112,12533760,5918720,1393280,14071808
.long 40960,61440,81920,102400,122880,143360,0,20480,184320,204800,225280,163840,266240,286720,307200,327680
.long 983040,1228800,1474560,1720320,0,245760,491520,737280,1966080,2211840,786432,983040,1179648,1376256,0,196608
.long 393216,589824,1572864,1769472,245760,14041088,13993984,8,8355840,13977600,13975552,14043136,11141120,8704000,2048000,14086144
.long 40960,61440,81920,102400,122880,143360,0,20480,184320,204800,225280,163840,266240,286720,307200,327680
.long 1228800,983040,1720320,1474560,245760,0,737280,491520,1966080,2211840,983040,786432,1376256,1179648,196608,0
.long 589824,393216,1572864,1769472,245760,14041088,13995008,12,8355840,13978624,13975552,14044160,12533760,8704000,2048640,14100480
.long 81920,102400,122880,143360,0,20480,40960,61440,204800,225280,163840,184320,286720,307200,327680,245760
.long 1228800,983040,1720320,1474560,245760,0,737280,491520,2211840,1966080,983040,786432,1376256,1179648,196608,0
.long 589824,393216,1769472,1572864,266240,14012416,13991936,0,3481600,13928704,13946880,14012416,11489280,348160,82080,14057472
.long 81920,102400,122880,143360,0,20480,40960,61440,204800,225280,163840,184320,286720,307200,327680,245760
.long 983040,1228800,1474560,1720320,0,245760,491520,737280,2211840,1966080,786432,983040,1179648,1376256,0,196608
.long 393216,589824,1769472,1572864,266240,14012416,13992960,4,3481600,13929728,13946880,14013440,12881920,348160,82720,14071808
.long 81920,102400,122880,143360,0,20480,40960,61440,204800,225280,163840,184320,286720,307200,327680,245760
.long 2211840,1966080,1228800,983040,1720320,1474560,245760,0,737280,491520,1769472,1572864,983040,786432,1376256,1179648
.long 196608,0,589824,393216,266240,14012416,2146435072,8,3481600,13945088,13946880,14014464,11489280,3133440,737440,14086144
.long 81920,102400,122880,143360,0,20480,40960,61440,204800,225280,163840,184320,286720,307200,327680,245760
.long 2211840,1966080,983040,1228800,1474560,1720320,0,245760,491520,737280,1769472,1572864,786432,983040,1179648,1376256
.long 0,196608,393216,589824,266240,2146435072,2146435072,12,3481600,13946112,13946880,14015488,12881920,3133440,738080,14100480
.long 81920,102400,122880,143360,0,20480,40960,61440,204800,225280,163840,184320,286720,307200,327680,245760
.long 2211840,1966080,1228800,983040,1720320,1474560,245760,0,737280,491520,1769472,1572864,983040,786432,1376256,1179648
.long 196608,0,589824,393216,266240,14045184,2146435072,0,9052160,13961472,13979648,14045184,11489280,5918720,1392800,14057472
.long 81920,102400,122880,143360,0,20480,40960,61440,204800,225280,163840,184320,286720,307200,327680,245760
.long 2211840,1966080,983040,1228800,1474560,1720320,0,245760,491520,737280,1769472,1572864,786432,983040,1179648,1376256
.long 0,196608,393216,589824,266240,2146435072,2146435072,4,9052160,13962496,13979648,14046208,12881920,5918720,1393440,14071808
.long 81920,102400,122880,143360,0,20480,40960,61440,204800,225280,163840,184320,286720,307200,327680,245760
.long 1228800,983040,1720320,1474560,245760,0,737280,491520,2211840,1966080,983040,786432,1376256,1179648,196608,0
.long 589824,393216,1769472,1572864,266240,14045184,13993984,8,9052160,13977856,13979648,14047232,11489280,8704000,2048160,14086144
.long 81920,102400,122880,143360,0,20480,40960,61440,204800,225280,163840,184320,286720,307200,327680,245760
.long 983040,1228800,1474560,1720320,0,245760,491520,737280,2211840,1966080,786432,983040,1179648,1376256,0,196608
.long 393216,589824,1769472,1572864,266240,14045184,13995008,12,9052160,13978880,13979648,14048256,12881920,8704000,2048800,14100480
.long 122880,143360,0,20480,40960,61440,81920,102400,225280,163840,184320,204800,307200,327680,245760,266240
.long 1474560,1720320,983040,1228800,491520,737280,0,245760,1966080,2211840,1179648,1376256,786432,983040,393216,589824
.long 0,196608,1572864,1769472,286720,14016512,13991936,0,4177920,13928960,13950976,14016512,11837440,348160,82240,14057472
.long 122880,143360,0,20480,40960,61440,81920,102400,225280,163840,184320,204800,307200,327680,245760,266240
.long 1720320,1474560,1228800,983040,737280,491520,245760,0,1966080,2211840,1376256,1179648,983040,786432,589824,393216
.long 196608,0,1572864,1769472,286720,14016512,13992960,4,4177920,13929984,13950976,14017536,13230080,348160,82880,14071808
.long 122880,143360,0,20480,40960,61440,81920,102400,225280,163840,184320,204800,307200,327680,245760,266240
.long 1966080,2211840,1474560,1720320,983040,1228800,491520,737280,0,245760,1572864,1769472,1179648,1376256,786432,983040
.long 393216,589824,0,196608,286720,14016512,2146435072,8,4177920,13945344,13950976,14018560,11837440,3133440,737600,14086144
.long 122880,143360,0,20480,40960,61440,81920,102400,225280,163840,184320,204800,307200,327680,245760,266240
.long 1966080,2211840,1720320,1474560,1228800,983040,737280,491520,245760,0,1572864,1769472,1376256,1179648,983040,786432
.long 589824,393216,196608,0,286720,2146435072,2146435072,12,4177920,13946368,13950976,14019584,13230080,3133440,738240,14100480
.long 122880,143360,0,20480,40960,61440,81920,102400,225280,163840,184320,204800,307200,327680,245760,266240
.long 1966080,2211840,1474560,1720320,983040,1228800,491520,737280,0,245760,1572864,1769472,1179648,1376256,786432,983040
.long 393216,589824,0,196608,286720,14049280,2146435072,0,9748480,13961728,13983744,14049280,11837440,5918720,1392960,14057472
.long 122880,143360,0,20480,40960,61440,81920,102400,225280,163840,184320,204800,307200,327680,245760,266240
.long 1966080,2211840,1720320,1474560,1228800,983040,737280,491520,245760,0,1572864,1769472,1376256,1179648,983040,786432
.long 589824,393216,196608,0,286720,2146435072,2146435072,4,9748480,13962752,13983744,14050304,13230080,5918720,1393600,14071808
.long 122880,143360,0,20480,40960,61440,81920,102400,225280,163840,184320,204800,307200,327680,245760,266240
.long 1474560,1720320,983040,1228800,491520,737280,0,245760,1966080,2211840,1179648,1376256,786432,983040,393216,589824
.long 0,196608,1572864,1769472,286720,14049280,13993984,8,9748480,13978112,13983744,14051328,11837440,8704000,2048320,14086144
.long 122880,143360,0,20480,40960,61440,81920,102400,225280,163840,184320,204800,307200,327680,245760,266240
.long 1720320,1474560,1228800,983040,737280,491520,245760,0,1966080,2211840,1376256,1179648,983040,786432,589824,393216
.long 196608,0,1572864,1769472,286720,14049280,13995008,12,9748480,13979136,13983744,14052352,13230080,8704000,2048960,14100480
.long 0,20480,40960,61440,81920,102400,122880,143360,163840,184320,204800,225280,327680,245760,266240,286720
.long 1720320,1474560,1228800,983040,737280,491520,245760,0,2211840,1966080,1376256,1179648,983040,786432,589824,393216
.long 196608,0,1769472,1572864,307200,14020608,13991936,0,4874240,13929216,13955072,14020608,12185600,348160,82400,14057472
.long 0,20480,40960,61440,81920,102400,122880,143360,163840,184320,204800,225280,327680,245760,266240,286720
.long 1474560,1720320,983040,1228800,491520,737280,0,245760,2211840,1966080,1179648,1376256,786432,983040,393216,589824
.long 0,196608,1769472,1572864,307200,14020608,13992960,4,4874240,13930240,13955072,14021632,13578240,348160,83040,14071808
.long 0,20480,40960,61440,81920,102400,122880,143360,163840,184320,204800,225280,327680,245760,266240,286720
.long 2211840,1966080,1720320,1474560,1228800,983040,737280,491520,245760,0,1769472,1572864,1376256,1179648,983040,786432
.long 589824,393216,196608,0,307200,14020608,2146435072,8,4874240,13945600,13955072,14022656,12185600,3133440,737760,14086144
.long 0,20480,40960,61440,81920,102400,122880,143360,163840,184320,204800,225280,327680,245760,266240,286720
.long 2211840,1966080,1474560,1720320,983040,1228800,491520,737280,0,245760,1769472,1572864,1179648,1376256,786432,983040
.long 393216,589824,0,196608,307200,2146435072,2146435072,12,4874240,13946624,13955072,14023680,13578240,3133440,738400,14100480
.long 0,20480,40960,61440,81920,102400,122880,143360,163840,184320,204800,225280,327680,245760,266240,286720
.long 2211840,1966080,1720320,1474560,1228800,983040,737280,491520,245760,0,1769472,1572864,1376256,1179648,983040,786432
.long 589824,393216,196608,0,307200,14053376,2146435072,0,10444800,13961984,13987840,14053376,12185600,5918720,1393120,14057472
.long 0,20480,40960,61440,81920,102400,122880,143360,163840,184320,204800,225280,327680,245760,266240,286720
.long 2211840,1966080,1474560,1720320,983040,1228800,491520,737280,0,245760,1769472,1572864,1179648,1376256,786432,983040
.long 393216,589824,0,196608,307200,2146435072,2146435072,4,10444800,13963008,13987840,14054400,13578240,5918720,1393760,14071808
.long 0,20480,40960,61440,81920,102400,122880,143360,163840,184320,204800,225280,327680,245760,266240,286720
.long 1720320,1474560,1228800,983040,737280,491520,245760,0,2211840,1966080,1376256,1179648,983040,786432,589824,393216
.long 196608,0,1769472,1572864,307200,14053376,13993984,8,10444800,13978368,13987840,14055424,12185600,8704000,2048480,14086144
.long 0,20480,40960,61440,81920,102400,122880,143360,163840,184320,204800,225280,327680,245760,266240,286720
.long 1474560,1720320,983040,1228800,491520,737280,0,245760,2211840,1966080,1179648,1376256,786432,983040,393216,589824
.long 0,196608,1769472,1572864,307200,14053376,13995008,12,10444800,13979392,13987840,14056448,13578240,8704000,2049120,14100480
.long 0,20480,40960,61440,81920,102400,122880,143360,163840,184320,204800,225280,245760,266240,286720,307200
.long 491520,737280,0,245760,1474560,1720320,983040,1228800,2211840,1966080,393216,589824,0,196608,1179648,1376256
.long 786432,983040,1769472,1572864,327680,13991936,13992192,1,0,13930496,13926400,13992192,11141120,696320,163840,14057472
.long 0,20480,40960,61440,81920,102400,122880,143360,163840,184320,204800,225280,245760,266240,286720,307200
.long 737280,491520,245760,0,1720320,1474560,1228800,983040,2211840,1966080,589824,393216,196608,0,1376256,1179648
.long 983040,786432,1769472,1572864,327680,13991936,13993216,5,0,13931520,13926400,13993216,12533760,696320,164480,14071808
.long 0,20480,40960,61440,81920,102400,122880,143360,163840,184320,204800,225280,245760,266240,286720,307200
.long 2211840,1966080,491520,737280,0,245760,1474560,1720320,983040,1228800,1769472,1572864,393216,589824,0,196608
.long 1179648,1376256,786432,983040,327680,13991936,13994240,9,0,13946880,13926400,13994240,11141120,3481600,819200,14086144
.long 0,20480,40960,61440,81920,102400,122880,143360,163840,184320,204800,225280,245760,266240,286720,307200
.long 2211840,1966080,737280,491520,245760,0,1720320,1474560,1228800,983040,1769472,1572864,589824,393216,196608,0
.long 1376256,1179648,983040,786432,327680,2146435072,13995264,13,0,13947904,13926400,13995264,12533760,3481600,819840,14100480
.long 0,20480,40960,61440,81920,102400,122880,143360,163840,184320,204800,225280,245760,266240,286720,307200
.long 2211840,1966080,491520,737280,0,245760,1474560,1720320,983040,1228800,1769472,1572864,393216,589824,0,196608
.long 1179648,1376256,786432,983040,327680,14024704,13992192,1,5570560,13963264,13959168,14024960,11141120,6266880,1474560,14057472
.long 0,20480,40960,61440,81920,102400,122880,143360,163840,184320,204800,225280,245760,266240,286720,307200
.long 2211840,1966080,737280,491520,245760,0,1720320,1474560,1228800,983040,1769472,1572864,589824,393216,196608,0
.long 1376256,1179648,983040,786432,327680,2146435072,13993216,5,5570560,13964288,13959168,14025984,12533760,6266880,1475200,14071808
.long 0,20480,40960,61440,81920,102400,122880,143360,163840,184320,204800,225280,245760,266240,286720,307200
.long 491520,737280,0,245760,1474560,1720320,983040,1228800,2211840,1966080,393216,589824,0,196608,1179648,1376256
.long 786432,983040,1769472,1572864,327680,14024704,13994240,9,5570560,13979648,13959168,14027008,11141120,9052160,2129920,14086144
.long 0,20480,40960,61440,81920,102400,122880,143360,163840,184320,204800,225280,245760,266240,286720,307200
.long 737280,491520,245760,0,1720320,1474560,1228800,983040,2211840,1966080,589824,393216,196608,0,1376256,1179648
.long 983040,786432,1769472,1572864,327680,14024704,13995264,13,5570560,13980672,13959168,14028032,12533760,9052160,2130560,14100480
.long 40960,61440,81920,102400,122880,143360,0,20480,184320,204800,225280,163840,266240,286720,307200,327680
.long 737280,491520,245760,0,1720320,1474560,1228800,983040,1966080,2211840,589824,393216,196608,0,1376256,1179648
.long 983040,786432,1572864,1769472,245760,13996032,13992192,1,696320,13930752,13930496,13996288,11489280,696320,164000,14057472
.long 40960,61440,81920,102400,122880,143360,0,20480,184320,204800,225280,163840,266240,286720,307200,327680
.long 491520,737280,0,245760,1474560,1720320,983040,1228800,1966080,2211840,393216,589824,0,196608,1179648,1376256
.long 786432,983040,1572864,1769472,245760,13996032,13993216,5,696320,13931776,13930496,13997312,12881920,696320,164640,14071808
.long 40960,61440,81920,102400,122880,143360,0,20480,184320,204800,225280,163840,266240,286720,307200,327680
.long 1966080,2211840,737280,491520,245760,0,1720320,1474560,1228800,983040,1572864,1769472,589824,393216,196608,0
.long 1376256,1179648,983040,786432,245760,13996032,13994240,9,696320,13947136,13930496,13998336,11489280,3481600,819360,14086144
.long 40960,61440,81920,102400,122880,143360,0,20480,184320,204800,225280,163840,266240,286720,307200,327680
.long 1966080,2211840,491520,737280,0,245760,1474560,1720320,983040,1228800,1572864,1769472,393216,589824,0,196608
.long 1179648,1376256,786432,983040,245760,2146435072,13995264,13,696320,13948160,13930496,13999360,12881920,3481600,820000,14100480
.long 40960,61440,81920,102400,122880,143360,0,20480,184320,204800,225280,163840,266240,286720,307200,327680
.long 1966080,2211840,737280,491520,245760,0,1720320,1474560,1228800,983040,1572864,1769472,589824,393216,196608,0
.long 1376256,1179648,983040,786432,245760,14028800,13992192,1,6266880,13963520,13963264,14029056,11489280,6266880,1474720,14057472
.long 40960,61440,81920,102400,122880,143360,0,20480,184320,204800,225280,163840,266240,286720,307200,327680
.long 1966080,2211840,491520,737280,0,245760,1474560,1720320,983040,1228800,1572864,1769472,393216,589824,0,196608
.long 1179648,1376256,786432,983040,245760,2146435072,13993216,5,6266880,13964544,13963264,14030080,12881920,6266880,1475360,14071808
.long 40960,61440,81920,102400,122880,143360,0,20480,184320,204800,225280,163840,266240,286720,307200,327680
.long 737280,491520,245760,0,1720320,1474560,1228800,983040,1966080,2211840,589824,393216,196608,0,1376256,1179648
.long 983040,786432,1572864,1769472,245760,14028800,13994240,9,6266880,13979904,13963264,14031104,11489280,9052160,2130080,14086144
.long 40960,61440,81920,102400,122880,143360,0,20480,184320,204800,225280,163840,266240,286720,307200,327680
.long 491520,737280,0,245760,1474560,1720320,983040,1228800,1966080,2211840,393216,589824,0,196608,1179648,1376256
.long 786432,983040,1572864,1769472,245760,14028800,13995264,13,6266880,13980928,13963264,14032128,12881920,9052160,2130720,14100480
.long 81920,102400,122880,143360,0,20480,40960,61440,204800,225280,163840,184320,286720,307200,327680,245760
.long 0,245760,491520,737280,983040,1228800,1474560,1720320,2211840,1966080,0,196608,393216,589824,786432,983040
.long 1179648,1376256,1769472,1572864,266240,14000128,13992192,1,1392640,13931008,13934592,14000384,11837440,696320,164160,14057472
.long 81920,102400,122880,143360,0,20480,40960,61440,204800,225280,163840,184320,286720,307200,327680,245760
.long 245760,0,737280,491520,1228800,983040,1720320,1474560,2211840,1966080,196608,0,589824,393216,983040,786432
.long 1376256,1179648,1769472,1572864,266240,14000128,13993216,5,1392640,13932032,13934592,14001408,13230080,696320,164800,14071808
.long 81920,102400,122880,143360,0,20480,40960,61440,204800,225280,163840,184320,286720,307200,327680,245760
.long 2211840,1966080,0,245760,491520,737280,983040,1228800,1474560,1720320,1769472,1572864,0,196608,393216,589824
.long 786432,983040,1179648,1376256,266240,14000128,2146435072,9,1392640,13947392,13934592,14002432,11837440,3481600,819520,14086144
.long 81920,102400,122880,143360,0,20480,40960,61440,204800,225280,163840,184320,286720,307200,327680,245760
.long 2211840,1966080,245760,0,737280,491520,1228800,983040,1720320,1474560,1769472,1572864,196608,0,589824,393216
.long 983040,786432,1376256,1179648,266240,2146435072,2146435072,13,1392640,13948416,13934592,14003456,13230080,3481600,820160,14100480
.long 81920,102400,122880,143360,0,20480,40960,61440,204800,225280,163840,184320,286720,307200,327680,245760
.long 2211840,1966080,0,245760,491520,737280,983040,1228800,1474560,1720320,1769472,1572864,0,196608,393216,589824
.long 786432,983040,1179648,1376256,266240,14032896,2146435072,1,6963200,13963776,13967360,14033152,11837440,6266880,1474880,14057472
.long 81920,102400,122880,143360,0,20480,40960,61440,204800,225280,163840,184320,286720,307200,327680,245760
.long 2211840,1966080,245760,0,737280,491520,1228800,983040,1720320,1474560,1769472,1572864,196608,0,589824,393216
.long 983040,786432,1376256,1179648,266240,2146435072,2146435072,5,6963200,13964800,13967360,14034176,13230080,6266880,1475520,14071808
.long 81920,102400,122880,143360,0,20480,40960,61440,204800,225280,163840,184320,286720,307200,327680,245760
.long 0,245760,491520,737280,983040,1228800,1474560,1720320,2211840,1966080,0,196608,393216,589824,786432,983040
.long 1179648,1376256,1769472,1572864,266240,14032896,13994240,9,6963200,13980160,13967360,14035200,11837440,9052160,2130240,14086144
.long 81920,102400,122880,143360,0,20480,40960,61440,204800,225280,163840,184320,286720,307200,327680,245760
.long 245760,0,737280,491520,1228800,983040,1720320,1474560,2211840,1966080,196608,0,589824,393216,983040,786432
.long 1376256,1179648,1769472,1572864,266240,14032896,13995264,13,6963200,13981184,13967360,14036224,13230080,9052160,2130880,14100480
.long 122880,143360,0,20480,40960,61440,81920,102400,225280,163840,184320,204800,307200,327680,245760,266240
.long 245760,0,737280,491520,1228800,983040,1720320,1474560,1966080,2211840,196608,0,589824,393216,983040,786432
.long 1376256,1179648,1572864,1769472,286720,14004224,13992192,1,2088960,13931264,13938688,14004480,12185600,696320,164320,14057472
.long 122880,143360,0,20480,40960,61440,81920,102400,225280,163840,184320,204800,307200,327680,245760,266240
.long 0,245760,491520,737280,983040,1228800,1474560,1720320,1966080,2211840,0,196608,393216,589824,786432,983040
.long 1179648,1376256,1572864,1769472,286720,14004224,13993216,5,2088960,13932288,13938688,14005504,13578240,696320,164960,14071808
.long 122880,143360,0,20480,40960,61440,81920,102400,225280,163840,184320,204800,307200,327680,245760,266240
.long 1966080,2211840,245760,0,737280,491520,1228800,983040,1720320,1474560,1572864,1769472,196608,0,589824,393216
.long 983040,786432,1376256,1179648,286720,14004224,2146435072,9,2088960,13947648,13938688,14006528,12185600,3481600,819680,14086144
.long 122880,143360,0,20480,40960,61440,81920,102400,225280,163840,184320,204800,307200,327680,245760,266240
.long 1966080,2211840,0,245760,491520,737280,983040,1228800,1474560,1720320,1572864,1769472,0,196608,393216,589824
.long 786432,983040,1179648,1376256,286720,2146435072,2146435072,13,2088960,13948672,13938688,14007552,13578240,3481600,820320,14100480
.long 122880,143360,0,20480,40960,61440,81920,102400,225280,163840,184320,204800,307200,327680,245760,266240
.long 1966080,2211840,245760,0,737280,491520,1228800,983040,1720320,1474560,1572864,1769472,196608,0,589824,393216
.long 983040,786432,1376256,1179648,286720,14036992,2146435072,1,7659520,13964032,13971456,14037248,12185600,6266880,1475040,14057472
.long 122880,143360,0,20480,40960,61440,81920,102400,225280,163840,184320,204800,307200,327680,245760,266240
.long 1966080,2211840,0,245760,491520,737280,983040,1228800,1474560,1720320,1572864,1769472,0,196608,393216,589824
.long 786432,983040,1179648,1376256,286720,2146435072,2146435072,5,7659520,13965056,13971456,14038272,13578240,6266880,1475680,14071808
.long 122880,143360,0,20480,40960,61440,81920,102400,225280,163840,184320,204800,307200,327680,245760,266240
.long 245760,0,737280,491520,1228800,983040,1720320,1474560,1966080,2211840,196608,0,589824,393216,983040,786432
.long 1376256,1179648,1572864,1769472,286720,14036992,13994240,9,7659520,13980416,13971456,14039296,12185600,9052160,2130400,14086144
.long 122880,143360,0,20480,40960,61440,81920,102400,225280,163840,184320,204800,307200,327680,245760,266240
.long 0,245760,491520,737280,983040,1228800,1474560,1720320,1966080,2211840,0,196608,393216,589824,786432,983040
.long 1179648,1376256,1572864,1769472,286720,14036992,13995264,13,7659520,13981440,13971456,14040320,13578240,9052160,2131040,14100480
.long 40960,61440,81920,102400,122880,143360,0,20480,184320,204800,225280,163840,266240,286720,307200,327680
.long 1474560,1720320,983040,1228800,491520,737280,0,245760,2211840,1966080,1179648,1376256,786432,983040,393216,589824
.long 0,196608,1769472,1572864,245760,14008320,13992192,1,2785280,13932544,13942784,14008576,11141120,1044480,245760,14057472
.long 40960,61440,81920,102400,122880,143360,0,20480,184320,204800,225280,163840,266240,286720,307200,327680
.long 1720320,1474560,1228800,983040,737280,491520,245760,0,2211840,1966080,1376256,1179648,983040,786432,589824,393216
.long 196608,0,1769472,1572864,245760,14008320,13993216,5,2785280,13933568,13942784,14009600,12533760,1044480,246400,14071808
.long 40960,61440,81920,102400,122880,143360,0,20480,184320,204800,225280,163840,266240,286720,307200,327680
.long 2211840,1966080,1474560,1720320,983040,1228800,491520,737280,0,245760,1769472,1572864,1179648,1376256,786432,983040
.long 393216,589824,0,196608,245760,14008320,2146435072,9,2785280,13948928,13942784,14010624,11141120,3829760,901120,14086144
.long 40960,61440,81920,102400,122880,143360,0,20480,184320,204800,225280,163840,266240,286720,307200,327680
.long 2211840,1966080,1720320,1474560,1228800,983040,737280,491520,245760,0,1769472,1572864,1376256,1179648,983040,786432
.long 589824,393216,196608,0,245760,2146435072,2146435072,13,2785280,13949952,13942784,14011648,12533760,3829760,901760,14100480
.long 40960,61440,81920,102400,122880,143360,0,20480,184320,204800,225280,163840,266240,286720,307200,327680
.long 2211840,1966080,1474560,1720320,983040,1228800,491520,737280,0,245760,1769472,1572864,1179648,1376256,786432,983040
.long 393216,589824,0,196608,245760,14041088,2146435072,1,8355840,13965312,13975552,14041344,11141120,6615040,1556480,14057472
.long 40960,61440,81920,102400,122880,143360,0,20480,184320,204800,225280,163840,266240,286720,307200,327680
.long 2211840,1966080,1720320,1474560,1228800,983040,737280,491520,245760,0,1769472,1572864,1376256,1179648,983040,786432
.long 589824,393216,196608,0,245760,2146435072,2146435072,5,8355840,13966336,13975552,14042368,12533760,6615040,1557120,14071808
.long 40960,61440,81920,102400,122880,143360,0,20480,184320,204800,225280,163840,266240,286720,307200,327680
.long 1474560,1720320,983040,1228800,491520,737280,0,245760,2211840,1966080,1179648,1376256,786432,983040,393216,589824
.long 0,196608,1769472,1572864,245760,14041088,13994240,9,8355840,13981696,13975552,14043392,11141120,9400320,2211840,14086144
.long 40960,61440,81920,102400,122880,143360,0,20480,184320,204800,225280,163840,266240,286720,307200,327680
.long 1720320,1474560,1228800,983040,737280,491520,245760,0,2211840,1966080,1376256,1179648,983040,786432,589824,393216
.long 196608,0,1769472,1572864,245760,14041088,13995264,13,8355840,13982720,13975552,14044416,12533760,9400320,2212480,14100480
.long 81920,102400,122880,143360,0,20480,40960,61440,204800,225280,163840,184320,286720,307200,327680,245760
.long 1720320,1474560,1228800,983040,737280,491520,245760,0,1966080,2211840,1376256,1179648,983040,786432,589824,393216
.long 196608,0,1572864,1769472,266240,14012416,13992192,1,3481600,13932800,13946880,14012672,11489280,1044480,245920,14057472
.long 81920,102400,122880,143360,0,20480,40960,61440,204800,225280,163840,184320,286720,307200,327680,245760
.long 1474560,1720320,983040,1228800,491520,737280,0,245760,1966080,2211840,1179648,1376256,786432,983040,393216,589824
.long 0,196608,1572864,1769472,266240,14012416,13993216,5,3481600,13933824,13946880,14013696,12881920,1044480,246560,14071808
.long 81920,102400,122880,143360,0,20480,40960,61440,204800,225280,163840,184320,286720,307200,327680,245760
.long 1966080,2211840,1720320,1474560,1228800,983040,737280,491520,245760,0,1572864,1769472,1376256,1179648,983040,786432
.long 589824,393216,196608,0,266240,14012416,2146435072,9,3481600,13949184,13946880,14014720,11489280,3829760,901280,14086144
.long 81920,102400,122880,143360,0,20480,40960,61440,204800,225280,163840,184320,286720,307200,327680,245760
.long 1966080,2211840,1474560,1720320,983040,1228800,491520,737280,0,245760,1572864,1769472,1179648,1376256,786432,983040
.long 393216,589824,0,196608,266240,2146435072,2146435072,13,3481600,13950208,13946880,14015744,12881920,3829760,901920,14100480
.long 81920,102400,122880,143360,0,20480,40960,61440,204800,225280,163840,184320,286720,307200,327680,245760
.long 1966080,2211840,1720320,1474560,1228800,983040,737280,491520,245760,0,1572864,1769472,1376256,1179648,983040,786432
.long 589824,393216,196608,0,266240,14045184,2146435072,1,9052160,13965568,13979648,14045440,11489280,6615040,1556640,14057472
.long 81920,102400,122880,143360,0,20480,40960,61440,204800,225280,163840,184320,286720,307200,327680,245760
.long 1966080,2211840,1474560,1720320,983040,1228800,491520,737280,0,245760,1572864,1769472,1179648,1376256,786432,983040
.long 393216,589824,0,196608,266240,2146435072,2146435072,5,9052160,13966592,13979648,14046464,12881920,6615040,1557280,14071808
.long 81920,102400,122880,143360,0,20480,40960,61440,204800,225280,163840,184320,286720,307200,327680,245760
.long 1720320,1474560,1228800,983040,737280,491520,245760,0,1966080,2211840,1376256,1179648,983040,786432,589824,393216
.long 196608,0,1572864,1769472,266240,14045184,13994240,9,9052160,13981952,13979648,14047488,11489280,9400320,2212000,14086144
.long 81920,102400,122880,143360,0,20480,40960,61440,204800,225280,163840,184320,286720,307200,327680,245760
.long 1474560,1720320,983040,1228800,491520,737280,0,245760,1966080,2211840,1179648,1376256,786432,983040,393216,589824
.long 0,196608,1572864,1769472,266240,14045184,13995264,13,9052160,13982976,13979648,14048512,12881920,9400320,2212640,14100480
.long 122880,143360,0,20480,40960,61440,81920,102400,225280,163840,184320,204800,307200,327680,245760,266240
.long 983040,1228800,1474560,1720320,0,245760,491520,737280,2211840,1966080,786432,983040,1179648,1376256,0,196608
.long 393216,589824,1769472,1572864,286720,14016512,13992192,1,4177920,13933056,13950976,14016768,11837440,1044480,246080,14057472
.long 122880,143360,0,20480,40960,61440,81920,102400,225280,163840,184320,204800,307200,327680,245760,266240
.long 1228800,983040,1720320,1474560,245760,0,737280,491520,2211840,1966080,983040,786432,1376256,1179648,196608,0
.long 589824,393216,1769472,1572864,286720,14016512,13993216,5,4177920,13934080,13950976,14017792,13230080,1044480,246720,14071808
.long 122880,143360,0,20480,40960,61440,81920,102400,225280,163840,184320,204800,307200,327680,245760,266240
.long 2211840,1966080,983040,1228800,1474560,1720320,0,245760,491520,737280,1769472,1572864,786432,983040,1179648,1376256
.long 0,196608,393216,589824,286720,14016512,2146435072,9,4177920,13949440,13950976,14018816,11837440,3829760,901440,14086144
.long 122880,143360,0,20480,40960,61440,81920,102400,225280,163840,184320,204800,307200,327680,245760,266240
.long 2211840,1966080,1228800,983040,1720320,1474560,245760,0,737280,491520,1769472,1572864,983040,786432,1376256,1179648
.long 196608,0,589824,393216,286720,2146435072,2146435072,13,4177920,13950464,13950976,14019840,13230080,3829760,902080,14100480
.long 122880,143360,0,20480,40960,61440,81920,102400,225280,163840,184320,204800,307200,327680,245760,266240
.long 2211840,1966080,983040,1228800,1474560,1720320,0,245760,491520,737280,1769472,1572864,786432,983040,1179648,1376256
.long 0,196608,393216,589824,286720,14049280,2146435072,1,9748480,13965824,13983744,14049536,11837440,6615040,1556800,14057472
.long 122880,143360,0,20480,40960,61440,81920,102400,225280,163840,184320,204800,307200,327680,245760,266240
.long 2211840,1966080,1228800,983040,1720320,1474560,245760,0,737280,491520,1769472,1572864,983040,786432,1376256,1179648
.long 196608,0,589824,393216,286720,2146435072,2146435072,5,9748480,13966848,13983744,14050560,13230080,6615040,1557440,14071808
.long 122880,143360,0,20480,40960,61440,81920,102400,225280,163840,184320,204800,307200,327680,245760,266240
.long 983040,1228800,1474560,1720320,0,245760,491520,737280,2211840,1966080,786432,983040,1179648,1376256,0,196608
.long 393216,589824,1769472,1572864,286720,14049280,13994240,9,9748480,13982208,13983744,14051584,11837440,9400320,2212160,14086144
.long 122880,143360,0,20480,40960,61440,81920,102400,225280,163840,184320,204800,307200,327680,245760,266240
.long 1228800,983040,1720320,1474560,245760,0,737280,491520,2211840,1966080,983040,786432,1376256,1179648,196608,0
.long 589824,393216,1769472,1572864,286720,14049280,13995264,13,9748480,13983232,13983744,14052608,13230080,9400320,2212800,14100480
.long 0,20480,40960,61440,81920,102400,122880,143360,163840,184320,204800,225280,327680,245760,266240,286720
.long 1228800,983040,1720320,1474560,245760,0,737280,491520,1966080,2211840,983040,786432,1376256,1179648,196608,0
.long 589824,393216,1572864,1769472,307200,14020608,13992192,1,4874240,13933312,13955072,14020864,12185600,1044480,246240,14057472
.long 0,20480,40960,61440,81920,102400,122880,143360,163840,184320,204800,225280,327680,245760,266240,286720
.long 983040,1228800,1474560,1720320,0,245760,491520,737280,1966080,2211840,786432,983040,1179648,1376256,0,196608
.long 393216,589824,1572864,1769472,307200,14020608,13993216,5,4874240,13934336,13955072,14021888,13578240,1044480,246880,14071808
.long 0,20480,40960,61440,81920,102400,122880,143360,163840,184320,204800,225280,327680,245760,266240,286720
.long 1966080,2211840,1228800,983040,1720320,1474560,245760,0,737280,491520,1572864,1769472,983040,786432,1376256,1179648
.long 196608,0,589824,393216,307200,14020608,2146435072,9,4874240,13949696,13955072,14022912,12185600,3829760,901600,14086144
.long 0,20480,40960,61440,81920,102400,122880,143360,163840,184320,204800,225280,327680,245760,266240,286720
.long 1966080,2211840,983040,1228800,1474560,1720320,0,245760,491520,737280,1572864,1769472,786432,983040,1179648,1376256
.long 0,196608,393216,589824,307200,2146435072,2146435072,13,4874240,13950720,13955072,14023936,13578240,3829760,902240,14100480
.long 0,20480,40960,61440,81920,102400,122880,143360,163840,184320,204800,225280,327680,245760,266240,286720
.long 1966080,2211840,1228800,983040,1720320,1474560,245760,0,737280,491520,1572864,1769472,983040,786432,1376256,1179648
.long 196608,0,589824,393216,307200,14053376,2146435072,1,10444800,13966080,13987840,14053632,12185600,6615040,1556960,14057472
.long 0,20480,40960,61440,81920,102400,122880,143360,163840,184320,204800,225280,327680,245760,266240,286720
.long 1966080,2211840,983040,1228800,1474560,1720320,0,245760,491520,737280,1572864,1769472,786432,983040,1179648,1376256
.long 0,196608,393216,589824,307200,2146435072,2146435072,5,10444800,13967104,13987840,14054656,13578240,6615040,1557600,14071808
.long 0,20480,40960,61440,81920,102400,122880,143360,163840,184320,204800,225280,327680,245760,266240,286720
.long 1228800,983040,1720320,1474560,245760,0,737280,491520,1966080,2211840,983040,786432,1376256,1179648,196608,0
.long 589824,393216,1572864,1769472,307200,14053376,13994240,9,10444800,13982464,13987840,14055680,12185600,9400320,2212320,14086144
.long 0,20480,40960,61440,81920,102400,122880,143360,163840,184320,204800,225280,327680,245760,266240,286720
.long 983040,1228800,1474560,1720320,0,245760,491520,737280,1966080,2211840,786432,983040,1179648,1376256,0,196608
.long 393216,589824,1572864,1769472,307200,14053376,13995264,13,10444800,13983488,13987840,14056704,13578240,9400320,2212960,14100480
.long 81920,102400,122880,143360,0,20480,40960,61440,204800,225280,163840,184320,286720,307200,327680,245760
.long 983040,1228800,1474560,1720320,0,245760,491520,737280,1966080,2211840,786432,983040,1179648,1376256,0,196608
.long 393216,589824,1572864,1769472,266240,13991936,13992448,2,0,13934592,13926400,13992448,11141120,1392640,327680,14064640
.long 81920,102400,122880,143360,0,20480,40960,61440,204800,225280,163840,184320,286720,307200,327680,245760
.long 1228800,983040,1720320,1474560,245760,0,737280,491520,1966080,2211840,983040,786432,1376256,1179648,196608,0
.long 589824,393216,1572864,1769472,266240,13991936,13993472,6,0,13935616,13926400,13993472,12533760,1392640,328320,14078976
.long 81920,102400,122880,143360,0,20480,40960,61440,204800,225280,163840,184320,286720,307200,327680,245760
.long 1966080,2211840,983040,1228800,1474560,1720320,0,245760,491520,737280,1572864,1769472,786432,983040,1179648,1376256
.long 0,196608,393216,589824,266240,2146435072,13994496,10,0,13950976,13926400,13994496,11141120,4177920,983040,14093312
.long 81920,102400,122880,143360,0,20480,40960,61440,204800,225280,163840,184320,286720,307200,327680,245760
.long 1966080,2211840,1228800,983040,1720320,1474560,245760,0,737280,491520,1572864,1769472,983040,786432,1376256,1179648
.long 196608,0,589824,393216,266240,2146435072,13995520,14,0,13952000,13926400,13995520,12533760,4177920,983680,14107648
.long 81920,102400,122880,143360,0,20480,40960,61440,204800,225280,163840,184320,286720,307200,327680,245760
.long 1966080,2211840,983040,1228800,1474560,1720320,0,245760,491520,737280,1572864,1769472,786432,983040,1179648,1376256
.long 0,196608,393216,589824,266240,2146435072,13992448,2,5570560,13967360,13959168,14025216,11141120,6963200,1638400,14064640
.long 81920,102400,122880,143360,0,20480,40960,61440,204800,225280,163840,184320,286720,307200,327680,245760
.long 1966080,2211840,1228800,983040,1720320,1474560,245760,0,737280,491520,1572864,1769472,983040,786432,1376256,1179648
.long 196608,0,589824,393216,266240,2146435072,13993472,6,5570560,13968384,13959168,14026240,12533760,6963200,1639040,14078976
.long 81920,102400,122880,143360,0,20480,40960,61440,204800,225280,163840,184320,286720,307200,327680,245760
.long 983040,1228800,1474560,1720320,0,245760,491520,737280,1966080,2211840,786432,983040,1179648,1376256,0,196608
.long 393216,589824,1572864,1769472,266240,14024704,13994496,10,5570560,13983744,13959168,14027264,11141120,9748480,2293760,14093312
.long 81920,102400,122880,143360,0,20480,40960,61440,204800,225280,163840,184320,286720,307200,327680,245760
.long 1228800,983040,1720320,1474560,245760,0,737280,491520,1966080,2211840,983040,786432,1376256,1179648,196608,0
.long 589824,393216,1572864,1769472,266240,14024704,13995520,14,5570560,13984768,13959168,14028288,12533760,9748480,2294400,14107648
.long 122880,143360,0,20480,40960,61440,81920,102400,225280,163840,184320,204800,307200,327680,245760,266240
.long 1228800,983040,1720320,1474560,245760,0,737280,491520,2211840,1966080,983040,786432,1376256,1179648,196608,0
.long 589824,393216,1769472,1572864,286720,13996032,13992448,2,696320,13934848,13930496,13996544,11489280,1392640,327840,14064640
.long 122880,143360,0,20480,40960,61440,81920,102400,225280,163840,184320,204800,307200,327680,245760,266240
.long 983040,1228800,1474560,1720320,0,245760,491520,737280,2211840,1966080,786432,983040,1179648,1376256,0,196608
.long 393216,589824,1769472,1572864,286720,13996032,13993472,6,696320,13935872,13930496,13997568,12881920,1392640,328480,14078976
.long 122880,143360,0,20480,40960,61440,81920,102400,225280,163840,184320,204800,307200,327680,245760,266240
.long 2211840,1966080,1228800,983040,1720320,1474560,245760,0,737280,491520,1769472,1572864,983040,786432,1376256,1179648
.long 196608,0,589824,393216,286720,2146435072,13994496,10,696320,13951232,13930496,13998592,11489280,4177920,983200,14093312
.long 122880,143360,0,20480,40960,61440,81920,102400,225280,163840,184320,204800,307200,327680,245760,266240
.long 2211840,1966080,983040,1228800,1474560,1720320,0,245760,491520,737280,1769472,1572864,786432,983040,1179648,1376256
.long 0,196608,393216,589824,286720,2146435072,13995520,14,696320,13952256,13930496,13999616,12881920,4177920,983840,14107648
.long 122880,143360,0,20480,40960,61440,81920,102400,225280,163840,184320,204800,307200,327680,245760,266240
.long 2211840,1966080,1228800,983040,1720320,1474560,245760,0,737280,491520,1769472,1572864,983040,786432,1376256,1179648
.long 196608,0,589824,393216,286720,2146435072,13992448,2,6266880,13967616,13963264,14029312,11489280,6963200,1638560,14064640
.long 122880,143360,0,20480,40960,61440,81920,102400,225280,163840,184320,204800,307200,327680,245760,266240
.long 2211840,1966080,983040,1228800,1474560,1720320,0,245760,491520,737280,1769472,1572864,786432,983040,1179648,1376256
.long 0,196608,393216,589824,286720,2146435072,13993472,6,6266880,13968640,13963264,14030336,12881920,6963200,1639200,14078976
.long 122880,143360,0,20480,40960,61440,81920,102400,225280,163840,184320,204800,307200,327680,245760,266240
.long 1228800,983040,1720320,1474560,245760,0,737280,491520,2211840,1966080,983040,786432,1376256,1179648,196608,0
.long 589824,393216,1769472,1572864,286720,14028800,13994496,10,6266880,13984000,13963264,14031360,11489280,9748480,2293920,14093312
.long 122880,143360,0,20480,40960,61440,81920,102400,225280,163840,184320,204800,307200,327680,245760,266240
.long 983040,1228800,1474560,1720320,0,245760,491520,737280,2211840,1966080,786432,983040,1179648,1376256,0,196608
.long 393216,589824,1769472,1572864,286720,14028800,13995520,14,6266880,13985024,13963264,14032384,12881920,9748480,2294560,14107648
.long 0,20480,40960,61440,81920,102400,122880,143360,163840,184320,204800,225280,327680,245760,266240,286720
.long 1474560,1720320,983040,1228800,491520,737280,0,245760,1966080,2211840,1179648,1376256,786432,983040,393216,589824
.long 0,196608,1572864,1769472,307200,14000128,13992448,2,1392640,13935104,13934592,14000640,11837440,1392640,328000,14064640
.long 0,20480,40960,61440,81920,102400,122880,143360,163840,184320,204800,225280,327680,245760,266240,286720
.long 1720320,1474560,1228800,983040,737280,491520,245760,0,1966080,2211840,1376256,1179648,983040,786432,589824,393216
.long 196608,0,1572864,1769472,307200,14000128,13993472,6,1392640,13936128,13934592,14001664,13230080,1392640,328640,14078976
.long 0,20480,40960,61440,81920,102400,122880,143360,163840,184320,204800,225280,327680,245760,266240,286720
.long 1966080,2211840,1474560,1720320,983040,1228800,491520,737280,0,245760,1572864,1769472,1179648,1376256,786432,983040
.long 393216,589824,0,196608,307200,2146435072,2146435072,10,1392640,13951488,13934592,14002688,11837440,4177920,983360,14093312
.long 0,20480,40960,61440,81920,102400,122880,143360,163840,184320,204800,225280,327680,245760,266240,286720
.long 1966080,2211840,1720320,1474560,1228800,983040,737280,491520,245760,0,1572864,1769472,1376256,1179648,983040,786432
.long 589824,393216,196608,0,307200,2146435072,2146435072,14,1392640,13952512,13934592,14003712,13230080,4177920,984000,14107648
.long 0,20480,40960,61440,81920,102400,122880,143360,163840,184320,204800,225280,327680,245760,266240,286720
.long 1966080,2211840,1474560,1720320,983040,1228800,491520,737280,0,245760,1572864,1769472,1179648,1376256,786432,983040
.long 393216,589824,0,196608,307200,2146435072,2146435072,2,6963200,13967872,13967360,14033408,11837440,6963200,1638720,14064640
.long 0,20480,40960,61440,81920,102400,122880,143360,163840,184320,204800,225280,327680,245760,266240,286720
.long 1966080,2211840,1720320,1474560,1228800,983040,737280,491520,245760,0,1572864,1769472,1376256,1179648,983040,786432
.long 589824,393216,196608,0,307200,2146435072,2146435072,6,6963200,13968896,13967360,14034432,13230080,6963200,1639360,14078976
.long 0,20480,40960,61440,81920,102400,122880,143360,163840,184320,204800,225280,327680,245760,266240,286720
.long 1474560,1720320,983040,1228800,491520,737280,0,245760,1966080,2211840,1179648,1376256,786432,983040,393216,589824
.long 0,196608,1572864,1769472,307200,14032896,13994496,10,6963200,13984256,13967360,14035456,11837440,9748480,2294080,14093312
.long 0,20480,40960,61440,81920,102400,122880,143360,163840,184320,204800,225280,327680,245760,266240,286720
.long 1720320,1474560,1228800,983040,737280,491520,245760,0,1966080,2211840,1376256,1179648,983040,786432,589824,393216
.long 196608,0,1572864,1769472,307200,14032896,13995520,14,6963200,13985280,13967360,14036480,13230080,9748480,2294720,14107648
.long 40960,61440,81920,102400,122880,143360,0,20480,184320,204800,225280,163840,245760,266240,286720,307200
.long 1720320,1474560,1228800,983040,737280,491520,245760,0,2211840,1966080,1376256,1179648,983040,786432,589824,393216
.long 196608,0,1769472,1572864,327680,14004224,13992448,2,2088960,13935360,13938688,14004736,12185600,1392640,328160,14064640
.long 40960,61440,81920,102400,122880,143360,0,20480,184320,204800,225280,163840,245760,266240,286720,307200
.long 1474560,1720320,983040,1228800,491520,737280,0,245760,2211840,1966080,1179648,1376256,786432,983040,393216,589824
.long 0,196608,1769472,1572864,327680,14004224,13993472,6,2088960,13936384,13938688,14005760,13578240,1392640,328800,14078976
.long 40960,61440,81920,102400,122880,143360,0,20480,184320,204800,225280,163840,245760,266240,286720,307200
.long 2211840,1966080,1720320,1474560,1228800,983040,737280,491520,245760,0,1769472,1572864,1376256,1179648,983040,786432
.long 589824,393216,196608,0,327680,2146435072,2146435072,10,2088960,13951744,13938688,14006784,12185600,4177920,983520,14093312
.long 40960,61440,81920,102400,122880,143360,0,20480,184320,204800,225280,163840,245760,266240,286720,307200
.long 2211840,1966080,1474560,1720320,983040,1228800,491520,737280,0,245760,1769472,1572864,1179648,1376256,786432,983040
.long 393216,589824,0,196608,327680,2146435072,2146435072,14,2088960,13952768,13938688,14007808,13578240,4177920,984160,14107648
.long 40960,61440,81920,102400,122880,143360,0,20480,184320,204800,225280,163840,245760,266240,286720,307200
.long 2211840,1966080,1720320,1474560,1228800,983040,737280,491520,245760,0,1769472,1572864,1376256,1179648,983040,786432
.long 589824,393216,196608,0,327680,2146435072,2146435072,2,7659520,13968128,13971456,14037504,12185600,6963200,1638880,14064640
.long 40960,61440,81920,102400,122880,143360,0,20480,184320,204800,225280,163840,245760,266240,286720,307200
.long 2211840,1966080,1474560,1720320,983040,1228800,491520,737280,0,245760,1769472,1572864,1179648,1376256,786432,983040
.long 393216,589824,0,196608,327680,2146435072,2146435072,6,7659520,13969152,13971456,14038528,13578240,6963200,1639520,14078976
.long 40960,61440,81920,102400,122880,143360,0,20480,184320,204800,225280,163840,245760,266240,286720,307200
.long 1720320,1474560,1228800,983040,737280,491520,245760,0,2211840,1966080,1376256,1179648,983040,786432,589824,393216
.long 196608,0,1769472,1572864,327680,14036992,13994496,10,7659520,13984512,13971456,14039552,12185600,9748480,2294240,14093312
.long 40960,61440,81920,102400,122880,143360,0,20480,184320,204800,225280,163840,245760,266240,286720,307200
.long 1474560,1720320,983040,1228800,491520,737280,0,245760,2211840,1966080,1179648,1376256,786432,983040,393216,589824
.long 0,196608,1769472,1572864,327680,14036992,13995520,14,7659520,13985536,13971456,14040576,13578240,9748480,2294880,14107648
.long 122880,143360,0,20480,40960,61440,81920,102400,225280,163840,184320,204800,307200,327680,245760,266240
.long 0,245760,491520,737280,983040,1228800,1474560,1720320,1966080,2211840,0,196608,393216,589824,786432,983040
.long 1179648,1376256,1572864,1769472,286720,14008320,13992448,2,2785280,13936640,13942784,14008832,11141120,1740800,409600,14064640
.long 122880,143360,0,20480,40960,61440,81920,102400,225280,163840,184320,204800,307200,327680,245760,266240
.long 245760,0,737280,491520,1228800,983040,1720320,1474560,1966080,2211840,196608,0,589824,393216,983040,786432
.long 1376256,1179648,1572864,1769472,286720,14008320,13993472,6,2785280,13937664,13942784,14009856,12533760,1740800,410240,14078976
.long 122880,143360,0,20480,40960,61440,81920,102400,225280,163840,184320,204800,307200,327680,245760,266240
.long 1966080,2211840,0,245760,491520,737280,983040,1228800,1474560,1720320,1572864,1769472,0,196608,393216,589824
.long 786432,983040,1179648,1376256,286720,2146435072,2146435072,10,2785280,13953024,13942784,14010880,11141120,4526080,1064960,14093312
.long 122880,143360,0,20480,40960,61440,81920,102400,225280,163840,184320,204800,307200,327680,245760,266240
.long 1966080,2211840,245760,0,737280,491520,1228800,983040,1720320,1474560,1572864,1769472,196608,0,589824,393216
.long 983040,786432,1376256,1179648,286720,2146435072,2146435072,14,2785280,13954048,13942784,14011904,12533760,4526080,1065600,14107648
.long 122880,143360,0,20480,40960,61440,81920,102400,225280,163840,184320,204800,307200,327680,245760,266240
.long 1966080,2211840,0,245760,491520,737280,983040,1228800,1474560,1720320,1572864,1769472,0,196608,393216,589824
.long 786432,983040,1179648,1376256,286720,2146435072,2146435072,2,8355840,13969408,13975552,14041600,11141120,7311360,1720320,14064640
.long 122880,143360,0,20480,40960,61440,81920,102400,225280,163840,184320,204800,307200,327680,245760,266240
.long 1966080,2211840,245760,0,737280,491520,1228800,983040,1720320,1474560,1572864,1769472,196608,0,589824,393216
.long 983040,786432,1376256,1179648,286720,2146435072,2146435072,6,8355840,13970432,13975552,14042624,12533760,7311360,1720960,14078976
.long 122880,143360,0,20480,40960,61440,81920,102400,225280,163840,184320,204800,307200,327680,245760,266240
.long 0,245760,491520,737280,983040,1228800,1474560,1720320,1966080,2211840,0,196608,393216,589824,786432,983040
.long 1179648,1376256,1572864,1769472,286720,14041088,13994496,10,8355840,13985792,13975552,14043648,11141120,10096640,2375680,14093312
.long 122880,143360,0,20480,40960,61440,81920,102400,225280,163840,184320,204800,307200,327680,245760,266240
.long 245760,0,737280,491520,1228800,983040,1720320,1474560,1966080,2211840,196608,0,589824,393216,983040,786432
.long 1376256,1179648,1572864,1769472,286720,14041088,13995520,14,8355840,13986816,13975552,14044672,12533760,10096640,2376320,14107648
.long 0,20480,40960,61440,81920,102400,122880,143360,163840,184320,204800,225280,327680,245760,266240,286720
.long 245760,0,737280,491520,1228800,983040,1720320,1474560,2211840,1966080,196608,0,589824,393216,983040,786432
.long 1376256,1179648,1769472,1572864,307200,14012416,13992448,2,3481600,13936896,13946880,14012928,11489280,1740800,409760,14064640
.long 0,20480,40960,61440,81920,102400,122880,143360,163840,184320,204800,225280,327680,245760,266240,286720
.long 0,245760,491520,737280,983040,1228800,1474560,1720320,2211840,1966080,0,196608,393216,589824,786432,983040
.long 1179648,1376256,1769472,1572864,307200,14012416,13993472,6,3481600,13937920,13946880,14013952,12881920,1740800,410400,14078976
.long 0,20480,40960,61440,81920,102400,122880,143360,163840,184320,204800,225280,327680,245760,266240,286720
.long 2211840,1966080,245760,0,737280,491520,1228800,983040,1720320,1474560,1769472,1572864,196608,0,589824,393216
.long 983040,786432,1376256,1179648,307200,2146435072,2146435072,10,3481600,13953280,13946880,14014976,11489280,4526080,1065120,14093312
.long 0,20480,40960,61440,81920,102400,122880,143360,163840,184320,204800,225280,327680,245760,266240,286720
.long 2211840,1966080,0,245760,491520,737280,983040,1228800,1474560,1720320,1769472,1572864,0,196608,393216,589824
.long 786432,983040,1179648,1376256,307200,2146435072,2146435072,14,3481600,13954304,13946880,14016000,12881920,4526080,1065760,14107648
.long 0,20480,40960,61440,81920,102400,122880,143360,163840,184320,204800,225280,327680,245760,266240,286720
.long 2211840,1966080,245760,0,737280,491520,1228800,983040,1720320,1474560,1769472,1572864,196608,0,589824,393216
.long 983040,786432,1376256,1179648,307200,2146435072,2146435072,2,9052160,13969664,13979648,14045696,11489280,7311360,1720480,14064640
.long 0,20480,40960,61440,81920,102400,122880,143360,163840,184320,204800,225280,327680,245760,266240,286720
.long 2211840,1966080,0,245760,491520,737280,983040,1228800,1474560,1720320,1769472,1572864,0,196608,393216,589824
.long 786432,983040,1179648,1376256,307200,2146435072,2146435072,6,9052160,13970688,13979648,14046720,12881920,7311360,1721120,14078976
.long 0,20480,40960,61440,81920,102400,122880,143360,163840,184320,204800,225280,327680,245760,266240,286720
.long 245760,0,737280,491520,1228800,983040,1720320,1474560,2211840,1966080,196608,0,589824,393216,983040,786432
.long 1376256,1179648,1769472,1572864,307200,14045184,13994496,10,9052160,13986048,13979648,14047744,11489280,10096640,2375840,14093312
.long 0,20480,40960,61440,81920,102400,122880,143360,163840,184320,204800,225280,327680,245760,266240,286720
.long 0,245760,491520,737280,983040,1228800,1474560,1720320,2211840,1966080,0,196608,393216,589824,786432,983040
.long 1179648,1376256,1769472,1572864,307200,14045184,13995520,14,9052160,13987072,13979648,14048768,12881920,10096640,2376480,14107648
.long 40960,61440,81920,102400,122880,143360,0,20480,184320,204800,225280,163840,245760,266240,286720,307200
.long 491520,737280,0,245760,1474560,1720320,983040,1228800,1966080,2211840,393216,589824,0,196608,1179648,1376256
.long 786432,983040,1572864,1769472,327680,14016512,13992448,2,4177920,13937152,13950976,14017024,11837440,1740800,409920,14064640
.long 40960,61440,81920,102400,122880,143360,0,20480,184320,204800,225280,163840,245760,266240,286720,307200
.long 737280,491520,245760,0,1720320,1474560,1228800,983040,1966080,2211840,589824,393216,196608,0,1376256,1179648
.long 983040,786432,1572864,1769472,327680,14016512,13993472,6,4177920,13938176,13950976,14018048,13230080,1740800,410560,14078976
.long 40960,61440,81920,102400,122880,143360,0,20480,184320,204800,225280,163840,245760,266240,286720,307200
.long 1966080,2211840,491520,737280,0,245760,1474560,1720320,983040,1228800,1572864,1769472,393216,589824,0,196608
.long 1179648,1376256,786432,983040,327680,2146435072,2146435072,10,4177920,13953536,13950976,14019072,11837440,4526080,1065280,14093312
.long 40960,61440,81920,102400,122880,143360,0,20480,184320,204800,225280,163840,245760,266240,286720,307200
.long 1966080,2211840,737280,491520,245760,0,1720320,1474560,1228800,983040,1572864,1769472,589824,393216,196608,0
.long 1376256,1179648,983040,786432,327680,2146435072,2146435072,14,4177920,13954560,13950976,14020096,13230080,4526080,1065920,14107648
.long 40960,61440,81920,102400,122880,143360,0,20480,184320,204800,225280,163840,245760,266240,286720,307200
.long 1966080,2211840,491520,737280,0,245760,1474560,1720320,983040,1228800,1572864,1769472,393216,589824,0,196608
.long 1179648,1376256,786432,983040,327680,2146435072,2146435072,2,9748480,13969920,13983744,14049792,11837440,7311360,1720640,14064640
.long 40960,61440,81920,102400,122880,143360,0,20480,184320,204800,225280,163840,245760,266240,286720,307200
.long 1966080,2211840,737280,491520,245760,0,1720320,1474560,1228800,983040,1572864,1769472,589824,393216,196608,0
.long 1376256,1179648,983040,786432,327680,2146435072,2146435072,6,9748480,13970944,13983744,14050816,13230080,7311360,1721280,14078976
.long 40960,61440,81920,102400,122880,143360,0,20480,184320,204800,225280,163840,245760,266240,286720,307200
.long 491520,737280,0,245760,1474560,1720320,983040,1228800,1966080,2211840,393216,589824,0,196608,1179648,1376256
.long 786432,983040,1572864,1769472,327680,14049280,13994496,10,9748480,13986304,13983744,14051840,11837440,10096640,2376000,14093312
.long 40960,61440,81920,102400,122880,143360,0,20480,184320,204800,225280,163840,245760,266240,286720,307200
.long 737280,491520,245760,0,1720320,1474560,1228800,983040,1966080,2211840,589824,393216,196608,0,1376256,1179648
.long 983040,786432,1572864,1769472,327680,14049280,13995520,14,9748480,13987328,13983744,14052864,13230080,10096640,2376640,14107648
.long 81920,102400,122880,143360,0,20480,40960,61440,204800,225280,163840,184320,266240,286720,307200,327680
.long 737280,491520,245760,0,1720320,1474560,1228800,983040,2211840,1966080,589824,393216,196608,0,1376256,1179648
.long 983040,786432,1769472,1572864,245760,14020608,13992448,2,4874240,13937408,13955072,14021120,12185600,1740800,410080,14064640
.long 81920,102400,122880,143360,0,20480,40960,61440,204800,225280,163840,184320,266240,286720,307200,327680
.long 491520,737280,0,245760,1474560,1720320,983040,1228800,2211840,1966080,393216,589824,0,196608,1179648,1376256
.long 786432,983040,1769472,1572864,245760,14020608,13993472,6,4874240,13938432,13955072,14022144,13578240,1740800,410720,14078976
.long 81920,102400,122880,143360,0,20480,40960,61440,204800,225280,163840,184320,266240,286720,307200,327680
.long 2211840,1966080,737280,491520,245760,0,1720320,1474560,1228800,983040,1769472,1572864,589824,393216,196608,0
.long 1376256,1179648,983040,786432,245760,2146435072,2146435072,10,4874240,13953792,13955072,14023168,12185600,4526080,1065440,14093312
.long 81920,102400,122880,143360,0,20480,40960,61440,204800,225280,163840,184320,266240,286720,307200,327680
.long 2211840,1966080,491520,737280,0,245760,1474560,1720320,983040,1228800,1769472,1572864,393216,589824,0,196608
.long 1179648,1376256,786432,983040,245760,2146435072,2146435072,14,4874240,13954816,13955072,14024192,13578240,4526080,1066080,14107648
.long 81920,102400,122880,143360,0,20480,40960,61440,204800,225280,163840,184320,266240,286720,307200,327680
.long 2211840,1966080,737280,491520,245760,0,1720320,1474560,1228800,983040,1769472,1572864,589824,393216,196608,0
.long 1376256,1179648,983040,786432,245760,2146435072,2146435072,2,10444800,13970176,13987840,14053888,12185600,7311360,1720800,14064640
.long 81920,102400,122880,143360,0,20480,40960,61440,204800,225280,163840,184320,266240,286720,307200,327680
.long 2211840,1966080,491520,737280,0,245760,1474560,1720320,983040,1228800,1769472,1572864,393216,589824,0,196608
.long 1179648,1376256,786432,983040,245760,2146435072,2146435072,6,10444800,13971200,13987840,14054912,13578240,7311360,1721440,14078976
.long 81920,102400,122880,143360,0,20480,40960,61440,204800,225280,163840,184320,266240,286720,307200,327680
.long 737280,491520,245760,0,1720320,1474560,1228800,983040,2211840,1966080,589824,393216,196608,0,1376256,1179648
.long 983040,786432,1769472,1572864,245760,14053376,13994496,10,10444800,13986560,13987840,14055936,12185600,10096640,2376160,14093312
.long 81920,102400,122880,143360,0,20480,40960,61440,204800,225280,163840,184320,266240,286720,307200,327680
.long 491520,737280,0,245760,1474560,1720320,983040,1228800,2211840,1966080,393216,589824,0,196608,1179648,1376256
.long 786432,983040,1769472,1572864,245760,14053376,13995520,14,10444800,13987584,13987840,14056960,13578240,10096640,2376800,14107648
.long 81920,102400,122880,143360,0,20480,40960,61440,204800,225280,163840,184320,286720,307200,327680,245760
.long 1474560,1720320,983040,1228800,491520,737280,0,245760,2211840,1966080,1179648,1376256,786432,983040,393216,589824
.long 0,196608,1769472,1572864,266240,13991936,13992704,3,0,13938688,13926400,13992704,11141120,2088960,491520,14064640
.long 81920,102400,122880,143360,0,20480,40960,61440,204800,225280,163840,184320,286720,307200,327680,245760
.long 1720320,1474560,1228800,983040,737280,491520,245760,0,2211840,1966080,1376256,1179648,983040,786432,589824,393216
.long 196608,0,1769472,1572864,266240,13991936,13993728,7,0,13939712,13926400,13993728,12533760,2088960,492160,14078976
.long 81920,102400,122880,143360,0,20480,40960,61440,204800,225280,163840,184320,286720,307200,327680,245760
.long 2211840,1966080,1474560,1720320,983040,1228800,491520,737280,0,245760,1769472,1572864,1179648,1376256,786432,983040
.long 393216,589824,0,196608,266240,2146435072,13994752,11,0,13955072,13926400,13994752,11141120,4874240,1146880,14093312
.long 81920,102400,122880,143360,0,20480,40960,61440,204800,225280,163840,184320,286720,307200,327680,245760
.long 2211840,1966080,1720320,1474560,1228800,983040,737280,491520,245760,0,1769472,1572864,1376256,1179648,983040,786432
.long 589824,393216,196608,0,266240,2146435072,13995776,15,0,13956096,13926400,13995776,12533760,4874240,1147520,14107648
.long 81920,102400,122880,143360,0,20480,40960,61440,204800,225280,163840,184320,286720,307200,327680,245760
.long 2211840,1966080,1474560,1720320,983040,1228800,491520,737280,0,245760,1769472,1572864,1179648,1376256,786432,983040
.long 393216,589824,0,196608,266240,2146435072,13992704,3,5570560,13971456,13959168,14025472,11141120,7659520,1802240,14064640
.long 81920,102400,122880,143360,0,20480,40960,61440,204800,225280,163840,184320,286720,307200,327680,245760
.long 2211840,1966080,1720320,1474560,1228800,983040,737280,491520,245760,0,1769472,1572864,1376256,1179648,983040,786432
.long 589824,393216,196608,0,266240,2146435072,13993728,7,5570560,13972480,13959168,14026496,12533760,7659520,1802880,14078976
.long 81920,102400,122880,143360,0,20480,40960,61440,204800,225280,163840,184320,286720,307200,327680,245760
.long 1474560,1720320,983040,1228800,491520,737280,0,245760,2211840,1966080,1179648,1376256,786432,983040,393216,589824
.long 0,196608,1769472,1572864,266240,14024704,13994752,11,5570560,13987840,13959168,14027520,11141120,10444800,2457600,14093312
.long 81920,102400,122880,143360,0,20480,40960,61440,204800,225280,163840,184320,286720,307200,327680,245760
.long 1720320,1474560,1228800,983040,737280,491520,245760,0,2211840,1966080,1376256,1179648,983040,786432,589824,393216
.long 196608,0,1769472,1572864,266240,14024704,13995776,15,5570560,13988864,13959168,14028544,12533760,10444800,2458240,14107648
.long 122880,143360,0,20480,40960,61440,81920,102400,225280,163840,184320,204800,307200,327680,245760,266240
.long 1720320,1474560,1228800,983040,737280,491520,245760,0,1966080,2211840,1376256,1179648,983040,786432,589824,393216
.long 196608,0,1572864,1769472,286720,13996032,13992704,3,696320,13938944,13930496,13996800,11489280,2088960,491680,14064640
.long 122880,143360,0,20480,40960,61440,81920,102400,225280,163840,184320,204800,307200,327680,245760,266240
.long 1474560,1720320,983040,1228800,491520,737280,0,245760,1966080,2211840,1179648,1376256,786432,983040,393216,589824
.long 0,196608,1572864,1769472,286720,13996032,13993728,7,696320,13939968,13930496,13997824,12881920,2088960,492320,14078976
.long 122880,143360,0,20480,40960,61440,81920,102400,225280,163840,184320,204800,307200,327680,245760,266240
.long 1966080,2211840,1720320,1474560,1228800,983040,737280,491520,245760,0,1572864,1769472,1376256,1179648,983040,786432
.long 589824,393216,196608,0,286720,2146435072,13994752,11,696320,13955328,13930496,13998848,11489280,4874240,1147040,14093312
.long 122880,143360,0,20480,40960,61440,81920,102400,225280,163840,184320,204800,307200,327680,245760,266240
.long 1966080,2211840,1474560,1720320,983040,1228800,491520,737280,0,245760,1572864,1769472,1179648,1376256,786432,983040
.long 393216,589824,0,196608,286720,2146435072,13995776,15,696320,13956352,13930496,13999872,12881920,4874240,1147680,14107648
.long 122880,143360,0,20480,40960,61440,81920,102400,225280,163840,184320,204800,307200,327680,245760,266240
.long 1966080,2211840,1720320,1474560,1228800,983040,737280,491520,245760,0,1572864,1769472,1376256,1179648,983040,786432
.long 589824,393216,196608,0,286720,2146435072,13992704,3,6266880,13971712,13963264,14029568,11489280,7659520,1802400,14064640
.long 122880,143360,0,20480,40960,61440,81920,102400,225280,163840,184320,204800,307200,327680,245760,266240
.long 1966080,2211840,1474560,1720320,983040,1228800,491520,737280,0,245760,1572864,1769472,1179648,1376256,786432,983040
.long 393216,589824,0,196608,286720,2146435072,13993728,7,6266880,13972736,13963264,14030592,12881920,7659520,1803040,14078976
.long 122880,143360,0,20480,40960,61440,81920,102400,225280,163840,184320,204800,307200,327680,245760,266240
.long 1720320,1474560,1228800,983040,737280,491520,245760,0,1966080,2211840,1376256,1179648,983040,786432,589824,393216
.long 196608,0,1572864,1769472,286720,14028800,13994752,11,6266880,13988096,13963264,14031616,11489280,10444800,2457760,14093312
.long 122880,143360,0,20480,40960,61440,81920,102400,225280,163840,184320,204800,307200,327680,245760,266240
.long 1474560,1720320,983040,1228800,491520,737280,0,245760,1966080,2211840,1179648,1376256,786432,983040,393216,589824
.long 0,196608,1572864,1769472,286720,14028800,13995776,15,6266880,13989120,13963264,14032640,12881920,10444800,2458400,14107648
.long 0,20480,40960,61440,81920,102400,122880,143360,163840,184320,204800,225280,327680,245760,266240,286720
.long 983040,1228800,1474560,1720320,0,245760,491520,737280,2211840,1966080,786432,983040,1179648,1376256,0,196608
.long 393216,589824,1769472,1572864,307200,14000128,13992704,3,1392640,13939200,13934592,14000896,11837440,2088960,491840,14064640
.long 0,20480,40960,61440,81920,102400,122880,143360,163840,184320,204800,225280,327680,245760,266240,286720
.long 1228800,983040,1720320,1474560,245760,0,737280,491520,2211840,1966080,983040,786432,1376256,1179648,196608,0
.long 589824,393216,1769472,1572864,307200,14000128,13993728,7,1392640,13940224,13934592,14001920,13230080,2088960,492480,14078976
.long 0,20480,40960,61440,81920,102400,122880,143360,163840,184320,204800,225280,327680,245760,266240,286720
.long 2211840,1966080,983040,1228800,1474560,1720320,0,245760,491520,737280,1769472,1572864,786432,983040,1179648,1376256
.long 0,196608,393216,589824,307200,2146435072,2146435072,11,1392640,13955584,13934592,14002944,11837440,4874240,1147200,14093312
.long 0,20480,40960,61440,81920,102400,122880,143360,163840,184320,204800,225280,327680,245760,266240,286720
.long 2211840,1966080,1228800,983040,1720320,1474560,245760,0,737280,491520,1769472,1572864,983040,786432,1376256,1179648
.long 196608,0,589824,393216,307200,2146435072,2146435072,15,1392640,13956608,13934592,14003968,13230080,4874240,1147840,14107648
.long 0,20480,40960,61440,81920,102400,122880,143360,163840,184320,204800,225280,327680,245760,266240,286720
.long 2211840,1966080,983040,1228800,1474560,1720320,0,245760,491520,737280,1769472,1572864,786432,983040,1179648,1376256
.long 0,196608,393216,589824,307200,2146435072,2146435072,3,6963200,13971968,13967360,14033664,11837440,7659520,1802560,14064640
.long 0,20480,40960,61440,81920,102400,122880,143360,163840,184320,204800,225280,327680,245760,266240,286720
.long 2211840,1966080,1228800,983040,1720320,1474560,245760,0,737280,491520,1769472,1572864,983040,786432,1376256,1179648
.long 196608,0,589824,393216,307200,2146435072,2146435072,7,6963200,13972992,13967360,14034688,13230080,7659520,1803200,14078976
.long 0,20480,40960,61440,81920,102400,122880,143360,163840,184320,204800,225280,327680,245760,266240,286720
.long 983040,1228800,1474560,1720320,0,245760,491520,737280,2211840,1966080,786432,983040,1179648,1376256,0,196608
.long 393216,589824,1769472,1572864,307200,14032896,13994752,11,6963200,13988352,13967360,14035712,11837440,10444800,2457920,14093312
.long 0,20480,40960,61440,81920,102400,122880,143360,163840,184320,204800,225280,327680,245760,266240,286720
.long 1228800,983040,1720320,1474560,245760,0,737280,491520,2211840,1966080,983040,786432,1376256,1179648,196608,0
.long 589824,393216,1769472,1572864,307200,14032896,13995776,15,6963200,13989376,13967360,14036736,13230080,10444800,2458560,14107648
.long 40960,61440,81920,102400,122880,143360,0,20480,184320,204800,225280,163840,245760,266240,286720,307200
.long 1228800,983040,1720320,1474560,245760,0,737280,491520,1966080,2211840,983040,786432,1376256,1179648,196608,0
.long 589824,393216,1572864,1769472,327680,14004224,13992704,3,2088960,13939456,13938688,14004992,12185600,2088960,492000,14064640
.long 40960,61440,81920,102400,122880,143360,0,20480,184320,204800,225280,163840,245760,266240,286720,307200
.long 983040,1228800,1474560,1720320,0,245760,491520,737280,1966080,2211840,786432,983040,1179648,1376256,0,196608
.long 393216,589824,1572864,1769472,327680,14004224,13993728,7,2088960,13940480,13938688,14006016,13578240,2088960,492640,14078976
.long 40960,61440,81920,102400,122880,143360,0,20480,184320,204800,225280,163840,245760,266240,286720,307200
.long 1966080,2211840,1228800,983040,1720320,1474560,245760,0,737280,491520,1572864,1769472,983040,786432,1376256,1179648
.long 196608,0,589824,393216,327680,2146435072,2146435072,11,2088960,13955840,13938688,14007040,12185600,4874240,1147360,14093312
.long 40960,61440,81920,102400,122880,143360,0,20480,184320,204800,225280,163840,245760,266240,286720,307200
.long 1966080,2211840,983040,1228800,1474560,1720320,0,245760,491520,737280,1572864,1769472,786432,983040,1179648,1376256
.long 0,196608,393216,589824,327680,2146435072,2146435072,15,2088960,13956864,13938688,14008064,13578240,4874240,1148000,14107648
.long 40960,61440,81920,102400,122880,143360,0,20480,184320,204800,225280,163840,245760,266240,286720,307200
.long 1966080,2211840,1228800,983040,1720320,1474560,245760,0,737280,491520,1572864,1769472,983040,786432,1376256,1179648
.long 196608,0,589824,393216,327680,2146435072,2146435072,3,7659520,13972224,13971456,14037760,12185600,7659520,1802720,14064640
.long 40960,61440,81920,102400,122880,143360,0,20480,184320,204800,225280,163840,245760,266240,286720,307200
.long 1966080,2211840,983040,1228800,1474560,1720320,0,245760,491520,737280,1572864,1769472,786432,983040,1179648,1376256
.long 0,196608,393216,589824,327680,2146435072,2146435072,7,7659520,13973248,13971456,14038784,13578240,7659520,1803360,14078976
.long 40960,61440,81920,102400,122880,143360,0,20480,184320,204800,225280,163840,245760,266240,286720,307200
.long 1228800,983040,1720320,1474560,245760,0,737280,491520,1966080,2211840,983040,786432,1376256,1179648,196608,0
.long 589824,393216,1572864,1769472,327680,14036992,13994752,11,7659520,13988608,13971456,14039808,12185600,10444800,2458080,14093312
.long 40960,61440,81920,102400,122880,143360,0,20480,184320,204800,225280,163840,245760,266240,286720,307200
.long 983040,1228800,1474560,1720320,0,245760,491520,737280,1966080,2211840,786432,983040,1179648,1376256,0,196608
.long 393216,589824,1572864,1769472,327680,14036992,13995776,15,7659520,13989632,13971456,14040832,13578240,10444800,2458720,14107648
.long 122880,143360,0,20480,40960,61440,81920,102400,225280,163840,184320,204800,307200,327680,245760,266240
.long 491520,737280,0,245760,1474560,1720320,983040,1228800,2211840,1966080,393216,589824,0,196608,1179648,1376256
.long 786432,983040,1769472,1572864,286720,14008320,13992704,3,2785280,13940736,13942784,14009088,11141120,2437120,573440,14064640
.long 122880,143360,0,20480,40960,61440,81920,102400,225280,163840,184320,204800,307200,327680,245760,266240
.long 737280,491520,245760,0,1720320,1474560,1228800,983040,2211840,1966080,589824,393216,196608,0,1376256,1179648
.long 983040,786432,1769472,1572864,286720,14008320,13993728,7,2785280,13941760,13942784,14010112,12533760,2437120,574080,14078976
.long 122880,143360,0,20480,40960,61440,81920,102400,225280,163840,184320,204800,307200,327680,245760,266240
.long 2211840,1966080,491520,737280,0,245760,1474560,1720320,983040,1228800,1769472,1572864,393216,589824,0,196608
.long 1179648,1376256,786432,983040,286720,2146435072,2146435072,11,2785280,13957120,13942784,14011136,11141120,5222400,1228800,14093312
.long 122880,143360,0,20480,40960,61440,81920,102400,225280,163840,184320,204800,307200,327680,245760,266240
.long 2211840,1966080,737280,491520,245760,0,1720320,1474560,1228800,983040,1769472,1572864,589824,393216,196608,0
.long 1376256,1179648,983040,786432,286720,2146435072,2146435072,15,2785280,13958144,13942784,14012160,12533760,5222400,1229440,14107648
.long 122880,143360,0,20480,40960,61440,81920,102400,225280,163840,184320,204800,307200,327680,245760,266240
.long 2211840,1966080,491520,737280,0,245760,1474560,1720320,983040,1228800,1769472,1572864,393216,589824,0,196608
.long 1179648,1376256,786432,983040,286720,2146435072,2146435072,3,8355840,13973504,13975552,14041856,11141120,8007680,1884160,14064640
.long 122880,143360,0,20480,40960,61440,81920,102400,225280,163840,184320,204800,307200,327680,245760,266240
.long 2211840,1966080,737280,491520,245760,0,1720320,1474560,1228800,983040,1769472,1572864,589824,393216,196608,0
.long 1376256,1179648,983040,786432,286720,2146435072,2146435072,7,8355840,13974528,13975552,14042880,12533760,8007680,1884800,14078976
.long 122880,143360,0,20480,40960,61440,81920,102400,225280,163840,184320,204800,307200,327680,245760,266240
.long 491520,737280,0,245760,1474560,1720320,983040,1228800,2211840,1966080,393216,589824,0,196608,1179648,1376256
.long 786432,983040,1769472,1572864,286720,14041088,13994752,11,8355840,13989888,13975552,14043904,11141120,10792960,2539520,14093312
.long 122880,143360,0,20480,40960,61440,81920,102400,225280,163840,184320,204800,307200,327680,245760,266240
.long 737280,491520,245760,0,1720320,1474560,1228800,983040,2211840,1966080,589824,393216,196608,0,1376256,1179648
.long 983040,786432,1769472,1572864,286720,14041088,13995776,15,8355840,13990912,13975552,14044928,12533760,10792960,2540160,14107648
.long 0,20480,40960,61440,81920,102400,122880,143360,163840,184320,204800,225280,327680,245760,266240,286720
.long 737280,491520,245760,0,1720320,1474560,1228800,983040,1966080,2211840,589824,393216,196608,0,1376256,1179648
.long 983040,786432,1572864,1769472,307200,14012416,13992704,3,3481600,13940992,13946880,14013184,11489280,2437120,573600,14064640
.long 0,20480,40960,61440,81920,102400,122880,143360,163840,184320,204800,225280,327680,245760,266240,286720
.long 491520,737280,0,245760,1474560,1720320,983040,1228800,1966080,2211840,393216,589824,0,196608,1179648,1376256
.long 786432,983040,1572864,1769472,307200,14012416,13993728,7,3481600,13942016,13946880,14014208,12881920,2437120,574240,14078976
.long 0,20480,40960,61440,81920,102400,122880,143360,163840,184320,204800,225280,327680,245760,266240,286720
.long 1966080,2211840,737280,491520,245760,0,1720320,1474560,1228800,983040,1572864,1769472,589824,393216,196608,0
.long 1376256,1179648,983040,786432,307200,2146435072,2146435072,11,3481600,13957376,13946880,14015232,11489280,5222400,1228960,14093312
.long 0,20480,40960,61440,81920,102400,122880,143360,163840,184320,204800,225280,327680,245760,266240,286720
.long 1966080,2211840,491520,737280,0,245760,1474560,1720320,983040,1228800,1572864,1769472,393216,589824,0,196608
.long 1179648,1376256,786432,983040,307200,2146435072,2146435072,15,3481600,13958400,13946880,14016256,12881920,5222400,1229600,14107648
.long 0,20480,40960,61440,81920,102400,122880,143360,163840,184320,204800,225280,327680,245760,266240,286720
.long 1966080,2211840,737280,491520,245760,0,1720320,1474560,1228800,983040,1572864,1769472,589824,393216,196608,0
.long 1376256,1179648,983040,786432,307200,2146435072,2146435072,3,9052160,13973760,13979648,14045952,11489280,8007680,1884320,14064640
.long 0,20480,40960,61440,81920,102400,122880,143360,163840,184320,204800,225280,327680,245760,266240,286720
.long 1966080,2211840,491520,737280,0,245760,1474560,1720320,983040,1228800,1572864,1769472,393216,589824,0,196608
.long 1179648,1376256,786432,983040,307200,2146435072,2146435072,7,9052160,13974784,13979648,14046976,12881920,8007680,1884960,14078976
.long 0,20480,40960,61440,81920,102400,122880,143360,163840,184320,204800,225280,327680,245760,266240,286720
.long 737280,491520,245760,0,1720320,1474560,1228800,983040,1966080,2211840,589824,393216,196608,0,1376256,1179648
.long 983040,786432,1572864,1769472,307200,14045184,13994752,11,9052160,13990144,13979648,14048000,11489280,10792960,2539680,14093312
.long 0,20480,40960,61440,81920,102400,122880,143360,163840,184320,204800,225280,327680,245760,266240,286720
.long 491520,737280,0,245760,1474560,1720320,983040,1228800,1966080,2211840,393216,589824,0,196608,1179648,1376256
.long 786432,983040,1572864,1769472,307200,14045184,13995776,15,9052160,13991168,13979648,14049024,12881920,10792960,2540320,14107648
.long 40960,61440,81920,102400,122880,143360,0,20480,184320,204800,225280,163840,245760,266240,286720,307200
.long 0,245760,491520,737280,983040,1228800,1474560,1720320,2211840,1966080,0,196608,393216,589824,786432,983040
.long 1179648,1376256,1769472,1572864,327680,14016512,13992704,3,4177920,13941248,13950976,14017280,11837440,2437120,573760,14064640
.long 40960,61440,81920,102400,122880,143360,0,20480,184320,204800,225280,163840,245760,266240,286720,307200
.long 245760,0,737280,491520,1228800,983040,1720320,1474560,2211840,1966080,196608,0,589824,393216,983040,786432
.long 1376256,1179648,1769472,1572864,327680,14016512,13993728,7,4177920,13942272,13950976,14018304,13230080,2437120,574400,14078976
.long 40960,61440,81920,102400,122880,143360,0,20480,184320,204800,225280,163840,245760,266240,286720,307200
.long 2211840,1966080,0,245760,491520,737280,983040,1228800,1474560,1720320,1769472,1572864,0,196608,393216,589824
.long 786432,983040,1179648,1376256,327680,2146435072,2146435072,11,4177920,13957632,13950976,14019328,11837440,5222400,1229120,14093312
.long 40960,61440,81920,102400,122880,143360,0,20480,184320,204800,225280,163840,245760,266240,286720,307200
.long 2211840,1966080,245760,0,737280,491520,1228800,983040,1720320,1474560,1769472,1572864,196608,0,589824,393216
.long 983040,786432,1376256,1179648,327680,2146435072,2146435072,15,4177920,13958656,13950976,14020352,13230080,5222400,1229760,14107648
.long 40960,61440,81920,102400,122880,143360,0,20480,184320,204800,225280,163840,245760,266240,286720,307200
.long 2211840,1966080,0,245760,491520,737280,983040,1228800,1474560,1720320,1769472,1572864,0,196608,393216,589824
.long 786432,983040,1179648,1376256,327680,2146435072,2146435072,3,9748480,13974016,13983744,14050048,11837440,8007680,1884480,14064640
.long 40960,61440,81920,102400,122880,143360,0,20480,184320,204800,225280,163840,245760,266240,286720,307200
.long 2211840,1966080,245760,0,737280,491520,1228800,983040,1720320,1474560,1769472,1572864,196608,0,589824,393216
.long 983040,786432,1376256,1179648,327680,2146435072,2146435072,7,9748480,13975040,13983744,14051072,13230080,8007680,1885120,14078976
.long 40960,61440,81920,102400,122880,143360,0,20480,184320,204800,225280,163840,245760,266240,286720,307200
.long 0,245760,491520,737280,983040,1228800,1474560,1720320,2211840,1966080,0,196608,393216,589824,786432,983040
.long 1179648,1376256,1769472,1572864,327680,14049280,13994752,11,9748480,13990400,13983744,14052096,11837440,10792960,2539840,14093312
.long 40960,61440,81920,102400,122880,143360,0,20480,184320,204800,225280,163840,245760,266240,286720,307200
.long 245760,0,737280,491520,1228800,983040,1720320,1474560,2211840,1966080,196608,0,589824,393216,983040,786432
.long 1376256,1179648,1769472,1572864,327680,14049280,13995776,15,9748480,13991424,13983744,14053120,13230080,10792960,2540480,14107648
.long 81920,102400,122880,143360,0,20480,40960,61440,204800,225280,163840,184320,266240,286720,307200,327680
.long 245760,0,737280,491520,1228800,983040,1720320,1474560,1966080,2211840,196608,0,589824,393216,983040,786432
.long 1376256,1179648,1572864,1769472,245760,14020608,13992704,3,4874240,13941504,13955072,14021376,12185600,2437120,573920,14064640
.long 81920,102400,122880,143360,0,20480,40960,61440,204800,225280,163840,184320,266240,286720,307200,327680
.long 0,245760,491520,737280,983040,1228800,1474560,1720320,1966080,2211840,0,196608,393216,589824,786432,983040
.long 1179648,1376256,1572864,1769472,245760,14020608,13993728,7,4874240,13942528,13955072,14022400,13578240,2437120,574560,14078976
.long 81920,102400,122880,143360,0,20480,40960,61440,204800,225280,163840,184320,266240,286720,307200,327680
.long 1966080,2211840,245760,0,737280,491520,1228800,983040,1720320,1474560,1572864,1769472,196608,0,589824,393216
.long 983040,786432,1376256,1179648,245760,2146435072,2146435072,11,4874240,13957888,13955072,14023424,12185600,5222400,1229280,14093312
.long 81920,102400,122880,143360,0,20480,40960,61440,204800,225280,163840,184320,266240,286720,307200,327680
.long 1966080,2211840,0,245760,491520,737280,983040,1228800,1474560,1720320,1572864,1769472,0,196608,393216,589824
.long 786432,983040,1179648,1376256,245760,2146435072,2146435072,15,4874240,13958912,13955072,14024448,13578240,5222400,1229920,14107648
.long 81920,102400,122880,143360,0,20480,40960,61440,204800,225280,163840,184320,266240,286720,307200,327680
.long 1966080,2211840,245760,0,737280,491520,1228800,983040,1720320,1474560,1572864,1769472,196608,0,589824,393216
.long 983040,786432,1376256,1179648,245760,2146435072,2146435072,3,10444800,13974272,13987840,14054144,12185600,8007680,1884640,14064640
.long 81920,102400,122880,143360,0,20480,40960,61440,204800,225280,163840,184320,266240,286720,307200,327680
.long 1966080,2211840,0,245760,491520,737280,983040,1228800,1474560,1720320,1572864,1769472,0,196608,393216,589824
.long 786432,983040,1179648,1376256,245760,2146435072,2146435072,7,10444800,13975296,13987840,14055168,13578240,8007680,1885280,14078976
.long 81920,102400,122880,143360,0,20480,40960,61440,204800,225280,163840,184320,266240,286720,307200,327680
.long 245760,0,737280,491520,1228800,983040,1720320,1474560,1966080,2211840,196608,0,589824,393216,983040,786432
.long 1376256,1179648,1572864,1769472,245760,14053376,13994752,11,10444800,13990656,13987840,14056192,12185600,10792960,2540000,14093312
.long 81920,102400,122880,143360,0,20480,40960,61440,204800,225280,163840,184320,266240,286720,307200,327680
.long 0,245760,491520,737280,983040,1228800,1474560,1720320,1966080,2211840,0,196608,393216,589824,786432,983040
.long 1179648,1376256,1572864,1769472,245760,14053376,13995776,15,10444800,13991680,13987840,14057216,13578240,10792960,2540640,14107648
.size STAB, .-STAB
.type RTAB,@object
RTAB:
.long 0,0,9216,18432,11141120,11142144,11143168,11144192,40960,0,9216,18432,11146240,11147264,11148288,11149312
.long 81920,0,9216,18432,11151360,11152384,11153408,11154432,122880,0,9216,18432,11156480,11157504,11158528,11159552
.long 163840,0,9216,18432,11161600,11162624,11163648,11164672,204800,0,9216,18432,11166720,11167744,11168768,11169792
.long 245760,0,9216,18432,11171840,11172864,11173888,11174912,286720,0,9216,18432,11176960,11177984,11179008,11180032
.long 327680,0,9216,18432,11182080,11183104,11184128,11185152,368640,0,9216,18432,11187200,11188224,11189248,11190272
.long 409600,0,9216,18432,11192320,11193344,11194368,11195392,450560,0,9216,18432,11197440,11198464,11199488,11200512
.long 491520,0,9216,18432,11202560,11203584,11204608,11205632,532480,0,9216,18432,11207680,11208704,11209728,11210752
.long 573440,0,9216,18432,11212800,11213824,11214848,11215872,614400,0,9216,18432,11217920,11218944,11219968,11220992
.long 655360,0,9216,18432,11223040,11224064,11225088,11226112,696320,0,9216,18432,11228160,11229184,11230208,11231232
.long 737280,0,9216,18432,11233280,11234304,11235328,11236352,778240,0,9216,18432,11238400,11239424,11240448,11241472
.long 819200,0,9216,18432,11243520,11244544,11245568,11246592,860160,0,9216,18432,11248640,11249664,11250688,11251712
.long 901120,0,9216,18432,11253760,11254784,11255808,11256832,942080,0,9216,18432,11258880,11259904,11260928,11261952
.long 983040,0,9216,18432,11264000,11265024,11266048,11267072,1024000,0,9216,18432,11269120,11270144,11271168,11272192
.long 1064960,0,9216,18432,11274240,11275264,11276288,11277312,1105920,0,9216,18432,11279360,11280384,11281408,11282432
.long 1146880,0,9216,18432,11284480,11285504,11286528,11287552,1187840,0,9216,18432,11289600,11290624,11291648,11292672
.long 1228800,0,9216,18432,11294720,11295744,11296768,11297792,1269760,0,9216,18432,11299840,11300864,11301888,11302912
.long 1310720,0,9216,18432,11304960,11305984,11307008,11308032,1351680,0,9216,18432,11310080,11311104,11312128,11313152
.long 1392640,0,9216,18432,11315200,11316224,11317248,11318272,1433600,0,9216,18432,11320320,11321344,11322368,11323392
.long 1474560,0,9216,18432,11325440,11326464,11327488,11328512,1515520,0,9216,18432,11330560,11331584,11332608,11333632
.long 1556480,0,9216,18432,11335680,11336704,11337728,11338752,1597440,0,9216,18432,11340800,11341824,11342848,11343872
.long 1638400,0,9216,18432,11345920,11346944,11347968,11348992,1679360,0,9216,18432,11351040,11352064,11353088,11354112
.long 1720320,0,9216,18432,11356160,11357184,11358208,11359232,1761280,0,9216,18432,11361280,11362304,11363328,11364352
.long 1802240,0,9216,18432,11366400,11367424,11368448,11369472,1843200,0,9216,18432,11371520,11372544,11373568,11374592
.long 1884160,0,9216,18432,11376640,11377664,11378688,11379712,1925120,0,9216,18432,11381760,11382784,11383808,11384832
.long 1,0,9216,23552,11386880,11387904,11388928,11389952,51201,0,9216,23552,11392000,11393024,11394048,11395072
.long 102401,0,9216,23552,11397120,11398144,11399168,11400192,153601,0,9216,23552,11402240,11403264,11404288,11405312
.long 204801,0,9216,23552,11407360,11408384,11409408,11410432,256001,0,9216,23552,11412480,11413504,11414528,11415552
.long 307201,0,9216,23552,11417600,11418624,11419648,11420672,358401,0,9216,23552,11422720,11423744,11424768,11425792
.long 409601,0,9216,23552,11427840,11428864,11429888,11430912,460801,0,9216,23552,11432960,11433984,11435008,11436032
.long 512001,0,9216,23552,11438080,11439104,11440128,11441152,563201,0,9216,23552,11443200,11444224,11445248,11446272
.long 614401,0,9216,23552,11448320,11449344,11450368,11451392,665601,0,9216,23552,11453440,11454464,11455488,11456512
.long 716801,0,9216,23552,11458560,11459584,11460608,11461632,768001,0,9216,23552,11463680,11464704,11465728,11466752
.long 20481,46080,24576,100352,11468800,11469824,11470848,11471872,225281,46080,24576,100352,11473920,11474944,11475968,11476992
.long 430081,46080,24576,100352,11479040,11480064,11481088,11482112,634881,46080,24576,100352,11484160,11485184,11486208,11487232
.long 128,0,9216,18432,11145216,11489280,11490304,11491328,41088,0,9216,18432,11150336,11494400,11495424,11496448
.long 82048,0,9216,18432,11155456,11499520,11500544,11501568,123008,0,9216,18432,11160576,11504640,11505664,11506688
.long 163968,0,9216,18432,11165696,11509760,11510784,11511808,204928,0,9216,18432,11170816,11514880,11515904,11516928
.long 245888,0,9216,18432,11175936,11520000,11521024,11522048,286848,0,9216,18432,11181056,11525120,11526144,11527168
.long 327808,0,9216,18432,11186176,11530240,11531264,11532288,368768,0,9216,18432,11191296,11535360,11536384,11537408
.long 409728,0,9216,18432,11196416,11540480,11541504,11542528,450688,0,9216,18432,11201536,11545600,11546624,11547648
.long 491648,0,9216,18432,11206656,11550720,11551744,11552768,532608,0,9216,18432,11211776,11555840,11556864,11557888
.long 573568,0,9216,18432,11216896,11560960,11561984,11563008,614528,0,9216,18432,11222016,11566080,11567104,11568128
.long 655488,0,9216,18432,11227136,11571200,11572224,11573248,696448,0,9216,18432,11232256,11576320,11577344,11578368
.long 737408,0,9216,18432,11237376,11581440,11582464,11583488,778368,0,9216,18432,11242496,11586560,11587584,11588608
.long 819328,0,9216,18432,11247616,11591680,11592704,11593728,860288,0,9216,18432,11252736,11596800,11597824,11598848
.long 901248,0,9216,18432,11257856,11601920,11602944,11603968,942208,0,9216,18432,11262976,11607040,11608064,11609088
.long 983168,0,9216,18432,11268096,11612160,11613184,11614208,1024128,0,9216,18432,11273216,11617280,11618304,11619328
.long 1065088,0,9216,18432,11278336,11622400,11623424,11624448,1106048,0,9216,18432,11283456,11627520,11628544,11629568
.long 1147008,0,9216,18432,11288576,11632640,11633664,11634688,1187968,0,9216,18432,11293696,11637760,11638784,11639808
.long 1228928,0,9216,18432,11298816,11642880,11643904,11644928,1269888,0,9216,18432,11303936,11648000,11649024,11650048
.long 1310848,0,9216,18432,11309056,11653120,11654144,11655168,1351808,0,9216,18432,11314176,11658240,11659264,11660288
.long 1392768,0,9216,18432,11319296,11663360,11664384,11665408,1433728,0,9216,18432,11324416,11668480,11669504,11670528
.long 1474688,0,9216,18432,11329536,11673600,11674624,11675648,1515648,0,9216,18432,11334656,11678720,11679744,11680768
.long 1556608,0,9216,18432,11339776,11683840,11684864,11685888,1597568,0,9216,18432,11344896,11688960,11689984,11691008
.long 1638528,0,9216,18432,11350016,11694080,11695104,11696128,1679488,0,9216,18432,11355136,11699200,11700224,11701248
.long 1720448,0,9216,18432,11360256,11704320,11705344,11706368,1761408,0,9216,18432,11365376,11709440,11710464,11711488
.long 1802368,0,9216,18432,11370496,11714560,11715584,11716608,1843328,0,9216,18432,11375616,11719680,11720704,11721728
.long 1884288,0,9216,18432,11380736,11724800,11725824,11726848,1925248,0,9216,18432,11385856,11729920,11730944,11731968
.long 129,0,9216,23552,11390976,11735040,11736064,11737088,51329,0,9216,23552,11396096,11740160,11741184,11742208
.long 102529,0,9216,23552,11401216,11745280,11746304,11747328,153729,0,9216,23552,11406336,11750400,11751424,11752448
.long 204929,0,9216,23552,11411456,11755520,11756544,11757568,256129,0,9216,23552,11416576,11760640,11761664,11762688
.long 307329,0,9216,23552,11421696,11765760,11766784,11767808,358529,0,9216,23552,11426816,11770880,11771904,11772928
.long 409729,0,9216,23552,11431936,11776000,11777024,11778048,460929,0,9216,23552,11437056,11781120,11782144,11783168
.long 512129,0,9216,23552,11442176,11786240,11787264,11788288,563329,0,9216,23552,11447296,11791360,11792384,11793408
.long 614529,0,9216,23552,11452416,11796480,11797504,11798528,665729,0,9216,23552,11457536,11801600,11802624,11803648
.long 716929,0,9216,23552,11462656,11806720,11807744,11808768,768129,0,9216,23552,11467776,11811840,11812864,11813888
.long 20609,46080,24576,100352,11472896,11816960,11817984,11819008,225409,46080,24576,100352,11478016,11822080,11823104,11824128
.long 430209,46080,24576,100352,11483136,11827200,11828224,11829248,635009,46080,24576,100352,11488256,11832320,11833344,11834368
.long 256,0,9216,18432,11492352,11493376,11837440,11838464,41216,0,9216,18432,11497472,11498496,11842560,11843584
.long 82176,0,9216,18432,11502592,11503616,11847680,11848704,123136,0,9216,18432,11507712,11508736,11852800,11853824
.long 164096,0,9216,18432,11512832,11513856,11857920,11858944,205056,0,9216,18432,11517952,11518976,11863040,11864064
.long 246016,0,9216,18432,11523072,11524096,11868160,11869184,286976,0,9216,18432,11528192,11529216,11873280,11874304
.long 327936,0,9216,18432,11533312,11534336,11878400,11879424,368896,0,9216,18432,11538432,11539456,11883520,11884544
.long 409856,0,9216,18432,11543552,11544576,11888640,11889664,450816,0,9216,18432,11548672,11549696,11893760,11894784
.long 491776,0,9216,18432,11553792,11554816,11898880,11899904,532736,0,9216,18432,11558912,11559936,11904000,11905024
.long 573696,0,9216,18432,11564032,11565056,11909120,11910144,614656,0,9216,18432,11569152,11570176,11914240,11915264
.long 655616,0,9216,18432,11574272,11575296,11919360,11920384,696576,0,9216,18432,11579392,11580416,11924480,11925504
.long 737536,0,9216,18432,11584512,11585536,11929600,11930624,778496,0,9216,18432,11589632,11590656,11934720,11935744
.long 819456,0,9216,18432,11594752,11595776,11939840,11940864,860416,0,9216,18432,11599872,11600896,11944960,11945984
.long 901376,0,9216,18432,11604992,11606016,11950080,11951104,942336,0,9216,18432,11610112,11611136,11955200,11956224
.long 983296,0,9216,18432,11615232,11616256,11960320,11961344,1024256,0,9216,18432,11620352,11621376,11965440,11966464
.long 1065216,0,9216,18432,11625472,11626496,11970560,11971584,1106176,0,9216,18432,11630592,11631616,11975680,11976704
.long 1147136,0,9216,18432,11635712,11636736,11980800,11981824,1188096,0,9216,18432,11640832,11641856,11985920,11986944
.long 1229056,0,9216,18432,11645952,11646976,11991040,11992064,1270016,0,9216,18432,11651072,11652096,11996160,11997184
.long 1310976,0,9216,18432,11656192,11657216,12001280,12002304,1351936,0,9216,18432,11661312,11662336,12006400,12007424
.long 1392896,0,9216,18432,11666432,11667456,12011520,12012544,1433856,0,9216,18432,11671552,11672576,12016640,12017664
.long 1474816,0,9216,18432,11676672,11677696,12021760,12022784,1515776,0,9216,18432,11681792,11682816,12026880,12027904
.long 1556736,0,9216,18432,11686912,11687936,12032000,12033024,1597696,0,9216,18432,11692032,11693056,12037120,12038144
.long 1638656,0,9216,18432,11697152,11698176,12042240,12043264,1679616,0,9216,18432,11702272,11703296,12047360,12048384
.long 1720576,0,9216,18432,11707392,11708416,12052480,12053504,1761536,0,9216,18432,11712512,11713536,12057600,12058624
.long 1802496,0,9216,18432,11717632,11718656,12062720,12063744,1843456,0,9216,18432,11722752,11723776,12067840,12068864
.long 1884416,0,9216,18432,11727872,11728896,12072960,12073984,1925376,0,9216,18432,11732992,11734016,12078080,12079104
.long 257,0,9216,23552,11738112,11739136,12083200,12084224,51457,0,9216,23552,11743232,11744256,12088320,12089344
.long 102657,0,9216,23552,11748352,11749376,12093440,12094464,153857,0,9216,23552,11753472,11754496,12098560,12099584
.long 205057,0,9216,23552,11758592,11759616,12103680,12104704,256257,0,9216,23552,11763712,11764736,12108800,12109824
.long 307457,0,9216,23552,11768832,11769856,12113920,12114944,358657,0,9216,23552,11773952,11774976,12119040,12120064
.long 409857,0,9216,23552,11779072,11780096,12124160,12125184,461057,0,9216,23552,11784192,11785216,12129280,12130304
.long 512257,0,9216,23552,11789312,11790336,12134400,12135424,563457,0,9216,23552,11794432,11795456,12139520,12140544
.long 614657,0,9216,23552,11799552,11800576,12144640,12145664,665857,0,9216,23552,11804672,11805696,12149760,12150784
.long 717057,0,9216,23552,11809792,11810816,12154880,12155904,768257,0,9216,23552,11814912,11815936,12160000,12161024
.long 20737,46080,24576,100352,11820032,11821056,12165120,12166144,225537,46080,24576,100352,11825152,11826176,12170240,12171264
.long 430337,46080,24576,100352,11830272,11831296,12175360,12176384,635137,46080,24576,100352,11835392,11836416,12180480,12181504
.long 384,0,9216,18432,11839488,11840512,11841536,12185600,41344,0,9216,18432,11844608,11845632,11846656,12190720
.long 82304,0,9216,18432,11849728,11850752,11851776,12195840,123264,0,9216,18432,11854848,11855872,11856896,12200960
.long 164224,0,9216,18432,11859968,11860992,11862016,12206080,205184,0,9216,18432,11865088,11866112,11867136,12211200
.long 246144,0,9216,18432,11870208,11871232,11872256,12216320,287104,0,9216,18432,11875328,11876352,11877376,12221440
.long 328064,0,9216,18432,11880448,11881472,11882496,12226560,369024,0,9216,18432,11885568,11886592,11887616,12231680
.long 409984,0,9216,18432,11890688,11891712,11892736,12236800,450944,0,9216,18432,11895808,11896832,11897856,12241920
.long 491904,0,9216,18432,11900928,11901952,11902976,12247040,532864,0,9216,18432,11906048,11907072,11908096,12252160
.long 573824,0,9216,18432,11911168,11912192,11913216,12257280,614784,0,9216,18432,11916288,11917312,11918336,12262400
.long 655744,0,9216,18432,11921408,11922432,11923456,12267520,696704,0,9216,18432,11926528,11927552,11928576,12272640
.long 737664,0,9216,18432,11931648,11932672,11933696,12277760,778624,0,9216,18432,11936768,11937792,11938816,12282880
.long 819584,0,9216,18432,11941888,11942912,11943936,12288000,860544,0,9216,18432,11947008,11948032,11949056,12293120
.long 901504,0,9216,18432,11952128,11953152,11954176,12298240,942464,0,9216,18432,11957248,11958272,11959296,12303360
.long 983424,0,9216,18432,11962368,11963392,11964416,12308480,1024384,0,9216,18432,11967488,11968512,11969536,12313600
.long 1065344,0,9216,18432,11972608,11973632,11974656,12318720,1106304,0,9216,18432,11977728,11978752,11979776,12323840
.long 1147264,0,9216,18432,11982848,11983872,11984896,12328960,1188224,0,9216,18432,11987968,11988992,11990016,12334080
.long 1229184,0,9216,18432,11993088,11994112,11995136,12339200,1270144,0,9216,18432,11998208,11999232,12000256,12344320
.long 1311104,0,9216,18432,12003328,12004352,12005376,12349440,1352064,0,9216,18432,12008448,12009472,12010496,12354560
.long 1393024,0,9216,18432,12013568,12014592,12015616,12359680,1433984,0,9216,18432,12018688,12019712,12020736,12364800
.long 1474944,0,9216,18432,12023808,12024832,12025856,12369920,1515904,0,9216,18432,12028928,12029952,12030976,12375040
.long 1556864,0,9216,18432,12034048,12035072,12036096,12380160,1597824,0,9216,18432,12039168,12040192,12041216,12385280
.long 1638784,0,9216,18432,12044288,12045312,12046336,12390400,1679744,0,9216,18432,12049408,12050432,12051456,12395520
.long 1720704,0,9216,18432,12054528,12055552,12056576,12400640,1761664,0,9216,18432,12059648,12060672,12061696,12405760
.long 1802624,0,9216,18432,12064768,12065792,12066816,12410880,1843584,0,9216,18432,12069888,12070912,12071936,12416000
.long 1884544,0,9216,18432,12075008,12076032,12077056,12421120,1925504,0,9216,18432,12080128,12081152,12082176,12426240
.long 385,0,9216,23552,12085248,12086272,12087296,12431360,51585,0,9216,23552,12090368,12091392,12092416,12436480
.long 102785,0,9216,23552,12095488,12096512,12097536,12441600,153985,0,9216,23552,12100608,12101632,12102656,12446720
.long 205185,0,9216,23552,12105728,12106752,12107776,12451840,256385,0,9216,23552,12110848,12111872,12112896,12456960
.long 307585,0,9216,23552,12115968,12116992,12118016,12462080,358785,0,9216,23552,12121088,12122112,12123136,12467200
.long 409985,0,9216,23552,12126208,12127232,12128256,12472320,461185,0,9216,23552,12131328,12132352,12133376,12477440
.long 512385,0,9216,23552,12136448,12137472,12138496,12482560,563585,0,9216,23552,12141568,12142592,12143616,12487680
.long 614785,0,9216,23552,12146688,12147712,12148736,12492800,665985,0,9216,23552,12151808,12152832,12153856,12497920
.long 717185,0,9216,23552,12156928,12157952,12158976,12503040,768385,0,9216,23552,12162048,12163072,12164096,12508160
.long 20865,46080,24576,100352,12167168,12168192,12169216,12513280,225665,46080,24576,100352,12172288,12173312,12174336,12518400
.long 430465,46080,24576,100352,12177408,12178432,12179456,12523520,635265,46080,24576,100352,12182528,12183552,12184576,12528640
.long 512,0,9216,18432,12186624,12187648,12188672,12189696,41472,0,9216,18432,12191744,12192768,12193792,12194816
.long 82432,0,9216,18432,12196864,12197888,12198912,12199936,123392,0,9216,18432,12201984,12203008,12204032,12205056
.long 164352,0,9216,18432,12207104,12208128,12209152,12210176,205312,0,9216,18432,12212224,12213248,12214272,12215296
.long 246272,0,9216,18432,12217344,12218368,12219392,12220416,287232,0,9216,18432,12222464,12223488,12224512,12225536
.long 328192,0,9216,18432,12227584,12228608,12229632,12230656,369152,0,9216,18432,12232704,12233728,12234752,12235776
.long 410112,0,9216,18432,12237824,12238848,12239872,12240896,451072,0,9216,18432,12242944,12243968,12244992,12246016
.long 492032,0,9216,18432,12248064,12249088,12250112,12251136,532992,0,9216,18432,12253184,12254208,12255232,12256256
.long 573952,0,9216,18432,12258304,12259328,12260352,12261376,614912,0,9216,18432,12263424,12264448,12265472,12266496
.long 655872,0,9216,18432,12268544,12269568,12270592,12271616,696832,0,9216,18432,12273664,12274688,12275712,12276736
.long 737792,0,9216,18432,12278784,12279808,12280832,12281856,778752,0,9216,18432,12283904,12284928,12285952,12286976
.long 819712,0,9216,18432,12289024,12290048,12291072,12292096,860672,0,9216,18432,12294144,12295168,12296192,12297216
.long 901632,0,9216,18432,12299264,12300288,12301312,12302336,942592,0,9216,18432,12304384,12305408,12306432,12307456
.long 983552,0,9216,18432,12309504,12310528,12311552,12312576,1024512,0,9216,18432,12314624,12315648,12316672,12317696
.long 1065472,0,9216,18432,12319744,12320768,12321792,12322816,1106432,0,9216,18432,12324864,12325888,12326912,12327936
.long 1147392,0,9216,18432,12329984,12331008,12332032,12333056,1188352,0,9216,18432,12335104,12336128,12337152,12338176
.long 1229312,0,9216,18432,12340224,12341248,12342272,12343296,1270272,0,9216,18432,12345344,12346368,12347392,12348416
.long 1311232,0,9216,18432,12350464,12351488,12352512,12353536,1352192,0,9216,18432,12355584,12356608,12357632,12358656
.long 1393152,0,9216,18432,12360704,12361728,12362752,12363776,1434112,0,9216,18432,12365824,12366848,12367872,12368896
.long 1475072,0,9216,18432,12370944,12371968,12372992,12374016,1516032,0,9216,18432,12376064,12377088,12378112,12379136
.long 1556992,0,9216,18432,12381184,12382208,12383232,12384256,1597952,0,9216,18432,12386304,12387328,12388352,12389376
.long 1638912,0,9216,18432,12391424,12392448,12393472,12394496,1679872,0,9216,18432,12396544,12397568,12398592,12399616
.long 1720832,0,9216,18432,12401664,12402688,12403712,12404736,1761792,0,9216,18432,12406784,12407808,12408832,12409856
.long 1802752,0,9216,18432,12411904,12412928,12413952,12414976,1843712,0,9216,18432,12417024,12418048,12419072,12420096
.long 1884672,0,9216,18432,12422144,12423168,12424192,12425216,1925632,0,9216,18432,12427264,12428288,12429312,12430336
.long 513,0,9216,23552,12432384,12433408,12434432,12435456,51713,0,9216,23552,12437504,12438528,12439552,12440576
.long 102913,0,9216,23552,12442624,12443648,12444672,12445696,154113,0,9216,23552,12447744,12448768,12449792,12450816
.long 205313,0,9216,23552,12452864,12453888,12454912,12455936,256513,0,9216,23552,12457984,12459008,12460032,12461056
.long 307713,0,9216,23552,12463104,12464128,12465152,12466176,358913,0,9216,23552,12468224,12469248,12470272,12471296
.long 410113,0,9216,23552,12473344,12474368,12475392,12476416,461313,0,9216,23552,12478464,12479488,12480512,12481536
.long 512513,0,9216,23552,12483584,12484608,12485632,12486656,563713,0,9216,23552,12488704,12489728,12490752,12491776
.long 614913,0,9216,23552,12493824,12494848,12495872,12496896,666113,0,9216,23552,12498944,12499968,12500992,12502016
.long 717313,0,9216,23552,12504064,12505088,12506112,12507136,768513,0,9216,23552,12509184,12510208,12511232,12512256
.long 20993,46080,24576,100352,12514304,12515328,12516352,12517376,225793,46080,24576,100352,12519424,12520448,12521472,12522496
.long 430593,46080,24576,100352,12524544,12525568,12526592,12527616,635393,46080,24576,100352,12529664,12530688,12531712,12532736
.long 640,0,9216,18432,12533760,12534784,12535808,12536832,41600,0,9216,18432,12538880,12539904,12540928,12541952
.long 82560,0,9216,18432,12544000,12545024,12546048,12547072,123520,0,9216,18432,12549120,12550144,12551168,12552192
.long 164480,0,9216,18432,12554240,12555264,12556288,12557312,205440,0,9216,18432,12559360,12560384,12561408,12562432
.long 246400,0,9216,18432,12564480,12565504,12566528,12567552,287360,0,9216,18432,12569600,12570624,12571648,12572672
.long 328320,0,9216,18432,12574720,12575744,12576768,12577792,369280,0,9216,18432,12579840,12580864,12581888,12582912
.long 410240,0,9216,18432,12584960,12585984,12587008,12588032,451200,0,9216,18432,12590080,12591104,12592128,12593152
.long 492160,0,9216,18432,12595200,12596224,12597248,12598272,533120,0,9216,18432,12600320,12601344,12602368,12603392
.long 574080,0,9216,18432,12605440,12606464,12607488,12608512,615040,0,9216,18432,12610560,12611584,12612608,12613632
.long 656000,0,9216,18432,12615680,12616704,12617728,12618752,696960,0,9216,18432,12620800,12621824,12622848,12623872
.long 737920,0,9216,18432,12625920,12626944,12627968,12628992,778880,0,9216,18432,12631040,12632064,12633088,12634112
.long 819840,0,9216,18432,12636160,12637184,12638208,12639232,860800,0,9216,18432,12641280,12642304,12643328,12644352
.long 901760,0,9216,18432,12646400,12647424,12648448,12649472,942720,0,9216,18432,12651520,12652544,12653568,12654592
.long 983680,0,9216,18432,12656640,12657664,12658688,12659712,1024640,0,9216,18432,12661760,12662784,12663808,12664832
.long 1065600,0,9216,18432,12666880,12667904,12668928,12669952,1106560,0,9216,18432,12672000,12673024,12674048,12675072
.long 1147520,0,9216,18432,12677120,12678144,12679168,12680192,1188480,0,9216,18432,12682240,12683264,12684288,12685312
.long 1229440,0,9216,18432,12687360,12688384,12689408,12690432,1270400,0,9216,18432,12692480,12693504,12694528,12695552
.long 1311360,0,9216,18432,12697600,12698624,12699648,12700672,1352320,0,9216,18432,12702720,12703744,12704768,12705792
.long 1393280,0,9216,18432,12707840,12708864,12709888,12710912,1434240,0,9216,18432,12712960,12713984,12715008,12716032
.long 1475200,0,9216,18432,12718080,12719104,12720128,12721152,1516160,0,9216,18432,12723200,12724224,12725248,12726272
.long 1557120,0,9216,18432,12728320,12729344,12730368,12731392,1598080,0,9216,18432,12733440,12734464,12735488,12736512
.long 1639040,0,9216,18432,12738560,12739584,12740608,12741632,1680000,0,9216,18432,12743680,12744704,12745728,12746752
.long 1720960,0,9216,18432,12748800,12749824,12750848,12751872,1761920,0,9216,18432,12753920,12754944,12755968,12756992
.long 1802880,0,9216,18432,12759040,12760064,12761088,12762112,1843840,0,9216,18432,12764160,12765184,12766208,12767232
.long 1884800,0,9216,18432,12769280,12770304,12771328,12772352,1925760,0,9216,18432,12774400,12775424,12776448,12777472
.long 641,0,9216,23552,12779520,12780544,12781568,12782592,51841,0,9216,23552,12784640,12785664,12786688,12787712
.long 103041,0,9216,23552,12789760,12790784,12791808,12792832,154241,0,9216,23552,12794880,12795904,12796928,12797952
.long 205441,0,9216,23552,12800000,12801024,12802048,12803072,256641,0,9216,23552,12805120,12806144,12807168,12808192
.long 307841,0,9216,23552,12810240,12811264,12812288,12813312,359041,0,9216,23552,12815360,12816384,12817408,12818432
.long 410241,0,9216,23552,12820480,12821504,12822528,12823552,461441,0,9216,23552,12825600,12826624,12827648,12828672
.long 512641,0,9216,23552,12830720,12831744,12832768,12833792,563841,0,9216,23552,12835840,12836864,12837888,12838912
.long 615041,0,9216,23552,12840960,12841984,12843008,12844032,666241,0,9216,23552,12846080,12847104,12848128,12849152
.long 717441,0,9216,23552,12851200,12852224,12853248,12854272,768641,0,9216,23552,12856320,12857344,12858368,12859392
.long 21121,46080,24576,100352,12861440,12862464,12863488,12864512,225921,46080,24576,100352,12866560,12867584,12868608,12869632
.long 430721,46080,24576,100352,12871680,12872704,12873728,12874752,635521,46080,24576,100352,12876800,12877824,12878848,12879872
.long 768,0,9216,18432,12537856,12881920,12882944,12883968,41728,0,9216,18432,12542976,12887040,12888064,12889088
.long 82688,0,9216,18432,12548096,12892160,12893184,12894208,123648,0,9216,18432,12553216,12897280,12898304,12899328
.long 164608,0,9216,18432,12558336,12902400,12903424,12904448,205568,0,9216,18432,12563456,12907520,12908544,12909568
.long 246528,0,9216,18432,12568576,12912640,12913664,12914688,287488,0,9216,18432,12573696,12917760,12918784,12919808
.long 328448,0,9216,18432,12578816,12922880,12923904,12924928,369408,0,9216,18432,12583936,12928000,12929024,12930048
.long 410368,0,9216,18432,12589056,12933120,12934144,12935168,451328,0,9216,18432,12594176,12938240,12939264,12940288
.long 492288,0,9216,18432,12599296,12943360,12944384,12945408,533248,0,9216,18432,12604416,12948480,12949504,12950528
.long 574208,0,9216,18432,12609536,12953600,12954624,12955648,615168,0,9216,18432,12614656,12958720,12959744,12960768
.long 656128,0,9216,18432,12619776,12963840,12964864,12965888,697088,0,9216,18432,12624896,12968960,12969984,12971008
.long 738048,0,9216,18432,12630016,12974080,12975104,12976128,779008,0,9216,18432,12635136,12979200,12980224,12981248
.long 819968,0,9216,18432,12640256,12984320,12985344,12986368,860928,0,9216,18432,12645376,12989440,12990464,12991488
.long 901888,0,9216,18432,12650496,12994560,12995584,12996608,942848,0,9216,18432,12655616,12999680,13000704,13001728
.long 983808,0,9216,18432,12660736,13004800,13005824,13006848,1024768,0,9216,18432,12665856,13009920,13010944,13011968
.long 1065728,0,9216,18432,12670976,13015040,13016064,13017088,1106688,0,9216,18432,12676096,13020160,13021184,13022208
.long 1147648,0,9216,18432,12681216,13025280,13026304,13027328,1188608,0,9216,18432,12686336,13030400,13031424,13032448
.long 1229568,0,9216,18432,12691456,13035520,13036544,13037568,1270528,0,9216,18432,12696576,13040640,13041664,13042688
.long 1311488,0,9216,18432,12701696,13045760,13046784,13047808,1352448,0,9216,18432,12706816,13050880,13051904,13052928
.long 1393408,0,9216,18432,12711936,13056000,13057024,13058048,1434368,0,9216,18432,12717056,13061120,13062144,13063168
.long 1475328,0,9216,18432,12722176,13066240,13067264,13068288,1516288,0,9216,18432,12727296,13071360,13072384,13073408
.long 1557248,0,9216,18432,12732416,13076480,13077504,13078528,1598208,0,9216,18432,12737536,13081600,13082624,13083648
.long 1639168,0,9216,18432,12742656,13086720,13087744,13088768,1680128,0,9216,18432,12747776,13091840,13092864,13093888
.long 1721088,0,9216,18432,12752896,13096960,13097984,13099008,1762048,0,9216,18432,12758016,13102080,13103104,13104128
.long 1803008,0,9216,18432,12763136,13107200,13108224,13109248,1843968,0,9216,18432,12768256,13112320,13113344,13114368
.long 1884928,0,9216,18432,12773376,13117440,13118464,13119488,1925888,0,9216,18432,12778496,13122560,13123584,13124608
.long 769,0,9216,23552,12783616,13127680,13128704,13129728,51969,0,9216,23552,12788736,13132800,13133824,13134848
.long 103169,0,9216,23552,12793856,13137920,13138944,13139968,154369,0,9216,23552,12798976,13143040,13144064,13145088
.long 205569,0,9216,23552,12804096,13148160,13149184,13150208,256769,0,9216,23552,12809216,13153280,13154304,13155328
.long 307969,0,9216,23552,12814336,13158400,13159424,13160448,359169,0,9216,23552,12819456,13163520,13164544,13165568
.long 410369,0,9216,23552,12824576,13168640,13169664,13170688,461569,0,9216,23552,12829696,13173760,13174784,13175808
.long 512769,0,9216,23552,12834816,13178880,13179904,13180928,563969,0,9216,23552,12839936,13184000,13185024,13186048
.long 615169,0,9216,23552,12845056,13189120,13190144,13191168,666369,0,9216,23552,12850176,13194240,13195264,13196288
.long 717569,0,9216,23552,12855296,13199360,13200384,13201408,768769,0,9216,23552,12860416,13204480,13205504,13206528
.long 21249,46080,24576,100352,12865536,13209600,13210624,13211648,226049,46080,24576,100352,12870656,13214720,13215744,13216768
.long 430849,46080,24576,100352,12875776,13219840,13220864,13221888,635649,46080,24576,100352,12880896,13224960,13225984,13227008
.long 896,0,9216,18432,12884992,12886016,13230080,13231104,41856,0,9216,18432,12890112,12891136,13235200,13236224
.long 82816,0,9216,18432,12895232,12896256,13240320,13241344,123776,0,9216,18432,12900352,12901376,13245440,13246464
.long 164736,0,9216,18432,12905472,12906496,13250560,13251584,205696,0,9216,18432,12910592,12911616,13255680,13256704
.long 246656,0,9216,18432,12915712,12916736,13260800,13261824,287616,0,9216,18432,12920832,12921856,13265920,13266944
.long 328576,0,9216,18432,12925952,12926976,13271040,13272064,369536,0,9216,18432,12931072,12932096,13276160,13277184
.long 410496,0,9216,18432,12936192,12937216,13281280,13282304,451456,0,9216,18432,12941312,12942336,13286400,13287424
.long 492416,0,9216,18432,12946432,12947456,13291520,13292544,533376,0,9216,18432,12951552,12952576,13296640,13297664
.long 574336,0,9216,18432,12956672,12957696,13301760,13302784,615296,0,9216,18432,12961792,12962816,13306880,13307904
.long 656256,0,9216,18432,12966912,12967936,13312000,13313024,697216,0,9216,18432,12972032,12973056,13317120,13318144
.long 738176,0,9216,18432,12977152,12978176,13322240,13323264,779136,0,9216,18432,12982272,12983296,13327360,13328384
.long 820096,0,9216,18432,12987392,12988416,13332480,13333504,861056,0,9216,18432,12992512,12993536,13337600,13338624
.long 902016,0,9216,18432,12997632,12998656,13342720,13343744,942976,0,9216,18432,13002752,13003776,13347840,13348864
.long 983936,0,9216,18432,13007872,13008896,13352960,13353984,1024896,0,9216,18432,13012992,13014016,13358080,13359104
.long 1065856,0,9216,18432,13018112,13019136,13363200,13364224,1106816,0,9216,18432,13023232,13024256,13368320,13369344
.long 1147776,0,9216,18432,13028352,13029376,13373440,13374464,1188736,0,9216,18432,13033472,13034496,13378560,13379584
.long 1229696,0,9216,18432,13038592,13039616,13383680,13384704,1270656,0,9216,18432,13043712,13044736,13388800,13389824
.long 1311616,0,9216,18432,13048832,13049856,13393920,13394944,1352576,0,9216,18432,13053952,13054976,13399040,13400064
.long 1393536,0,9216,18432,13059072,13060096,13404160,13405184,1434496,0,9216,18432,13064192,13065216,13409280,13410304
.long 1475456,0,9216,18432,13069312,13070336,13414400,13415424,1516416,0,9216,18432,13074432,13075456,13419520,13420544
.long 1557376,0,9216,18432,13079552,13080576,13424640,13425664,1598336,0,9216,18432,13084672,13085696,13429760,13430784
.long 1639296,0,9216,18432,13089792,13090816,13434880,13435904,1680256,0,9216,18432,13094912,13095936,13440000,13441024
.long 1721216,0,9216,18432,13100032,13101056,13445120,13446144,1762176,0,9216,18432,13105152,13106176,13450240,13451264
.long 1803136,0,9216,18432,13110272,13111296,13455360,13456384,1844096,0,9216,18432,13115392,13116416,13460480,13461504
.long 1885056,0,9216,18432,13120512,13121536,13465600,13466624,1926016,0,9216,18432,13125632,13126656,13470720,13471744
.long 897,0,9216,23552,13130752,13131776,13475840,13476864,52097,0,9216,23552,13135872,13136896,13480960,13481984
.long 103297,0,9216,23552,13140992,13142016,13486080,13487104,154497,0,9216,23552,13146112,13147136,13491200,13492224
.long 205697,0,9216,23552,13151232,13152256,13496320,13497344,256897,0,9216,23552,13156352,13157376,13501440,13502464
.long 308097,0,9216,23552,13161472,13162496,13506560,13507584,359297,0,9216,23552,13166592,13167616,13511680,13512704
.long 410497,0,9216,23552,13171712,13172736,13516800,13517824,461697,0,9216,23552,13176832,13177856,13521920,13522944
.long 512897,0,9216,23552,13181952,13182976,13527040,13528064,564097,0,9216,23552,13187072,13188096,13532160,13533184
.long 615297,0,9216,23552,13192192,13193216,13537280,13538304,666497,0,9216,23552,13197312,13198336,13542400,13543424
.long 717697,0,9216,23552,13202432,13203456,13547520,13548544,768897,0,9216,23552,13207552,13208576,13552640,13553664
.long 21377,46080,24576,100352,13212672,13213696,13557760,13558784,226177,46080,24576,100352,13217792,13218816,13562880,13563904
.long 430977,46080,24576,100352,13222912,13223936,13568000,13569024,635777,46080,24576,100352,13228032,13229056,13573120,13574144
.long 1024,0,9216,18432,13232128,13233152,13234176,13578240,41984,0,9216,18432,13237248,13238272,13239296,13583360
.long 82944,0,9216,18432,13242368,13243392,13244416,13588480,123904,0,9216,18432,13247488,13248512,13249536,13593600
.long 164864,0,9216,18432,13252608,13253632,13254656,13598720,205824,0,9216,18432,13257728,13258752,13259776,13603840
.long 246784,0,9216,18432,13262848,13263872,13264896,13608960,287744,0,9216,18432,13267968,13268992,13270016,13614080
.long 328704,0,9216,18432,13273088,13274112,13275136,13619200,369664,0,9216,18432,13278208,13279232,13280256,13624320
.long 410624,0,9216,18432,13283328,13284352,13285376,13629440,451584,0,9216,18432,13288448,13289472,13290496,13634560
.long 492544,0,9216,18432,13293568,13294592,13295616,13639680,533504,0,9216,18432,13298688,13299712,13300736,13644800
.long 574464,0,9216,18432,13303808,13304832,13305856,13649920,615424,0,9216,18432,13308928,13309952,13310976,13655040
.long 656384,0,9216,18432,13314048,13315072,13316096,13660160,697344,0,9216,18432,13319168,13320192,13321216,13665280
.long 738304,0,9216,18432,13324288,13325312,13326336,13670400,779264,0,9216,18432,13329408,13330432,13331456,13675520
.long 820224,0,9216,18432,13334528,13335552,13336576,13680640,861184,0,9216,18432,13339648,13340672,13341696,13685760
.long 902144,0,9216,18432,13344768,13345792,13346816,13690880,943104,0,9216,18432,13349888,13350912,13351936,13696000
.long 984064,0,9216,18432,13355008,13356032,13357056,13701120,1025024,0,9216,18432,13360128,13361152,13362176,13706240
.long 1065984,0,9216,18432,13365248,13366272,13367296,13711360,1106944,0,9216,18432,13370368,13371392,13372416,13716480
.long 1147904,0,9216,18432,13375488,13376512,13377536,13721600,1188864,0,9216,18432,13380608,13381632,13382656,13726720
.long 1229824,0,9216,18432,13385728,13386752,13387776,13731840,1270784,0,9216,18432,13390848,13391872,13392896,13736960
.long 1311744,0,9216,18432,13395968,13396992,13398016,13742080,1352704,0,9216,18432,13401088,13402112,13403136,13747200
.long 1393664,0,9216,18432,13406208,13407232,13408256,13752320,1434624,0,9216,18432,13411328,13412352,13413376,13757440
.long 1475584,0,9216,18432,13416448,13417472,13418496,13762560,1516544,0,9216,18432,13421568,13422592,13423616,13767680
.long 1557504,0,9216,18432,13426688,13427712,13428736,13772800,1598464,0,9216,18432,13431808,13432832,13433856,13777920
.long 1639424,0,9216,18432,13436928,13437952,13438976,13783040,1680384,0,9216,18432,13442048,13443072,13444096,13788160
.long 1721344,0,9216,18432,13447168,13448192,13449216,13793280,1762304,0,9216,18432,13452288,13453312,13454336,13798400
.long 1803264,0,9216,18432,13457408,13458432,13459456,13803520,1844224,0,9216,18432,13462528,13463552,13464576,13808640
.long 1885184,0,9216,18432,13467648,13468672,13469696,13813760,1926144,0,9216,18432,13472768,13473792,13474816,13818880
.long 1025,0,9216,23552,13477888,13478912,13479936,13824000,52225,0,9216,23552,13483008,13484032,13485056,13829120
.long 103425,0,9216,23552,13488128,13489152,13490176,13834240,154625,0,9216,23552,13493248,13494272,13495296,13839360
.long 205825,0,9216,23552,13498368,13499392,13500416,13844480,257025,0,9216,23552,13503488,13504512,13505536,13849600
.long 308225,0,9216,23552,13508608,13509632,13510656,13854720,359425,0,9216,23552,13513728,13514752,13515776,13859840
.long 410625,0,9216,23552,13518848,13519872,13520896,13864960,461825,0,9216,23552,13523968,13524992,13526016,13870080
.long 513025,0,9216,23552,13529088,13530112,13531136,13875200,564225,0,9216,23552,13534208,13535232,13536256,13880320
.long 615425,0,9216,23552,13539328,13540352,13541376,13885440,666625,0,9216,23552,13544448,13545472,13546496,13890560
.long 717825,0,9216,23552,13549568,13550592,13551616,13895680,769025,0,9216,23552,13554688,13555712,13556736,13900800
.long 21505,46080,24576,100352,13559808,13560832,13561856,13905920,226305,46080,24576,100352,13564928,13565952,13566976,13911040
.long 431105,46080,24576,100352,13570048,13571072,13572096,13916160,635905,46080,24576,100352,13575168,13576192,13577216,13921280
.long 1152,0,9216,18432,13579264,13580288,13581312,13582336,42112,0,9216,18432,13584384,13585408,13586432,13587456
.long 83072,0,9216,18432,13589504,13590528,13591552,13592576,124032,0,9216,18432,13594624,13595648,13596672,13597696
.long 164992,0,9216,18432,13599744,13600768,13601792,13602816,205952,0,9216,18432,13604864,13605888,13606912,13607936
.long 246912,0,9216,18432,13609984,13611008,13612032,13613056,287872,0,9216,18432,13615104,13616128,13617152,13618176
.long 328832,0,9216,18432,13620224,13621248,13622272,13623296,369792,0,9216,18432,13625344,13626368,13627392,13628416
.long 410752,0,9216,18432,13630464,13631488,13632512,13633536,451712,0,9216,18432,13635584,13636608,13637632,13638656
.long 492672,0,9216,18432,13640704,13641728,13642752,13643776,533632,0,9216,18432,13645824,13646848,13647872,13648896
.long 574592,0,9216,18432,13650944,13651968,13652992,13654016,615552,0,9216,18432,13656064,13657088,13658112,13659136
.long 656512,0,9216,18432,13661184,13662208,13663232,13664256,697472,0,9216,18432,13666304,13667328,13668352,13669376
.long 738432,0,9216,18432,13671424,13672448,13673472,13674496,779392,0,9216,18432,13676544,13677568,13678592,13679616
.long 820352,0,9216,18432,13681664,13682688,13683712,13684736,861312,0,9216,18432,13686784,13687808,13688832,13689856
.long 902272,0,9216,18432,13691904,13692928,13693952,13694976,943232,0,9216,18432,13697024,13698048,13699072,13700096
.long 984192,0,9216,18432,13702144,13703168,13704192,13705216,1025152,0,9216,18432,13707264,13708288,13709312,13710336
.long 1066112,0,9216,18432,13712384,13713408,13714432,13715456,1107072,0,9216,18432,13717504,13718528,13719552,13720576
.long 1148032,0,9216,18432,13722624,13723648,13724672,13725696,1188992,0,9216,18432,13727744,13728768,13729792,13730816
.long 1229952,0,9216,18432,13732864,13733888,13734912,13735936,1270912,0,9216,18432,13737984,13739008,13740032,13741056
.long 1311872,0,9216,18432,13743104,13744128,13745152,13746176,1352832,0,9216,18432,13748224,13749248,13750272,13751296
.long 1393792,0,9216,18432,13753344,13754368,13755392,13756416,1434752,0,9216,18432,13758464,13759488,13760512,13761536
.long 1475712,0,9216,18432,13763584,13764608,13765632,13766656,1516672,0,9216,18432,13768704,13769728,13770752,13771776
.long 1557632,0,9216,18432,13773824,13774848,13775872,13776896,1598592,0,9216,18432,13778944,13779968,13780992,13782016
.long 1639552,0,9216,18432,13784064,13785088,13786112,13787136,1680512,0,9216,18432,13789184,13790208,13791232,13792256
.long 1721472,0,9216,18432,13794304,13795328,13796352,13797376,1762432,0,9216,18432,13799424,13800448,13801472,13802496
.long 1803392,0,9216,18432,13804544,13805568,13806592,13807616,1844352,0,9216,18432,13809664,13810688,13811712,13812736
.long 1885312,0,9216,18432,13814784,13815808,13816832,13817856,1926272,0,9216,18432,13819904,13820928,13821952,13822976
.long 1153,0,9216,23552,13825024,13826048,13827072,13828096,52353,0,9216,23552,13830144,13831168,13832192,13833216
.long 103553,0,9216,23552,13835264,13836288,13837312,13838336,154753,0,9216,23552,13840384,13841408,13842432,13843456
.long 205953,0,9216,23552,13845504,13846528,13847552,13848576,257153,0,9216,23552,13850624,13851648,13852672,13853696
.long 308353,0,9216,23552,13855744,13856768,13857792,13858816,359553,0,9216,23552,13860864,13861888,13862912,13863936
.long 410753,0,9216,23552,13865984,13867008,13868032,13869056,461953,0,9216,23552,13871104,13872128,13873152,13874176
.long 513153,0,9216,23552,13876224,13877248,13878272,13879296,564353,0,9216,23552,13881344,13882368,13883392,13884416
.long 615553,0,9216,23552,13886464,13887488,13888512,13889536,666753,0,9216,23552,13891584,13892608,13893632,13894656
.long 717953,0,9216,23552,13896704,13897728,13898752,13899776,769153,0,9216,23552,13901824,13902848,13903872,13904896
.long 21633,46080,24576,100352,13906944,13907968,13908992,13910016,226433,46080,24576,100352,13912064,13913088,13914112,13915136
.long 431233,46080,24576,100352,13917184,13918208,13919232,13920256,636033,46080,24576,100352,13922304,13923328,13924352,13925376
.long 2146435072,0,9216,18432,2146435072,2146435072,2146435072,2146435072
.size RTAB, .-RTAB
.globl parallel_sum__linear_attn_block__glu_gated_bilinear__prompt_kernel
.p2align 8
.type parallel_sum__linear_attn_block__glu_gated_bilinear__prompt_kernel,@function
parallel_sum__linear_attn_block__glu_gated_bilinear__prompt_kernel:
    s_cmp_ge_u32 s2, 256
    s_cbranch_scc1 DONE
    s_load_dwordx4 s[28:31], s[0:1], 0
    s_load_dwordx2 s[48:49], s[0:1], 16
    s_load_dwordx8 s[36:43], s[0:1], 32
    s_load_dwordx4 s[44:47], s[0:1], 64
    s_getpc_b64 s[98:99]
PCREF:
    s_sub_u32 s98, s98, PCREF - LTAB
    s_subb_u32 s99, s99, 0
    v_lshrrev_b32 v200, 6, v0
    v_and_b32 v0, 63, v0
    v_readfirstlane_b32 s3, v200
    s_bfe_u32 s6, s2, 0x10006
    s_mul_i32 s4, s6, 8192
    s_add_u32 s4, s4, 2048
    v_lshlrev_b32 v200, 4, v0
    v_add_u32 v200, s4, v200
    global_load_dwordx4 v[164:167], v200, s[98:99] offset:-2048
    global_load_dwordx4 v[168:171], v200, s[98:99] offset:-1024
    global_load_dwordx4 v[172:175], v200, s[98:99] offset:0
    global_load_dwordx4 v[176:179], v200, s[98:99] offset:1024
    global_load_dwordx4 v[180:183], v200, s[98:99] offset:2048
    s_lshr_b32 s4, s2, 3
    s_lshl_b32 s4, s4, 11
    s_lshl_b32 s5, s3, 9
    s_add_u32 s4, s4, s5
    s_min_u32 s4, s4, CODE_END - PCREF - 512
    s_add_u32 s4, s4, PCREF - LTAB
    v_and_b32 v201, 3, v0
    v_lshlrev_b32 v201, 7, v201
    v_add_u32 v201, s4, v201
    global_load_dword v204, v201, s[98:99]
    s_mul_i32 s4, s2, 192
    s_add_u32 s4, s4, STAB - LTAB
    s_add_u32 s100, s98, s4
    s_addc_u32 s101, s99, 0
    s_lshl_b32 s4, s2, 2
    s_add_u32 s4, s4, s3
    s_min_u32 s4, s4, 680
    s_lshl_b32 s4, s4, 5
    s_add_u32 s4, s4, RTAB - LTAB
    s_add_u32 s24, s98, s4
    s_addc_u32 s25, s99, 0
    s_bfe_u32 s7, s2, 0x30003
    s_and_b32 s4, s2, 4
    s_lshl_b32 s4, s4, 1
    s_add_u32 s4, s4, s7
    s_lshr_b32 s98, s2, 6
    s_and_b32 s97, s2, 3
    s_lshl_b32 s97, s97, 2
    s_add_u32 s97, s97, s98
    s_lshr_b32 s96, s97, 1
    s_xor_b32 s99, s7, s98
    s_and_b32 s99, s99, 1
    s_add_u32 s99, s99, 8
    s_lshl_b32 s98, s98, 1
    s_xor_b32 s5, s7, s98
    s_and_b32 s98, s2, 1
    s_xor_b32 s5, s5, s98
    s_lshr_b32 s98, s2, 1
    s_xor_b32 s98, s98, s2
    s_bitcmp1_b32 s98, 1
    s_cselect_b32 s5, s99, s5
    s_lshl_b32 s61, s5, 7
    s_mul_i32 s62, s5, 245760
    s_mul_i32 s63, s5, 196608
    s_mul_i32 s60, s3, 40960
    s_mul_i32 s7, s4, 163840
    s_add_u32 s7, s7, s60
    v_lshrrev_b32 v200, 3, v0
    v_and_b32 v201, 7, v0
    v_lshrrev_b32 v202, 1, v200
    v_xor_b32 v202, v202, v201
    v_lshlrev_b32 v202, 4, v202
    v_mul_u32_u24 v203, 1280, v200
    v_add3_u32 v160, v202, v203, s7
    v_xor_b32 v161, 64, v160
    v_add_u32 v161, 9216, v161
    v_add_u32 v162, 18432, v160
    v_add_u32 v163, 18432, v161
    s_add_u32 s7, s96, 16
    s_lshl_b32 s98, s96, 1
    s_cmp_eq_u32 s6, 1
    s_cselect_b32 s7, s98, s7
    s_lshl_b32 s7, s7, 7
    s_mul_i32 s98, s3, 49152
    s_add_u32 s7, s7, s98
    s_add_u32 s7, s7, 4096
    v_lshlrev_b32 v202, 1, v200
    v_and_b32 v202, 4, v202
    v_xor_b32 v202, v202, v201
    v_lshlrev_b32 v202, 4, v202
    v_mul_u32_u24 v203, 3072, v200
    v_add3_u32 v7, v202, v203, s7
    v_add_u32 v8, 23552, v7
    s_mul_i32 s97, s3, 61440
    s_mul_i32 s99, s96, 160
    s_add_u32 s97, s97, s99
    s_add_u32 s97, s97, 4096
    v_mov_b32 v192, 0
    v_mov_b32 v193, 0
    v_mov_b32 v194, 0
    v_mov_b32 v195, 0
    s_cmp_eq_u32 s6, 1
    s_cbranch_scc1 BHEAD
    s_waitcnt lgkmcnt(0)
    s_load_dwordx16 s[8:23], s[100:101], 0
    s_load_dwordx16 s[64:79], s[100:101], 64
    s_load_dwordx16 s[80:95], s[100:101], 128
    s_load_dwordx8 s[52:59], s[24:25], 0
    s_sub_u32 s32, s30, 4096
    s_subb_u32 s33, s31, 0
    s_and_b32 s29, s29, 0xffff
    s_mov_b32 s30, 2621440
    s_mov_b32 s31, 0x20000
    s_mov_b32 s24, s44
    s_and_b32 s25, s45, 0xffff
    s_mov_b32 s26, 256
    s_mov_b32 s27, 0x20000
    s_mov_b32 s44, s46
    s_and_b32 s45, s47, 0xffff
    s_mov_b32 s46, 14155776
    s_mov_b32 s47, 0x20000
    s_cmp_lg_u32 s4, 0
    s_cbranch_scc1 NOZERO
    s_lshl_b32 s7, s96, 2
    s_add_u32 s7, s7, s3
    s_mul_i32 s98, s7, 3072
    s_add_u32 s98, s98, 14057472
    s_lshl_b32 s7, s7, 12
    s_add_u32 s7, s7, 13926400
    v_lshlrev_b32 v200, 4, v0
    v_lshlrev_b32 v201, 8, v0
    buffer_store_dwordx4 v[192:195], v200, s[44:47], s98 offen offset:0 sc1
    buffer_store_dwordx4 v[192:195], v200, s[44:47], s98 offen offset:1024 sc1
    buffer_store_dwordx4 v[192:195], v200, s[44:47], s98 offen offset:2048 sc1
    s_mov_b64 exec, 0xffff
    buffer_store_dwordx4 v[192:195], v201, s[44:47], s7 offen sc1
    s_mov_b64 exec, -1
NOZERO:
    s_add_u32 m0, s60, 32768
    s_nop 0
    buffer_load_dwordx4 v160, s[28:31], s61 offen offset:0  lds
    buffer_load_dwordx4 v161, s[28:31], s61 offen offset:1024  lds
    buffer_load_dwordx4 v162, s[28:31], s61 offen offset:2048  lds
    buffer_load_dwordx4 v163, s[28:31], s61 offen offset:3072  lds
    s_movk_i32 s7, 3277
    s_add_u32 s97, s97, 1280
    v_add_u32 v200, 0, v0
    v_mul_u32_u24 v201, s7, v200
    v_lshrrev_b32 v201, 16, v201
    v_mul_u32_u24 v202, 20, v201
    v_sub_u32 v200, v200, v202
    v_mul_u32_u24 v201, 3840, v201
    v_cmp_lt_u32 vcc, 9, v200
    v_lshlrev_b32 v200, 4, v200
    v_add3_u32 v200, v200, v201, s97
    v_add_u32 v201, 1120, v200
    v_cndmask_b32 v200, v200, v201, vcc
    v_subrev_u32 v2, 0, v200
    v_add_u32 v200, 64, v0
    v_mul_u32_u24 v201, s7, v200
    v_lshrrev_b32 v201, 16, v201
    v_mul_u32_u24 v202, 20, v201
    v_sub_u32 v200, v200, v202
    v_mul_u32_u24 v201, 3840, v201
    v_cmp_lt_u32 vcc, 9, v200
    v_lshlrev_b32 v200, 4, v200
    v_add3_u32 v200, v200, v201, s97
    v_add_u32 v201, 1120, v200
    v_cndmask_b32 v200, v200, v201, vcc
    v_subrev_u32 v3, 1024, v200
    v_add_u32 v200, 128, v0
    v_mul_u32_u24 v201, s7, v200
    v_lshrrev_b32 v201, 16, v201
    v_mul_u32_u24 v202, 20, v201
    v_sub_u32 v200, v200, v202
    v_mul_u32_u24 v201, 3840, v201
    v_cmp_lt_u32 vcc, 9, v200
    v_lshlrev_b32 v200, 4, v200
    v_add3_u32 v200, v200, v201, s97
    v_add_u32 v201, 1120, v200
    v_cndmask_b32 v200, v200, v201, vcc
    v_subrev_u32 v4, 2048, v200
    v_add_u32 v200, 192, v0
    v_mul_u32_u24 v201, s7, v200
    v_lshrrev_b32 v201, 16, v201
    v_mul_u32_u24 v202, 20, v201
    v_sub_u32 v200, v200, v202
    v_mul_u32_u24 v201, 3840, v201
    v_cmp_lt_u32 vcc, 9, v200
    v_lshlrev_b32 v200, 4, v200
    v_add3_u32 v200, v200, v201, s97
    v_add_u32 v201, 1120, v200
    v_cndmask_b32 v200, v200, v201, vcc
    v_subrev_u32 v5, 3072, v200
    v_add_u32 v200, 256, v0
    v_mul_u32_u24 v201, s7, v200
    v_lshrrev_b32 v201, 16, v201
    v_mul_u32_u24 v202, 20, v201
    v_sub_u32 v200, v200, v202
    v_mul_u32_u24 v201, 3840, v201
    v_cmp_lt_u32 vcc, 9, v200
    v_lshlrev_b32 v200, 4, v200
    v_add3_u32 v200, v200, v201, s97
    v_add_u32 v201, 1120, v200
    v_cndmask_b32 v200, v200, v201, vcc
    v_subrev_u32 v6, 0, v200
    s_mov_b64 s[98:99], s[40:41]
    s_mov_b64 s[100:101], s[42:43]
    s_and_b32 s33, s33, 0xffff
    s_mov_b32 s34, 2461696
    s_mov_b32 s35, 0x20000
    s_sub_u32 s40, s38, 6144
    s_subb_u32 s41, s39, 0
    s_and_b32 s41, s41, 0xffff
    s_mov_b32 s42, 1972224
    s_mov_b32 s43, 0x20000
    s_sub_u32 s36, s36, 4096
    s_subb_u32 s37, s37, 0
    s_and_b32 s37, s37, 0xffff
    s_mov_b32 s38, 1970176
    s_mov_b32 s39, 0x20000
    s_add_u32 m0, s60, 0
    s_nop 0
    buffer_load_dwordx4 v2, s[32:35], s62 offen offset:0  lds
    buffer_load_dwordx4 v3, s[32:35], s62 offen offset:1024  lds
    buffer_load_dwordx4 v4, s[32:35], s62 offen offset:2048  lds
    buffer_load_dwordx4 v5, s[32:35], s62 offen offset:3072  lds
    s_add_u32 m0, s60, 4096
    s_nop 0
    buffer_load_dwordx4 v6, s[32:35], s62 offen offset:0  lds
    s_branch ROLEA
BHEAD:
    v_add_u32 v5, 128, v7
    v_add_u32 v6, 128, v8
    s_waitcnt lgkmcnt(0)
    s_load_dwordx16 s[8:23], s[100:101], 0
    s_load_dwordx16 s[64:79], s[100:101], 64
    s_load_dwordx16 s[80:95], s[100:101], 128
    s_load_dwordx8 s[52:59], s[24:25], 0
    s_sub_u32 s32, s30, 4096
    s_subb_u32 s33, s31, 0
    s_and_b32 s29, s29, 0xffff
    s_mov_b32 s30, 2621440
    s_mov_b32 s31, 0x20000
    s_add_u32 m0, s60, 32768
    s_nop 0
    buffer_load_dwordx4 v160, s[28:31], s61 offen offset:0  lds
    buffer_load_dwordx4 v161, s[28:31], s61 offen offset:1024  lds
    buffer_load_dwordx4 v162, s[28:31], s61 offen offset:2048  lds
    buffer_load_dwordx4 v163, s[28:31], s61 offen offset:3072  lds
    s_mov_b32 s24, s44
    s_and_b32 s25, s45, 0xffff
    s_mov_b32 s26, 256
    s_mov_b32 s27, 0x20000
    s_mov_b32 s44, s46
    s_and_b32 s45, s47, 0xffff
    s_mov_b32 s46, 14155776
    s_mov_b32 s47, 0x20000
    s_mov_b64 s[98:99], s[40:41]
    s_mov_b64 s[100:101], s[42:43]
    s_and_b32 s33, s33, 0xffff
    s_mov_b32 s34, 2461696
    s_mov_b32 s35, 0x20000
    s_sub_u32 s40, s38, 6144
    s_subb_u32 s41, s39, 0
    s_and_b32 s41, s41, 0xffff
    s_mov_b32 s42, 1972224
    s_mov_b32 s43, 0x20000
    s_sub_u32 s36, s36, 4096
    s_subb_u32 s37, s37, 0
    s_and_b32 s37, s37, 0xffff
    s_mov_b32 s38, 1970176
    s_mov_b32 s39, 0x20000
    s_add_u32 m0, s60, 0
    s_nop 0
    buffer_load_dwordx4 v7, s[36:39], s63 offen offset:0  lds
    buffer_load_dwordx4 v8, s[36:39], s63 offen offset:1024  lds
    buffer_load_dwordx4 v7, s[40:43], s63 offen offset:2048  lds
    buffer_load_dwordx4 v8, s[40:43], s63 offen offset:3072  lds
    s_add_u32 m0, s60, 4096
    s_nop 0
    buffer_load_dwordx4 v5, s[36:39], s63 offen offset:0  lds
    buffer_load_dwordx4 v6, s[36:39], s63 offen offset:1024  lds
    buffer_load_dwordx4 v5, s[40:43], s63 offen offset:2048  lds
    buffer_load_dwordx4 v6, s[40:43], s63 offen offset:3072  lds
    s_movk_i32 s7, 5462
    v_add_u32 v200, 0, v0
    v_mul_u32_u24 v201, s7, v200
    v_lshrrev_b32 v201, 16, v201
    v_mul_u32_u24 v202, 12, v201
    v_sub_u32 v200, v200, v202
    v_mul_u32_u24 v201, 3840, v201
    v_min_u32 v200, 9, v200
    v_lshlrev_b32 v200, 4, v200
    v_add3_u32 v200, v200, v201, s97
    v_subrev_u32 v2, 0, v200
    v_add_u32 v200, 64, v0
    v_mul_u32_u24 v201, s7, v200
    v_lshrrev_b32 v201, 16, v201
    v_mul_u32_u24 v202, 12, v201
    v_sub_u32 v200, v200, v202
    v_mul_u32_u24 v201, 3840, v201
    v_min_u32 v200, 9, v200
    v_lshlrev_b32 v200, 4, v200
    v_add3_u32 v200, v200, v201, s97
    v_subrev_u32 v3, 1024, v200
    v_add_u32 v200, 128, v0
    v_mul_u32_u24 v201, s7, v200
    v_lshrrev_b32 v201, 16, v201
    v_mul_u32_u24 v202, 12, v201
    v_sub_u32 v200, v200, v202
    v_mul_u32_u24 v201, 3840, v201
    v_min_u32 v200, 9, v200
    v_lshlrev_b32 v200, 4, v200
    v_add3_u32 v200, v200, v201, s97
    v_subrev_u32 v4, 2048, v200
    s_mov_b32 s61, 2796203
    s_waitcnt lgkmcnt(0)
    v_lshlrev_b32 v203, 4, v0
    v_add_u32 v188, s56, v203
    v_add_u32 v189, s57, v203
    v_add_u32 v190, s58, v203
    v_add_u32 v191, s59, v203
    s_bitcmp1_b32 s52, 0
    s_cselect_b32 s48, s48, s98
    s_cselect_b32 s49, s49, s99
    s_mov_b32 s7, 1966080
    s_cselect_b32 s50, 819200, s7
    s_and_b32 s49, s49, 0xffff
    s_mov_b32 s51, 0x20000
    s_andn2_b32 s96, s52, 1
    v_mov_b32 v185, s53
    v_mov_b32 v186, s54
    v_mov_b32 v187, s55
    s_mov_b32 s56, s100
    s_and_b32 s57, s101, 0xffff
    s_mov_b32 s58, 2621440
    s_mov_b32 s59, 0x20000
    s_mul_i32 s52, s2, 3856
    s_lshr_b32 s52, s52, 16
    s_cmp_ge_u32 s52, 5
    s_cselect_b32 s53, 1, 0
    s_mul_i32 s54, s53, 5
    s_sub_u32 s54, s52, s54
    s_sub_u32 s52, s52, s53
    s_lshl_b32 s52, s52, 8
    s_sub_u32 s53, s52, 256
    s_cmp_ge_u32 s54, 1
    s_cselect_b32 s53, s53, 2146435072
    s_cmp_le_u32 s54, 3
    s_cselect_b32 s52, s52, 2146435072
    v_mov_b32 v201, s53
    v_mov_b32 v202, s52
    v_cmp_gt_u32 vcc, 8, v0
    s_lshr_b32 s54, s3, 1
    s_mul_i32 s54, s54, 348160
    s_and_b32 s55, s3, 1
    s_lshl_b32 s55, s55, 11
    s_add_u32 s54, s54, s55
    s_add_u32 s54, s54, s88
    v_cndmask_b32 v201, v202, v201, vcc
    s_mul_i32 s62, s87, 1536
    s_add_u32 s62, s62, 14114816
    s_lshl_b32 s63, s4, 2
    s_add_u32 s63, s63, s3
    s_lshl_b32 s63, s63, 8
    s_add_u32 s63, s63, 14139392
    s_mul_i32 s7, s3, 5120
    s_add_u32 s92, s92, s7
    s_add_u32 s93, s93, s7
    v_add_u32 v15, s92, v203
    v_add_u32 v16, 4096, v15
    s_add_u32 m0, s60, 36864
    s_mul_hi_u32 s5, s75, s61
    buffer_load_dwordx4 v160, s[28:31], s5 offen offset:0  lds
    buffer_load_dwordx4 v161, s[28:31], s5 offen offset:1024  lds
    buffer_load_dwordx4 v162, s[28:31], s5 offen offset:2048  lds
    buffer_load_dwordx4 v163, s[28:31], s5 offen offset:3072  lds
    s_waitcnt vmcnt(17)
    v_add_u32 v164, s60, v164
    v_add_u32 v165, s60, v165
    v_add_u32 v166, s60, v166
    v_add_u32 v167, s60, v167
    v_mov_b32 v9, v169
    v_add_u32 v10, 65536, v169
    v_add_u32 v11, 131072, v169
    v_mov_b32 v12, v170
    v_add_u32 v13, 65536, v170
    v_add_u32 v14, 131072, v170
    v_mov_b32 v208, v181
    v_mov_b32 v209, v181
    v_mov_b32 v210, v181
    v_mov_b32 v211, v181
    v_add_u32 v1, s54, v171
    v_add_u32 v172, s60, v172
    v_add_u32 v175, v175, v201
    v_mul_lo_u32 v185, v185, v174
    v_add3_u32 v184, v185, v173, s96
    v_add_u32 v185, v184, v186
    v_add_u32 v186, v184, v187
    v_add_u32 v187, v185, v187
    s_waitcnt vmcnt(12)
    ds_read_b128 a[0:3], v164 offset:0
    ds_read_b128 a[4:7], v165 offset:0
    ds_read_b128 a[8:11], v166 offset:0
    ds_read_b128 a[12:15], v167 offset:0
    ds_read_b128 v[240:243], v164
    ds_read_b128 v[244:247], v165
    ds_read_b128 v[248:251], v166
    ds_read_b128 v[252:255], v167
    s_mov_b32 s7, 0x3f803f80
    s_waitcnt lgkmcnt(0)
    v_dot2c_f32_bf16 v192, s7, v240
    v_dot2c_f32_bf16 v194, v240, v240
    v_dot2c_f32_bf16 v193, s7, v241
    v_dot2c_f32_bf16 v195, v241, v241
    v_dot2c_f32_bf16 v192, s7, v242
    v_dot2c_f32_bf16 v194, v242, v242
    v_dot2c_f32_bf16 v193, s7, v243
    v_dot2c_f32_bf16 v195, v243, v243
    v_dot2c_f32_bf16 v192, s7, v244
    v_dot2c_f32_bf16 v194, v244, v244
    v_dot2c_f32_bf16 v193, s7, v245
    v_dot2c_f32_bf16 v195, v245, v245
    v_dot2c_f32_bf16 v192, s7, v246
    v_dot2c_f32_bf16 v194, v246, v246
    v_dot2c_f32_bf16 v193, s7, v247
    v_dot2c_f32_bf16 v195, v247, v247
    v_dot2c_f32_bf16 v192, s7, v248
    v_dot2c_f32_bf16 v194, v248, v248
    v_dot2c_f32_bf16 v193, s7, v249
    v_dot2c_f32_bf16 v195, v249, v249
    v_dot2c_f32_bf16 v192, s7, v250
    v_dot2c_f32_bf16 v194, v250, v250
    v_dot2c_f32_bf16 v193, s7, v251
    v_dot2c_f32_bf16 v195, v251, v251
    v_dot2c_f32_bf16 v192, s7, v252
    v_dot2c_f32_bf16 v194, v252, v252
    v_dot2c_f32_bf16 v193, s7, v253
    v_dot2c_f32_bf16 v195, v253, v253
    v_dot2c_f32_bf16 v192, s7, v254
    v_dot2c_f32_bf16 v194, v254, v254
    v_dot2c_f32_bf16 v193, s7, v255
    v_dot2c_f32_bf16 v195, v255, v255
    s_nop 2
    v_add_f32 v192, v192, v193
    v_add_f32 v194, v194, v195
    s_nop 1
    v_permlane32_swap_b32 v192, v194
    s_nop 1
    v_add_f32 v197, v192, v194
    s_add_u32 m0, s60, 8192
    s_nop 0
    buffer_load_dwordx4 v7, s[36:39], s75 offen offset:0  lds
    buffer_load_dwordx4 v8, s[36:39], s75 offen offset:1024  lds
    buffer_load_dwordx4 v7, s[40:43], s75 offen offset:2048  lds
    buffer_load_dwordx4 v8, s[40:43], s75 offen offset:3072  lds
    s_add_u32 m0, s60, 12288
    s_nop 0
    buffer_load_dwordx4 v5, s[36:39], s75 offen offset:0  lds
    buffer_load_dwordx4 v6, s[36:39], s75 offen offset:1024  lds
    buffer_load_dwordx4 v5, s[40:43], s75 offen offset:2048  lds
    buffer_load_dwordx4 v6, s[40:43], s75 offen offset:3072  lds
    s_waitcnt vmcnt(12)
    s_barrier
    ds_read_b64_tr_b16 a[160:161], v9 offset:0
    ds_read_b64_tr_b16 a[162:163], v9 offset:512
    ds_read_b64_tr_b16 a[164:165], v12 offset:0
    ds_read_b64_tr_b16 a[166:167], v12 offset:512
    ds_read_b64_tr_b16 a[168:169], v9 offset:2048
    ds_read_b64_tr_b16 a[170:171], v9 offset:2560
    ds_read_b64_tr_b16 a[172:173], v12 offset:2048
    ds_read_b64_tr_b16 a[174:175], v12 offset:2560
    ds_read_b64_tr_b16 a[176:177], v9 offset:4096
    ds_read_b64_tr_b16 a[178:179], v9 offset:4608
    ds_read_b64_tr_b16 a[180:181], v12 offset:4096
    ds_read_b64_tr_b16 a[182:183], v12 offset:4608
    ds_read_b64_tr_b16 a[184:185], v9 offset:6144
    ds_read_b64_tr_b16 a[186:187], v9 offset:6656
    ds_read_b64_tr_b16 a[188:189], v12 offset:6144
    ds_read_b64_tr_b16 a[190:191], v12 offset:6656
    ds_read_b64_tr_b16 a[192:193], v9 offset:40960
    ds_read_b64_tr_b16 a[194:195], v9 offset:41472
    ds_read_b64_tr_b16 a[196:197], v12 offset:40960
    ds_read_b64_tr_b16 a[198:199], v12 offset:41472
    ds_read_b64_tr_b16 a[200:201], v9 offset:43008
    ds_read_b64_tr_b16 a[202:203], v9 offset:43520
    ds_read_b64_tr_b16 a[204:205], v12 offset:43008
    ds_read_b64_tr_b16 a[206:207], v12 offset:43520
    ds_read_b64_tr_b16 a[208:209], v9 offset:45056
    ds_read_b64_tr_b16 a[210:211], v9 offset:45568
    ds_read_b64_tr_b16 a[212:213], v12 offset:45056
    ds_read_b64_tr_b16 a[214:215], v12 offset:45568
    ds_read_b64_tr_b16 a[216:217], v9 offset:47104
    ds_read_b64_tr_b16 a[218:219], v9 offset:47616
    ds_read_b64_tr_b16 a[220:221], v12 offset:47104
    ds_read_b64_tr_b16 a[222:223], v12 offset:47616
    s_waitcnt lgkmcnt(15)
    v_mfma_f32_32x32x16_bf16 v[32:47], a[160:163], a[0:3], 0
    s_add_u32 m0, s60, 28672
    s_bitcmp1_b32 s2, 2
    s_cselect_b32 s97, s64, s64
    s_cmp_eq_u32 s86, 2146435072
    s_cselect_b32 s97, s86, s97
    ds_read_b64_tr_b16 a[224:225], v10 offset:16384
    ds_read_b64_tr_b16 a[226:227], v10 offset:16896
    v_mfma_f32_32x32x16_bf16 v[48:63], a[164:167], a[0:3], 0
    ds_read_b64_tr_b16 a[228:229], v13 offset:16384
    ds_read_b64_tr_b16 a[230:231], v13 offset:16896
    buffer_load_dwordx4 v2, s[32:35], s97 offen offset:0 lds
    v_mfma_f32_32x32x16_bf16 v[64:79], a[168:171], a[0:3], 0
    ds_read_b64_tr_b16 a[232:233], v10 offset:18432
    ds_read_b64_tr_b16 a[234:235], v10 offset:18944
    buffer_load_dwordx4 v3, s[32:35], s97 offen offset:1024 lds
    v_mfma_f32_32x32x16_bf16 v[80:95], a[172:175], a[0:3], 0
    ds_read_b64_tr_b16 a[236:237], v13 offset:18432
    ds_read_b64_tr_b16 a[238:239], v13 offset:18944
    buffer_load_dwordx4 v4, s[32:35], s97 offen offset:2048 lds
    v_mfma_f32_32x32x16_bf16 v[96:111], a[176:179], a[0:3], 0
    s_add_u32 m0, s60, 24576
    s_nop 0
    ds_read_b64_tr_b16 a[240:241], v10 offset:20480
    ds_read_b64_tr_b16 a[242:243], v10 offset:20992
    buffer_load_dwordx4 v184, s[48:51], 0 offen offset:0  lds
    v_mfma_f32_32x32x16_bf16 v[112:127], a[180:183], a[0:3], 0
    ds_read_b64_tr_b16 a[244:245], v13 offset:20480
    ds_read_b64_tr_b16 a[246:247], v13 offset:20992
    buffer_load_dwordx4 v185, s[48:51], 0 offen offset:1024  lds
    v_mfma_f32_32x32x16_bf16 v[128:143], a[184:187], a[0:3], 0
    ds_read_b64_tr_b16 a[248:249], v10 offset:22528
    ds_read_b64_tr_b16 a[250:251], v10 offset:23040
    buffer_load_dwordx4 v186, s[48:51], 0 offen offset:2048  lds
    v_mfma_f32_32x32x16_bf16 v[144:159], a[188:191], a[0:3], 0
    ds_read_b64_tr_b16 a[252:253], v13 offset:22528
    ds_read_b64_tr_b16 a[254:255], v13 offset:23040
    buffer_load_dwordx4 v187, s[48:51], 0 offen offset:3072  lds
    s_cmp_lg_u32 s3, 0
    s_cbranch_scc1 CSK2
    v_mfma_f32_16x16x32_bf16 v[212:215], v[208:211], a[160:163], 0
    v_mfma_f32_16x16x32_bf16 v[216:219], v[208:211], a[164:167], 0
    s_branch CSE1
CSK2:
    s_cmp_lg_u32 s3, 1
    s_cbranch_scc1 CSK3
    v_mfma_f32_16x16x32_bf16 v[212:215], v[208:211], a[168:171], 0
    v_mfma_f32_16x16x32_bf16 v[216:219], v[208:211], a[172:175], 0
    s_branch CSE1
CSK3:
    s_cmp_lg_u32 s3, 2
    s_cbranch_scc1 CSK4
    v_mfma_f32_16x16x32_bf16 v[212:215], v[208:211], a[176:179], 0
    v_mfma_f32_16x16x32_bf16 v[216:219], v[208:211], a[180:183], 0
    s_branch CSE1
CSK4:
    s_cmp_lg_u32 s3, 3
    s_cbranch_scc1 CSK5
    v_mfma_f32_16x16x32_bf16 v[212:215], v[208:211], a[184:187], 0
    v_mfma_f32_16x16x32_bf16 v[216:219], v[208:211], a[188:191], 0
    s_branch CSE1
CSK5:
CSE1:
    s_waitcnt lgkmcnt(15)
    v_mfma_f32_32x32x16_bf16 v[32:47], a[192:195], a[4:7], v[32:47]
    s_add_u32 m0, s60, 16384
    ds_read_b64_tr_b16 a[160:161], v10 offset:57344
    ds_read_b64_tr_b16 a[162:163], v10 offset:57856
    v_mfma_f32_32x32x16_bf16 v[48:63], a[196:199], a[4:7], v[48:63]
    ds_read_b64_tr_b16 a[164:165], v13 offset:57344
    ds_read_b64_tr_b16 a[166:167], v13 offset:57856
    buffer_load_dwordx4 v7, s[36:39], s76 offen offset:0  lds
    v_mfma_f32_32x32x16_bf16 v[64:79], a[200:203], a[4:7], v[64:79]
    ds_read_b64_tr_b16 a[168:169], v10 offset:59392
    ds_read_b64_tr_b16 a[170:171], v10 offset:59904
    v_mfma_f32_32x32x16_bf16 v[80:95], a[204:207], a[4:7], v[80:95]
    ds_read_b64_tr_b16 a[172:173], v13 offset:59392
    ds_read_b64_tr_b16 a[174:175], v13 offset:59904
    buffer_load_dwordx4 v8, s[36:39], s76 offen offset:1024  lds
    v_mfma_f32_32x32x16_bf16 v[96:111], a[208:211], a[4:7], v[96:111]
    ds_read_b64_tr_b16 a[176:177], v10 offset:61440
    ds_read_b64_tr_b16 a[178:179], v10 offset:61952
    v_mfma_f32_32x32x16_bf16 v[112:127], a[212:215], a[4:7], v[112:127]
    ds_read_b64_tr_b16 a[180:181], v13 offset:61440
    ds_read_b64_tr_b16 a[182:183], v13 offset:61952
    buffer_load_dwordx4 v7, s[40:43], s76 offen offset:2048  lds
    v_mfma_f32_32x32x16_bf16 v[128:143], a[216:219], a[4:7], v[128:143]
    ds_read_b64_tr_b16 a[184:185], v10 offset:63488
    ds_read_b64_tr_b16 a[186:187], v10 offset:64000
    v_mfma_f32_32x32x16_bf16 v[144:159], a[220:223], a[4:7], v[144:159]
    ds_read_b64_tr_b16 a[188:189], v13 offset:63488
    ds_read_b64_tr_b16 a[190:191], v13 offset:64000
    buffer_load_dwordx4 v8, s[40:43], s76 offen offset:3072  lds
    s_cmp_lg_u32 s3, 0
    s_cbranch_scc1 CSK7
    v_mfma_f32_16x16x32_bf16 v[212:215], v[208:211], a[192:195], v[212:215]
    v_mfma_f32_16x16x32_bf16 v[216:219], v[208:211], a[196:199], v[216:219]
    s_branch CSE6
CSK7:
    s_cmp_lg_u32 s3, 1
    s_cbranch_scc1 CSK8
    v_mfma_f32_16x16x32_bf16 v[212:215], v[208:211], a[200:203], v[212:215]
    v_mfma_f32_16x16x32_bf16 v[216:219], v[208:211], a[204:207], v[216:219]
    s_branch CSE6
CSK8:
    s_cmp_lg_u32 s3, 2
    s_cbranch_scc1 CSK9
    v_mfma_f32_16x16x32_bf16 v[212:215], v[208:211], a[208:211], v[212:215]
    v_mfma_f32_16x16x32_bf16 v[216:219], v[208:211], a[212:215], v[216:219]
    s_branch CSE6
CSK9:
    s_cmp_lg_u32 s3, 3
    s_cbranch_scc1 CSK10
    v_mfma_f32_16x16x32_bf16 v[212:215], v[208:211], a[216:219], v[212:215]
    v_mfma_f32_16x16x32_bf16 v[216:219], v[208:211], a[220:223], v[216:219]
    s_branch CSE6
CSK10:
CSE6:
    s_waitcnt lgkmcnt(15)
    v_mfma_f32_32x32x16_bf16 v[32:47], a[224:227], a[8:11], v[32:47]
    s_waitcnt vmcnt(11)
    s_barrier
    s_add_u32 m0, s60, 20480
    ds_read_b64_tr_b16 a[192:193], v9 offset:8192
    ds_read_b64_tr_b16 a[194:195], v9 offset:8704
    v_mfma_f32_32x32x16_bf16 v[48:63], a[228:231], a[8:11], v[48:63]
    ds_read_b64_tr_b16 a[196:197], v12 offset:8192
    ds_read_b64_tr_b16 a[198:199], v12 offset:8704
    ds_read_b128 a[16:19], v164 offset:4096
    buffer_load_dwordx4 v5, s[36:39], s76 offen offset:0  lds
    v_mfma_f32_32x32x16_bf16 v[64:79], a[232:235], a[8:11], v[64:79]
    ds_read_b64_tr_b16 a[200:201], v9 offset:10240
    ds_read_b64_tr_b16 a[202:203], v9 offset:10752
    ds_read_b128 a[20:23], v165 offset:4096
    v_mfma_f32_32x32x16_bf16 v[80:95], a[236:239], a[8:11], v[80:95]
    ds_read_b64_tr_b16 a[204:205], v12 offset:10240
    ds_read_b64_tr_b16 a[206:207], v12 offset:10752
    ds_read_b128 a[24:27], v166 offset:4096
    buffer_load_dwordx4 v6, s[36:39], s76 offen offset:1024  lds
    v_mfma_f32_32x32x16_bf16 v[96:111], a[240:243], a[8:11], v[96:111]
    ds_read_b64_tr_b16 a[208:209], v9 offset:12288
    ds_read_b64_tr_b16 a[210:211], v9 offset:12800
    ds_read_b128 a[28:31], v167 offset:4096
    v_mfma_f32_32x32x16_bf16 v[112:127], a[244:247], a[8:11], v[112:127]
    ds_read_b64_tr_b16 a[212:213], v12 offset:12288
    ds_read_b64_tr_b16 a[214:215], v12 offset:12800
    buffer_load_dwordx4 v5, s[40:43], s76 offen offset:2048  lds
    v_mfma_f32_32x32x16_bf16 v[128:143], a[248:251], a[8:11], v[128:143]
    ds_read_b64_tr_b16 a[216:217], v9 offset:14336
    ds_read_b64_tr_b16 a[218:219], v9 offset:14848
    v_mfma_f32_32x32x16_bf16 v[144:159], a[252:255], a[8:11], v[144:159]
    ds_read_b64_tr_b16 a[220:221], v12 offset:14336
    ds_read_b64_tr_b16 a[222:223], v12 offset:14848
    buffer_load_dwordx4 v6, s[40:43], s76 offen offset:3072  lds
    s_cmp_lg_u32 s3, 0
    s_cbranch_scc1 CSK12
    v_mfma_f32_16x16x32_bf16 v[212:215], v[208:211], a[224:227], v[212:215]
    v_mfma_f32_16x16x32_bf16 v[216:219], v[208:211], a[228:231], v[216:219]
    s_branch CSE11
CSK12:
    s_cmp_lg_u32 s3, 1
    s_cbranch_scc1 CSK13
    v_mfma_f32_16x16x32_bf16 v[212:215], v[208:211], a[232:235], v[212:215]
    v_mfma_f32_16x16x32_bf16 v[216:219], v[208:211], a[236:239], v[216:219]
    s_branch CSE11
CSK13:
    s_cmp_lg_u32 s3, 2
    s_cbranch_scc1 CSK14
    v_mfma_f32_16x16x32_bf16 v[212:215], v[208:211], a[240:243], v[212:215]
    v_mfma_f32_16x16x32_bf16 v[216:219], v[208:211], a[244:247], v[216:219]
    s_branch CSE11
CSK14:
    s_cmp_lg_u32 s3, 3
    s_cbranch_scc1 CSK15
    v_mfma_f32_16x16x32_bf16 v[212:215], v[208:211], a[248:251], v[212:215]
    v_mfma_f32_16x16x32_bf16 v[216:219], v[208:211], a[252:255], v[216:219]
    s_branch CSE11
CSK15:
CSE11:
    s_waitcnt lgkmcnt(15)
    v_mfma_f32_32x32x16_bf16 v[32:47], a[160:163], a[12:15], v[32:47]
    s_add_u32 m0, s60, 32768
    s_mul_hi_u32 s5, s76, s61
    ds_read_b64_tr_b16 a[224:225], v9 offset:49152
    ds_read_b64_tr_b16 a[226:227], v9 offset:49664
    v_mfma_f32_32x32x16_bf16 v[48:63], a[164:167], a[12:15], v[48:63]
    ds_read_b64_tr_b16 a[228:229], v12 offset:49152
    ds_read_b64_tr_b16 a[230:231], v12 offset:49664
    buffer_load_dwordx4 v160, s[28:31], s5 offen offset:0  lds
    v_mfma_f32_32x32x16_bf16 v[64:79], a[168:171], a[12:15], v[64:79]
    ds_read_b64_tr_b16 a[232:233], v9 offset:51200
    ds_read_b64_tr_b16 a[234:235], v9 offset:51712
    v_mfma_f32_32x32x16_bf16 v[80:95], a[172:175], a[12:15], v[80:95]
    ds_read_b64_tr_b16 a[236:237], v12 offset:51200
    ds_read_b64_tr_b16 a[238:239], v12 offset:51712
    buffer_load_dwordx4 v161, s[28:31], s5 offen offset:1024  lds
    v_mfma_f32_32x32x16_bf16 v[96:111], a[176:179], a[12:15], v[96:111]
    ds_read_b64_tr_b16 a[240:241], v9 offset:53248
    ds_read_b64_tr_b16 a[242:243], v9 offset:53760
    v_mfma_f32_32x32x16_bf16 v[112:127], a[180:183], a[12:15], v[112:127]
    ds_read_b64_tr_b16 a[244:245], v12 offset:53248
    ds_read_b64_tr_b16 a[246:247], v12 offset:53760
    buffer_load_dwordx4 v162, s[28:31], s5 offen offset:2048  lds
    v_mfma_f32_32x32x16_bf16 v[128:143], a[184:187], a[12:15], v[128:143]
    ds_read_b64_tr_b16 a[248:249], v9 offset:55296
    ds_read_b64_tr_b16 a[250:251], v9 offset:55808
    v_mfma_f32_32x32x16_bf16 v[144:159], a[188:191], a[12:15], v[144:159]
    ds_read_b64_tr_b16 a[252:253], v12 offset:55296
    ds_read_b64_tr_b16 a[254:255], v12 offset:55808
    buffer_load_dwordx4 v163, s[28:31], s5 offen offset:3072  lds
    s_cmp_lg_u32 s3, 0
    s_cbranch_scc1 CSK17
    v_mfma_f32_16x16x32_bf16 v[212:215], v[208:211], a[160:163], v[212:215]
    v_mfma_f32_16x16x32_bf16 v[216:219], v[208:211], a[164:167], v[216:219]
    s_branch CSE16
CSK17:
    s_cmp_lg_u32 s3, 1
    s_cbranch_scc1 CSK18
    v_mfma_f32_16x16x32_bf16 v[212:215], v[208:211], a[168:171], v[212:215]
    v_mfma_f32_16x16x32_bf16 v[216:219], v[208:211], a[172:175], v[216:219]
    s_branch CSE16
CSK18:
    s_cmp_lg_u32 s3, 2
    s_cbranch_scc1 CSK19
    v_mfma_f32_16x16x32_bf16 v[212:215], v[208:211], a[176:179], v[212:215]
    v_mfma_f32_16x16x32_bf16 v[216:219], v[208:211], a[180:183], v[216:219]
    s_branch CSE16
CSK19:
    s_cmp_lg_u32 s3, 3
    s_cbranch_scc1 CSK20
    v_mfma_f32_16x16x32_bf16 v[212:215], v[208:211], a[184:187], v[212:215]
    v_mfma_f32_16x16x32_bf16 v[216:219], v[208:211], a[188:191], v[216:219]
    s_branch CSE16
CSK20:
CSE16:
    s_waitcnt lgkmcnt(15)
    v_mfma_f32_32x32x16_bf16 v[32:47], a[192:195], a[16:19], v[32:47]
    s_add_u32 m0, s60, 36864
    s_mul_hi_u32 s5, s77, s61
    ds_read_b64_tr_b16 a[160:161], v10 offset:24576
    ds_read_b64_tr_b16 a[162:163], v10 offset:25088
    s_waitcnt vmcnt(16)
    v_add_u32 v202, s60, v168
    v_add_u32 v203, s60, v170
    v_mfma_f32_32x32x16_bf16 v[48:63], a[196:199], a[16:19], v[48:63]
    ds_read_b64_tr_b16 a[164:165], v13 offset:24576
    ds_read_b64_tr_b16 a[166:167], v13 offset:25088
    buffer_load_dwordx4 v160, s[28:31], s5 offen offset:0  lds
    ds_read_b64_tr_b16 v[228:229], v202 offset:28672
    ds_read_b64_tr_b16 v[230:231], v202 offset:29440
    v_mfma_f32_32x32x16_bf16 v[64:79], a[200:203], a[16:19], v[64:79]
    ds_read_b64_tr_b16 a[168:169], v10 offset:26624
    ds_read_b64_tr_b16 a[170:171], v10 offset:27136
    ds_read_b64_tr_b16 v[232:233], v202 offset:28736
    ds_read_b64_tr_b16 v[234:235], v202 offset:29504
    ds_read_b64_tr_b16 v[236:237], v202 offset:28800
    ds_read_b64_tr_b16 v[238:239], v202 offset:29568
    s_waitcnt vmcnt(13)
    v_mfma_f32_32x32x16_bf16 v[80:95], a[204:207], a[16:19], v[80:95]
    ds_read_b64_tr_b16 a[172:173], v13 offset:26624
    ds_read_b64_tr_b16 a[174:175], v13 offset:27136
    buffer_load_dwordx4 v161, s[28:31], s5 offen offset:1024  lds
    ds_read_b64_tr_b16 v[240:241], v172 offset:0
    ds_read_b64_tr_b16 v[242:243], v172 offset:1024
    v_mfma_f32_32x32x16_bf16 v[96:111], a[208:211], a[16:19], v[96:111]
    ds_read_b64_tr_b16 a[176:177], v10 offset:28672
    ds_read_b64_tr_b16 a[178:179], v10 offset:29184
    ds_read_b64_tr_b16 v[244:245], v172 offset:32
    ds_read_b64_tr_b16 v[246:247], v172 offset:1056
    ds_read_b64_tr_b16 v[248:249], v172 offset:64
    ds_read_b64_tr_b16 v[250:251], v172 offset:1088
    ds_read_b64_tr_b16 v[252:253], v172 offset:96
    v_mfma_f32_32x32x16_bf16 v[112:127], a[212:215], a[16:19], v[112:127]
    ds_read_b64_tr_b16 a[180:181], v13 offset:28672
    ds_read_b64_tr_b16 a[182:183], v13 offset:29184
    buffer_load_dwordx4 v162, s[28:31], s5 offen offset:2048  lds
    ds_read_b64_tr_b16 v[254:255], v172 offset:1120
    v_mfma_f32_32x32x16_bf16 v[128:143], a[216:219], a[16:19], v[128:143]
    ds_read_b64_tr_b16 a[184:185], v10 offset:30720
    ds_read_b64_tr_b16 a[186:187], v10 offset:31232
    v_mfma_f32_32x32x16_bf16 v[144:159], a[220:223], a[16:19], v[144:159]
    ds_read_b64_tr_b16 a[188:189], v13 offset:30720
    ds_read_b64_tr_b16 a[190:191], v13 offset:31232
    buffer_load_dwordx4 v163, s[28:31], s5 offen offset:3072  lds
    s_waitcnt lgkmcnt(15)
    v_mfma_f32_32x32x16_bf16 v[32:47], a[224:227], a[20:23], v[32:47]
    ds_read_b64_tr_b16 a[192:193], v11 offset:0
    ds_read_b64_tr_b16 a[194:195], v11 offset:512
    v_mfma_f32_32x32x16_bf16 v[48:63], a[228:231], a[20:23], v[48:63]
    ds_read_b64_tr_b16 a[196:197], v14 offset:0
    ds_read_b64_tr_b16 a[198:199], v14 offset:512
    s_waitcnt lgkmcnt(8)
    v_mfma_f32_16x16x32_bf16 v[18:21], v[208:211], v[228:231], 0
    v_mfma_f32_16x16x32_bf16 v[22:25], v[208:211], v[232:235], 0
    v_mfma_f32_16x16x32_bf16 v[26:29], v[208:211], v[236:239], 0
    v_mfma_f32_32x32x16_bf16 v[64:79], a[232:235], a[20:23], v[64:79]
    s_add_u32 m0, s60, 24576
    ds_read_b64_tr_b16 a[200:201], v11 offset:2048
    ds_read_b64_tr_b16 a[202:203], v11 offset:2560
    buffer_store_dwordx4 v[240:243], v188, s[44:47], 0 offen sc1
    v_mfma_f32_32x32x16_bf16 v[80:95], a[236:239], a[20:23], v[80:95]
    ds_read_b64_tr_b16 a[204:205], v14 offset:2048
    ds_read_b64_tr_b16 a[206:207], v14 offset:2560
    buffer_store_dwordx4 v[244:247], v189, s[44:47], 0 offen sc1
    buffer_load_dwordx4 v7, s[36:39], s77 offen offset:0  lds
    v_mfma_f32_32x32x16_bf16 v[96:111], a[240:243], a[20:23], v[96:111]
    ds_read_b64_tr_b16 a[208:209], v11 offset:4096
    ds_read_b64_tr_b16 a[210:211], v11 offset:4608
    buffer_store_dwordx4 v[248:251], v190, s[44:47], 0 offen sc1
    v_mfma_f32_32x32x16_bf16 v[112:127], a[244:247], a[20:23], v[112:127]
    ds_read_b64_tr_b16 a[212:213], v14 offset:4096
    ds_read_b64_tr_b16 a[214:215], v14 offset:4608
    buffer_store_dwordx4 v[252:255], v191, s[44:47], 0 offen sc1
    buffer_load_dwordx4 v8, s[36:39], s77 offen offset:1024  lds
    v_mfma_f32_32x32x16_bf16 v[128:143], a[248:251], a[20:23], v[128:143]
    ds_read_b64_tr_b16 a[216:217], v11 offset:6144
    ds_read_b64_tr_b16 a[218:219], v11 offset:6656
    v_mfma_f32_32x32x16_bf16 v[144:159], a[252:255], a[20:23], v[144:159]
    ds_read_b64_tr_b16 a[220:221], v14 offset:6144
    ds_read_b64_tr_b16 a[222:223], v14 offset:6656
    buffer_load_dwordx4 v7, s[40:43], s77 offen offset:2048  lds
    s_waitcnt lgkmcnt(15)
    v_mfma_f32_32x32x16_bf16 v[32:47], a[160:163], a[24:27], v[32:47]
    s_waitcnt vmcnt(11)
    s_barrier
    ds_read_b64_tr_b16 a[224:225], v9 offset:16384
    ds_read_b64_tr_b16 a[226:227], v9 offset:16896
    buffer_load_dwordx4 v8, s[40:43], s77 offen offset:3072  lds
    v_mfma_f32_32x32x16_bf16 v[48:63], a[164:167], a[24:27], v[48:63]
    s_add_u32 m0, s60, 28672
    ds_read_b64_tr_b16 a[228:229], v12 offset:16384
    ds_read_b64_tr_b16 a[230:231], v12 offset:16896
    ds_read_b128 a[32:35], v164 offset:0
    buffer_load_dword v196, off, s[24:27], 0 sc1
    v_mfma_f32_32x32x16_bf16 v[64:79], a[168:171], a[24:27], v[64:79]
    ds_read_b64_tr_b16 a[232:233], v9 offset:18432
    ds_read_b64_tr_b16 a[234:235], v9 offset:18944
    ds_read_b128 a[36:39], v165 offset:0
    buffer_load_dwordx4 v5, s[36:39], s77 offen offset:0  lds
    v_mfma_f32_32x32x16_bf16 v[80:95], a[172:175], a[24:27], v[80:95]
    ds_read_b64_tr_b16 a[236:237], v12 offset:18432
    ds_read_b64_tr_b16 a[238:239], v12 offset:18944
    ds_read_b128 a[40:43], v166 offset:0
    v_mfma_f32_32x32x16_bf16 v[96:111], a[176:179], a[24:27], v[96:111]
    ds_read_b64_tr_b16 a[240:241], v9 offset:20480
    ds_read_b64_tr_b16 a[242:243], v9 offset:20992
    ds_read_b128 a[44:47], v167 offset:0
    buffer_load_dwordx4 v6, s[36:39], s77 offen offset:1024  lds
    v_mfma_f32_32x32x16_bf16 v[112:127], a[180:183], a[24:27], v[112:127]
    ds_read_b64_tr_b16 a[244:245], v12 offset:20480
    ds_read_b64_tr_b16 a[246:247], v12 offset:20992
    v_mfma_f32_32x32x16_bf16 v[128:143], a[184:187], a[24:27], v[128:143]
    ds_read_b64_tr_b16 a[248:249], v9 offset:22528
    ds_read_b64_tr_b16 a[250:251], v9 offset:23040
    buffer_load_dwordx4 v5, s[40:43], s77 offen offset:2048  lds
    v_mfma_f32_32x32x16_bf16 v[144:159], a[188:191], a[24:27], v[144:159]
    ds_read_b64_tr_b16 a[252:253], v12 offset:22528
    ds_read_b64_tr_b16 a[254:255], v12 offset:23040
    s_waitcnt lgkmcnt(15)
    v_mfma_f32_32x32x16_bf16 v[32:47], a[192:195], a[28:31], v[32:47]
    ds_read_b64_tr_b16 a[160:161], v9 offset:57344
    ds_read_b64_tr_b16 a[162:163], v9 offset:57856
    buffer_load_dwordx4 v6, s[40:43], s77 offen offset:3072  lds
    v_mfma_f32_32x32x16_bf16 v[48:63], a[196:199], a[28:31], v[48:63]
    s_add_u32 m0, s60, 0
    ds_read_b64_tr_b16 a[164:165], v12 offset:57344
    ds_read_b64_tr_b16 a[166:167], v12 offset:57856
    v_mfma_f32_32x32x16_bf16 v[64:79], a[200:203], a[28:31], v[64:79]
    ds_read_b64_tr_b16 a[168:169], v9 offset:59392
    ds_read_b64_tr_b16 a[170:171], v9 offset:59904
    buffer_load_dwordx4 v7, s[36:39], s78 offen offset:0  lds
    v_mfma_f32_32x32x16_bf16 v[80:95], a[204:207], a[28:31], v[80:95]
    ds_read_b64_tr_b16 a[172:173], v12 offset:59392
    ds_read_b64_tr_b16 a[174:175], v12 offset:59904
    v_mfma_f32_32x32x16_bf16 v[96:111], a[208:211], a[28:31], v[96:111]
    ds_read_b64_tr_b16 a[176:177], v9 offset:61440
    ds_read_b64_tr_b16 a[178:179], v9 offset:61952
    buffer_load_dwordx4 v8, s[36:39], s78 offen offset:1024  lds
    v_mfma_f32_32x32x16_bf16 v[112:127], a[212:215], a[28:31], v[112:127]
    ds_read_b64_tr_b16 a[180:181], v12 offset:61440
    ds_read_b64_tr_b16 a[182:183], v12 offset:61952
    v_mfma_f32_32x32x16_bf16 v[128:143], a[216:219], a[28:31], v[128:143]
    ds_read_b64_tr_b16 a[184:185], v9 offset:63488
    ds_read_b64_tr_b16 a[186:187], v9 offset:64000
    buffer_load_dwordx4 v7, s[40:43], s78 offen offset:2048  lds
    v_mfma_f32_32x32x16_bf16 v[144:159], a[220:223], a[28:31], v[144:159]
    ds_read_b64_tr_b16 a[188:189], v12 offset:63488
    ds_read_b64_tr_b16 a[190:191], v12 offset:64000
    s_waitcnt lgkmcnt(15)
    v_mfma_f32_32x32x16_bf16 v[32:47], a[224:227], a[32:35], v[32:47]
    ds_read_b64_tr_b16 a[192:193], v10 offset:32768
    ds_read_b64_tr_b16 a[194:195], v10 offset:33280
    buffer_load_dwordx4 v8, s[40:43], s78 offen offset:3072  lds
    v_mfma_f32_32x32x16_bf16 v[48:63], a[228:231], a[32:35], v[48:63]
    s_add_u32 m0, s60, 4096
    ds_read_b64_tr_b16 a[196:197], v13 offset:32768
    ds_read_b64_tr_b16 a[198:199], v13 offset:33280
    v_mfma_f32_32x32x16_bf16 v[64:79], a[232:235], a[32:35], v[64:79]
    ds_read_b64_tr_b16 a[200:201], v10 offset:34816
    ds_read_b64_tr_b16 a[202:203], v10 offset:35328
    buffer_load_dwordx4 v5, s[36:39], s78 offen offset:0  lds
    v_mfma_f32_32x32x16_bf16 v[80:95], a[236:239], a[32:35], v[80:95]
    ds_read_b64_tr_b16 a[204:205], v13 offset:34816
    ds_read_b64_tr_b16 a[206:207], v13 offset:35328
    v_mfma_f32_32x32x16_bf16 v[96:111], a[240:243], a[32:35], v[96:111]
    ds_read_b64_tr_b16 a[208:209], v10 offset:36864
    ds_read_b64_tr_b16 a[210:211], v10 offset:37376
    buffer_load_dwordx4 v6, s[36:39], s78 offen offset:1024  lds
    v_mfma_f32_32x32x16_bf16 v[112:127], a[244:247], a[32:35], v[112:127]
    ds_read_b64_tr_b16 a[212:213], v13 offset:36864
    ds_read_b64_tr_b16 a[214:215], v13 offset:37376
    v_mfma_f32_32x32x16_bf16 v[128:143], a[248:251], a[32:35], v[128:143]
    ds_read_b64_tr_b16 a[216:217], v10 offset:38912
    ds_read_b64_tr_b16 a[218:219], v10 offset:39424
    buffer_load_dwordx4 v5, s[40:43], s78 offen offset:2048  lds
    v_mfma_f32_32x32x16_bf16 v[144:159], a[252:255], a[32:35], v[144:159]
    ds_read_b64_tr_b16 a[220:221], v13 offset:38912
    ds_read_b64_tr_b16 a[222:223], v13 offset:39424
    s_waitcnt lgkmcnt(15)
    v_mfma_f32_32x32x16_bf16 v[32:47], a[160:163], a[36:39], v[32:47]
    ds_read_b64_tr_b16 a[224:225], v11 offset:8192
    ds_read_b64_tr_b16 a[226:227], v11 offset:8704
    buffer_load_dwordx4 v6, s[40:43], s78 offen offset:3072  lds
    v_mfma_f32_32x32x16_bf16 v[48:63], a[164:167], a[36:39], v[48:63]
    s_add_u32 m0, s60, 32768
    s_mul_hi_u32 s5, s78, s61
    ds_read_b64_tr_b16 a[228:229], v14 offset:8192
    ds_read_b64_tr_b16 a[230:231], v14 offset:8704
    v_mfma_f32_32x32x16_bf16 v[64:79], a[168:171], a[36:39], v[64:79]
    ds_read_b64_tr_b16 a[232:233], v11 offset:10240
    ds_read_b64_tr_b16 a[234:235], v11 offset:10752
    buffer_load_dwordx4 v160, s[28:31], s5 offen offset:0  lds
    v_mfma_f32_32x32x16_bf16 v[80:95], a[172:175], a[36:39], v[80:95]
    ds_read_b64_tr_b16 a[236:237], v14 offset:10240
    ds_read_b64_tr_b16 a[238:239], v14 offset:10752
    v_mfma_f32_32x32x16_bf16 v[96:111], a[176:179], a[36:39], v[96:111]
    ds_read_b64_tr_b16 a[240:241], v11 offset:12288
    ds_read_b64_tr_b16 a[242:243], v11 offset:12800
    buffer_load_dwordx4 v161, s[28:31], s5 offen offset:1024  lds
    v_mfma_f32_32x32x16_bf16 v[112:127], a[180:183], a[36:39], v[112:127]
    ds_read_b64_tr_b16 a[244:245], v14 offset:12288
    ds_read_b64_tr_b16 a[246:247], v14 offset:12800
    v_mfma_f32_32x32x16_bf16 v[128:143], a[184:187], a[36:39], v[128:143]
    ds_read_b64_tr_b16 a[248:249], v11 offset:14336
    ds_read_b64_tr_b16 a[250:251], v11 offset:14848
    buffer_load_dwordx4 v162, s[28:31], s5 offen offset:2048  lds
    v_mfma_f32_32x32x16_bf16 v[144:159], a[188:191], a[36:39], v[144:159]
    ds_read_b64_tr_b16 a[252:253], v14 offset:14336
    ds_read_b64_tr_b16 a[254:255], v14 offset:14848
    s_waitcnt lgkmcnt(15)
    v_mfma_f32_32x32x16_bf16 v[32:47], a[192:195], a[40:43], v[32:47]
    s_waitcnt vmcnt(11)
    s_barrier
    ds_read_b64_tr_b16 a[160:161], v9 offset:24576
    ds_read_b64_tr_b16 a[162:163], v9 offset:25088
    buffer_load_dwordx4 v163, s[28:31], s5 offen offset:3072  lds
    v_mfma_f32_32x32x16_bf16 v[48:63], a[196:199], a[40:43], v[48:63]
    s_add_u32 m0, s60, 8192
    ds_read_b64_tr_b16 a[164:165], v12 offset:24576
    ds_read_b64_tr_b16 a[166:167], v12 offset:25088
    ds_read_b128 a[48:51], v164 offset:4096
    v_readfirstlane_b32 s98, v196
    s_cmp_ge_u32 s98, 4194304
    s_cbranch_scc0 SPIN21
RET21:
    v_mfma_f32_32x32x16_bf16 v[64:79], a[200:203], a[40:43], v[64:79]
    ds_read_b64_tr_b16 a[168:169], v9 offset:26624
    ds_read_b64_tr_b16 a[170:171], v9 offset:27136
    ds_read_b128 a[52:55], v165 offset:4096
    buffer_load_dwordx4 v7, s[36:39], s79 offen offset:0  lds
    s_lshl_b32 s7, s3, 8
    s_add_u32 s7, s7, s62
    s_cmp_eq_u32 s86, 2146435072
    s_cselect_b32 s7, s86, s7
    s_cmp_ge_u32 s3, 4
    s_cselect_b32 s7, 2146435072, s7
    v_cmp_gt_u32 vcc, 32, v0
    v_lshlrev_b32 v30, 2, v0
    s_nop 0
    v_cndmask_b32 v212, v216, v212, vcc
    buffer_atomic_add_f32 v212, v30, s[44:47], s7 offen offset:0
    v_mfma_f32_32x32x16_bf16 v[80:95], a[204:207], a[40:43], v[80:95]
    ds_read_b64_tr_b16 a[172:173], v12 offset:26624
    ds_read_b64_tr_b16 a[174:175], v12 offset:27136
    ds_read_b128 a[56:59], v166 offset:4096
    s_cmp_eq_u32 s86, 2146435072
    s_cselect_b32 s7, s86, s62
    v_cndmask_b32 v18, v22, v18, vcc
    buffer_atomic_add_f32 v18, v30, s[44:47], s7 offen offset:1024
    buffer_atomic_add_f32 v26, v30, s[44:47], s7 offen offset:1280
    v_mfma_f32_32x32x16_bf16 v[96:111], a[208:211], a[40:43], v[96:111]
    ds_read_b64_tr_b16 a[176:177], v9 offset:28672
    ds_read_b64_tr_b16 a[178:179], v9 offset:29184
    ds_read_b128 a[60:63], v167 offset:4096
    buffer_load_dwordx4 v8, s[36:39], s79 offen offset:1024  lds
    s_cmp_eq_u32 s85, 2146435072
    s_cselect_b32 s7, s85, s63
    buffer_atomic_add_f32 v197, v30, s[44:47], s7 offen
    v_mfma_f32_32x32x16_bf16 v[112:127], a[212:215], a[40:43], v[112:127]
    ds_read_b64_tr_b16 a[180:181], v12 offset:28672
    ds_read_b64_tr_b16 a[182:183], v12 offset:29184
    v_mfma_f32_32x32x16_bf16 v[128:143], a[216:219], a[40:43], v[128:143]
    ds_read_b64_tr_b16 a[184:185], v9 offset:30720
    ds_read_b64_tr_b16 a[186:187], v9 offset:31232
    buffer_load_dwordx4 v7, s[40:43], s79 offen offset:2048  lds
    v_mfma_f32_32x32x16_bf16 v[144:159], a[220:223], a[40:43], v[144:159]
    ds_read_b64_tr_b16 a[188:189], v12 offset:30720
    ds_read_b64_tr_b16 a[190:191], v12 offset:31232
    s_waitcnt lgkmcnt(15)
    v_mfma_f32_32x32x16_bf16 v[32:47], a[224:227], a[44:47], v[32:47]
    ds_read_b64_tr_b16 a[192:193], v10 offset:0
    ds_read_b64_tr_b16 a[194:195], v10 offset:512
    buffer_load_dwordx4 v8, s[40:43], s79 offen offset:3072  lds
    v_mfma_f32_32x32x16_bf16 v[48:63], a[228:231], a[44:47], v[48:63]
    s_add_u32 m0, s60, 12288
    ds_read_b64_tr_b16 a[196:197], v13 offset:0
    ds_read_b64_tr_b16 a[198:199], v13 offset:512
    v_mfma_f32_32x32x16_bf16 v[64:79], a[232:235], a[44:47], v[64:79]
    ds_read_b64_tr_b16 a[200:201], v10 offset:2048
    ds_read_b64_tr_b16 a[202:203], v10 offset:2560
    buffer_load_dwordx4 v5, s[36:39], s79 offen offset:0  lds
    v_mfma_f32_32x32x16_bf16 v[80:95], a[236:239], a[44:47], v[80:95]
    ds_read_b64_tr_b16 a[204:205], v13 offset:2048
    ds_read_b64_tr_b16 a[206:207], v13 offset:2560
    v_mfma_f32_32x32x16_bf16 v[96:111], a[240:243], a[44:47], v[96:111]
    ds_read_b64_tr_b16 a[208:209], v10 offset:4096
    ds_read_b64_tr_b16 a[210:211], v10 offset:4608
    buffer_load_dwordx4 v6, s[36:39], s79 offen offset:1024  lds
    v_mfma_f32_32x32x16_bf16 v[112:127], a[244:247], a[44:47], v[112:127]
    ds_read_b64_tr_b16 a[212:213], v13 offset:4096
    ds_read_b64_tr_b16 a[214:215], v13 offset:4608
    v_mfma_f32_32x32x16_bf16 v[128:143], a[248:251], a[44:47], v[128:143]
    ds_read_b64_tr_b16 a[216:217], v10 offset:6144
    ds_read_b64_tr_b16 a[218:219], v10 offset:6656
    buffer_load_dwordx4 v5, s[40:43], s79 offen offset:2048  lds
    v_mfma_f32_32x32x16_bf16 v[144:159], a[252:255], a[44:47], v[144:159]
    ds_read_b64_tr_b16 a[220:221], v13 offset:6144
    ds_read_b64_tr_b16 a[222:223], v13 offset:6656
    s_waitcnt lgkmcnt(15)
    v_mfma_f32_32x32x16_bf16 v[32:47], a[160:163], a[48:51], v[32:47]
    ds_read_b64_tr_b16 a[224:225], v10 offset:40960
    ds_read_b64_tr_b16 a[226:227], v10 offset:41472
    buffer_load_dwordx4 v6, s[40:43], s79 offen offset:3072  lds
    v_mfma_f32_32x32x16_bf16 v[48:63], a[164:167], a[48:51], v[48:63]
    s_add_u32 m0, s60, 36864
    s_mul_hi_u32 s5, s79, s61
    ds_read_b64_tr_b16 a[228:229], v13 offset:40960
    ds_read_b64_tr_b16 a[230:231], v13 offset:41472
    v_mfma_f32_32x32x16_bf16 v[64:79], a[168:171], a[48:51], v[64:79]
    ds_read_b64_tr_b16 a[232:233], v10 offset:43008
    ds_read_b64_tr_b16 a[234:235], v10 offset:43520
    buffer_load_dwordx4 v160, s[28:31], s5 offen offset:0  lds
    v_mfma_f32_32x32x16_bf16 v[80:95], a[172:175], a[48:51], v[80:95]
    ds_read_b64_tr_b16 a[236:237], v13 offset:43008
    ds_read_b64_tr_b16 a[238:239], v13 offset:43520
    v_mfma_f32_32x32x16_bf16 v[96:111], a[176:179], a[48:51], v[96:111]
    ds_read_b64_tr_b16 a[240:241], v10 offset:45056
    ds_read_b64_tr_b16 a[242:243], v10 offset:45568
    buffer_load_dwordx4 v161, s[28:31], s5 offen offset:1024  lds
    v_mfma_f32_32x32x16_bf16 v[112:127], a[180:183], a[48:51], v[112:127]
    ds_read_b64_tr_b16 a[244:245], v13 offset:45056
    ds_read_b64_tr_b16 a[246:247], v13 offset:45568
    v_mfma_f32_32x32x16_bf16 v[128:143], a[184:187], a[48:51], v[128:143]
    ds_read_b64_tr_b16 a[248:249], v10 offset:47104
    ds_read_b64_tr_b16 a[250:251], v10 offset:47616
    buffer_load_dwordx4 v162, s[28:31], s5 offen offset:2048  lds
    v_mfma_f32_32x32x16_bf16 v[144:159], a[188:191], a[48:51], v[144:159]
    ds_read_b64_tr_b16 a[252:253], v13 offset:47104
    ds_read_b64_tr_b16 a[254:255], v13 offset:47616
    s_waitcnt lgkmcnt(15)
    v_mfma_f32_32x32x16_bf16 v[32:47], a[192:195], a[52:55], v[32:47]
    ds_read_b64_tr_b16 a[160:161], v11 offset:16384
    ds_read_b64_tr_b16 a[162:163], v11 offset:16896
    buffer_load_dwordx4 v163, s[28:31], s5 offen offset:3072  lds
    v_mfma_f32_32x32x16_bf16 v[48:63], a[196:199], a[52:55], v[48:63]
    ds_read_b64_tr_b16 a[164:165], v14 offset:16384
    ds_read_b64_tr_b16 a[166:167], v14 offset:16896
    v_mfma_f32_32x32x16_bf16 v[64:79], a[200:203], a[52:55], v[64:79]
    ds_read_b64_tr_b16 a[168:169], v11 offset:18432
    ds_read_b64_tr_b16 a[170:171], v11 offset:18944
    v_mfma_f32_32x32x16_bf16 v[80:95], a[204:207], a[52:55], v[80:95]
    ds_read_b64_tr_b16 a[172:173], v14 offset:18432
    ds_read_b64_tr_b16 a[174:175], v14 offset:18944
    v_mfma_f32_32x32x16_bf16 v[96:111], a[208:211], a[52:55], v[96:111]
    ds_read_b64_tr_b16 a[176:177], v11 offset:20480
    ds_read_b64_tr_b16 a[178:179], v11 offset:20992
    v_mfma_f32_32x32x16_bf16 v[112:127], a[212:215], a[52:55], v[112:127]
    ds_read_b64_tr_b16 a[180:181], v14 offset:20480
    ds_read_b64_tr_b16 a[182:183], v14 offset:20992
    v_mfma_f32_32x32x16_bf16 v[128:143], a[216:219], a[52:55], v[128:143]
    ds_read_b64_tr_b16 a[184:185], v11 offset:22528
    ds_read_b64_tr_b16 a[186:187], v11 offset:23040
    v_mfma_f32_32x32x16_bf16 v[144:159], a[220:223], a[52:55], v[144:159]
    ds_read_b64_tr_b16 a[188:189], v14 offset:22528
    ds_read_b64_tr_b16 a[190:191], v14 offset:23040
    s_waitcnt lgkmcnt(15)
    v_mfma_f32_32x32x16_bf16 v[32:47], a[224:227], a[56:59], v[32:47]
    s_waitcnt vmcnt(10)
    s_barrier
    s_add_u32 m0, s60, 16384
    ds_read_b64_tr_b16 a[192:193], v9 offset:0
    ds_read_b64_tr_b16 a[194:195], v9 offset:512
    buffer_load_dwordx4 v7, s[36:39], s80 offen offset:0  lds
    v_mfma_f32_32x32x16_bf16 v[48:63], a[228:231], a[56:59], v[48:63]
    ds_read_b64_tr_b16 a[196:197], v12 offset:0
    ds_read_b64_tr_b16 a[198:199], v12 offset:512
    ds_read_b128 a[64:67], v164 offset:0
    s_cmp_eq_u32 s3, 0
    s_cselect_b32 s7, s85, 2146435072
    v_lshlrev_b32 v200, 8, v0
    s_mov_b64 exec, 0xffff
    buffer_atomic_add v11, v200, s[44:47], s7 offen offset:4 sc1
    s_mov_b64 exec, -1
    v_mfma_f32_32x32x16_bf16 v[64:79], a[232:235], a[56:59], v[64:79]
    ds_read_b64_tr_b16 a[200:201], v9 offset:2048
    ds_read_b64_tr_b16 a[202:203], v9 offset:2560
    ds_read_b128 a[68:71], v165 offset:0
    buffer_load_dwordx4 v8, s[36:39], s80 offen offset:1024  lds
    s_cmp_eq_u32 s3, 0
    s_cselect_b32 s7, s86, 2146435072
    v_lshlrev_b32 v200, 12, v0
    s_mov_b64 exec, 0xffff
    buffer_atomic_add v11, v200, s[44:47], s7 offen offset:4 sc1
    s_mov_b64 exec, -1
    v_mfma_f32_32x32x16_bf16 v[80:95], a[236:239], a[56:59], v[80:95]
    ds_read_b64_tr_b16 a[204:205], v12 offset:2048
    ds_read_b64_tr_b16 a[206:207], v12 offset:2560
    ds_read_b128 a[72:75], v166 offset:0
    s_mov_b32 s7, 13926400
    s_cmp_lt_u32 s2, 170
    s_cselect_b32 s7, s7, 2146435072
    s_cmp_eq_u32 s3, 0
    s_cselect_b32 s7, s7, 2146435072
    s_mov_b64 exec, 0xffff
    buffer_atomic_add v11, v175, s[44:47], s7 offen offset:0 sc1
    s_mov_b64 exec, -1
    v_mfma_f32_32x32x16_bf16 v[96:111], a[240:243], a[56:59], v[96:111]
    ds_read_b64_tr_b16 a[208:209], v9 offset:4096
    ds_read_b64_tr_b16 a[210:211], v9 offset:4608
    ds_read_b128 a[76:79], v167 offset:0
    buffer_load_dwordx4 v7, s[40:43], s80 offen offset:2048  lds
    v_mfma_f32_32x32x16_bf16 v[112:127], a[244:247], a[56:59], v[112:127]
    ds_read_b64_tr_b16 a[212:213], v12 offset:4096
    ds_read_b64_tr_b16 a[214:215], v12 offset:4608
    v_mfma_f32_32x32x16_bf16 v[128:143], a[248:251], a[56:59], v[128:143]
    ds_read_b64_tr_b16 a[216:217], v9 offset:6144
    ds_read_b64_tr_b16 a[218:219], v9 offset:6656
    buffer_load_dwordx4 v8, s[40:43], s80 offen offset:3072  lds
    v_mfma_f32_32x32x16_bf16 v[144:159], a[252:255], a[56:59], v[144:159]
    s_add_u32 m0, s60, 20480
    ds_read_b64_tr_b16 a[220:221], v12 offset:6144
    ds_read_b64_tr_b16 a[222:223], v12 offset:6656
    s_waitcnt lgkmcnt(15)
    v_mfma_f32_32x32x16_bf16 v[32:47], a[160:163], a[60:63], v[32:47]
    ds_read_b64_tr_b16 a[224:225], v9 offset:40960
    ds_read_b64_tr_b16 a[226:227], v9 offset:41472
    buffer_load_dwordx4 v5, s[36:39], s80 offen offset:0  lds
    v_mfma_f32_32x32x16_bf16 v[48:63], a[164:167], a[60:63], v[48:63]
    ds_read_b64_tr_b16 a[228:229], v12 offset:40960
    ds_read_b64_tr_b16 a[230:231], v12 offset:41472
    v_mfma_f32_32x32x16_bf16 v[64:79], a[168:171], a[60:63], v[64:79]
    ds_read_b64_tr_b16 a[232:233], v9 offset:43008
    ds_read_b64_tr_b16 a[234:235], v9 offset:43520
    buffer_load_dwordx4 v6, s[36:39], s80 offen offset:1024  lds
    v_mfma_f32_32x32x16_bf16 v[80:95], a[172:175], a[60:63], v[80:95]
    ds_read_b64_tr_b16 a[236:237], v12 offset:43008
    ds_read_b64_tr_b16 a[238:239], v12 offset:43520
    v_mfma_f32_32x32x16_bf16 v[96:111], a[176:179], a[60:63], v[96:111]
    ds_read_b64_tr_b16 a[240:241], v9 offset:45056
    ds_read_b64_tr_b16 a[242:243], v9 offset:45568
    buffer_load_dwordx4 v5, s[40:43], s80 offen offset:2048  lds
    v_mfma_f32_32x32x16_bf16 v[112:127], a[180:183], a[60:63], v[112:127]
    ds_read_b64_tr_b16 a[244:245], v12 offset:45056
    ds_read_b64_tr_b16 a[246:247], v12 offset:45568
    v_mfma_f32_32x32x16_bf16 v[128:143], a[184:187], a[60:63], v[128:143]
    ds_read_b64_tr_b16 a[248:249], v9 offset:47104
    ds_read_b64_tr_b16 a[250:251], v9 offset:47616
    buffer_load_dwordx4 v6, s[40:43], s80 offen offset:3072  lds
    v_mfma_f32_32x32x16_bf16 v[144:159], a[188:191], a[60:63], v[144:159]
    ds_read_b64_tr_b16 a[252:253], v12 offset:47104
    ds_read_b64_tr_b16 a[254:255], v12 offset:47616
    s_waitcnt lgkmcnt(15)
    v_mfma_f32_32x32x16_bf16 v[32:47], a[192:195], a[64:67], v[32:47]
    s_add_u32 m0, s60, 32768
    s_mul_hi_u32 s5, s80, s61
    ds_read_b64_tr_b16 a[160:161], v10 offset:16384
    ds_read_b64_tr_b16 a[162:163], v10 offset:16896
    buffer_load_dwordx4 v160, s[28:31], s5 offen offset:0  lds
    v_mfma_f32_32x32x16_bf16 v[48:63], a[196:199], a[64:67], v[48:63]
    ds_read_b64_tr_b16 a[164:165], v13 offset:16384
    ds_read_b64_tr_b16 a[166:167], v13 offset:16896
    v_mfma_f32_32x32x16_bf16 v[64:79], a[200:203], a[64:67], v[64:79]
    ds_read_b64_tr_b16 a[168:169], v10 offset:18432
    ds_read_b64_tr_b16 a[170:171], v10 offset:18944
    buffer_load_dwordx4 v161, s[28:31], s5 offen offset:1024  lds
    v_mfma_f32_32x32x16_bf16 v[80:95], a[204:207], a[64:67], v[80:95]
    ds_read_b64_tr_b16 a[172:173], v13 offset:18432
    ds_read_b64_tr_b16 a[174:175], v13 offset:18944
    v_mfma_f32_32x32x16_bf16 v[96:111], a[208:211], a[64:67], v[96:111]
    ds_read_b64_tr_b16 a[176:177], v10 offset:20480
    ds_read_b64_tr_b16 a[178:179], v10 offset:20992
    buffer_load_dwordx4 v162, s[28:31], s5 offen offset:2048  lds
    v_mfma_f32_32x32x16_bf16 v[112:127], a[212:215], a[64:67], v[112:127]
    ds_read_b64_tr_b16 a[180:181], v13 offset:20480
    ds_read_b64_tr_b16 a[182:183], v13 offset:20992
    v_mfma_f32_32x32x16_bf16 v[128:143], a[216:219], a[64:67], v[128:143]
    ds_read_b64_tr_b16 a[184:185], v10 offset:22528
    ds_read_b64_tr_b16 a[186:187], v10 offset:23040
    buffer_load_dwordx4 v163, s[28:31], s5 offen offset:3072  lds
    v_mfma_f32_32x32x16_bf16 v[144:159], a[220:223], a[64:67], v[144:159]
    ds_read_b64_tr_b16 a[188:189], v13 offset:22528
    ds_read_b64_tr_b16 a[190:191], v13 offset:23040
    s_waitcnt lgkmcnt(15)
    v_mfma_f32_32x32x16_bf16 v[32:47], a[224:227], a[68:71], v[32:47]
    ds_read_b64_tr_b16 a[192:193], v10 offset:57344
    ds_read_b64_tr_b16 a[194:195], v10 offset:57856
    v_mfma_f32_32x32x16_bf16 v[48:63], a[228:231], a[68:71], v[48:63]
    ds_read_b64_tr_b16 a[196:197], v13 offset:57344
    ds_read_b64_tr_b16 a[198:199], v13 offset:57856
    v_mfma_f32_32x32x16_bf16 v[64:79], a[232:235], a[68:71], v[64:79]
    ds_read_b64_tr_b16 a[200:201], v10 offset:59392
    ds_read_b64_tr_b16 a[202:203], v10 offset:59904
    v_mfma_f32_32x32x16_bf16 v[80:95], a[236:239], a[68:71], v[80:95]
    ds_read_b64_tr_b16 a[204:205], v13 offset:59392
    ds_read_b64_tr_b16 a[206:207], v13 offset:59904
    v_mfma_f32_32x32x16_bf16 v[96:111], a[240:243], a[68:71], v[96:111]
    ds_read_b64_tr_b16 a[208:209], v10 offset:61440
    ds_read_b64_tr_b16 a[210:211], v10 offset:61952
    v_mfma_f32_32x32x16_bf16 v[112:127], a[244:247], a[68:71], v[112:127]
    ds_read_b64_tr_b16 a[212:213], v13 offset:61440
    ds_read_b64_tr_b16 a[214:215], v13 offset:61952
    v_mfma_f32_32x32x16_bf16 v[128:143], a[248:251], a[68:71], v[128:143]
    ds_read_b64_tr_b16 a[216:217], v10 offset:63488
    ds_read_b64_tr_b16 a[218:219], v10 offset:64000
    v_mfma_f32_32x32x16_bf16 v[144:159], a[252:255], a[68:71], v[144:159]
    ds_read_b64_tr_b16 a[220:221], v13 offset:63488
    ds_read_b64_tr_b16 a[222:223], v13 offset:64000
    s_waitcnt lgkmcnt(15)
    v_mfma_f32_32x32x16_bf16 v[32:47], a[160:163], a[72:75], v[32:47]
    s_waitcnt vmcnt(15)
    s_barrier
    s_add_u32 m0, s60, 24576
    ds_read_b64_tr_b16 a[224:225], v9 offset:8192
    ds_read_b64_tr_b16 a[226:227], v9 offset:8704
    buffer_load_dwordx4 v7, s[36:39], s81 offen offset:0  lds
    v_mfma_f32_32x32x16_bf16 v[48:63], a[164:167], a[72:75], v[48:63]
    ds_read_b64_tr_b16 a[228:229], v12 offset:8192
    ds_read_b64_tr_b16 a[230:231], v12 offset:8704
    ds_read_b128 a[80:83], v164 offset:4096
    v_mfma_f32_32x32x16_bf16 v[64:79], a[168:171], a[72:75], v[64:79]
    ds_read_b64_tr_b16 a[232:233], v9 offset:10240
    ds_read_b64_tr_b16 a[234:235], v9 offset:10752
    ds_read_b128 a[84:87], v165 offset:4096
    buffer_load_dwordx4 v8, s[36:39], s81 offen offset:1024  lds
    v_mfma_f32_32x32x16_bf16 v[80:95], a[172:175], a[72:75], v[80:95]
    ds_read_b64_tr_b16 a[236:237], v12 offset:10240
    ds_read_b64_tr_b16 a[238:239], v12 offset:10752
    ds_read_b128 a[88:91], v166 offset:4096
    v_mfma_f32_32x32x16_bf16 v[96:111], a[176:179], a[72:75], v[96:111]
    ds_read_b64_tr_b16 a[240:241], v9 offset:12288
    ds_read_b64_tr_b16 a[242:243], v9 offset:12800
    ds_read_b128 a[92:95], v167 offset:4096
    buffer_load_dwordx4 v7, s[40:43], s81 offen offset:2048  lds
    v_mfma_f32_32x32x16_bf16 v[112:127], a[180:183], a[72:75], v[112:127]
    ds_read_b64_tr_b16 a[244:245], v12 offset:12288
    ds_read_b64_tr_b16 a[246:247], v12 offset:12800
    v_mfma_f32_32x32x16_bf16 v[128:143], a[184:187], a[72:75], v[128:143]
    ds_read_b64_tr_b16 a[248:249], v9 offset:14336
    ds_read_b64_tr_b16 a[250:251], v9 offset:14848
    buffer_load_dwordx4 v8, s[40:43], s81 offen offset:3072  lds
    v_mfma_f32_32x32x16_bf16 v[144:159], a[188:191], a[72:75], v[144:159]
    s_add_u32 m0, s60, 28672
    ds_read_b64_tr_b16 a[252:253], v12 offset:14336
    ds_read_b64_tr_b16 a[254:255], v12 offset:14848
    s_waitcnt lgkmcnt(15)
    v_mfma_f32_32x32x16_bf16 v[32:47], a[192:195], a[76:79], v[32:47]
    ds_read_b64_tr_b16 a[160:161], v9 offset:49152
    ds_read_b64_tr_b16 a[162:163], v9 offset:49664
    buffer_load_dwordx4 v5, s[36:39], s81 offen offset:0  lds
    v_mfma_f32_32x32x16_bf16 v[48:63], a[196:199], a[76:79], v[48:63]
    ds_read_b64_tr_b16 a[164:165], v12 offset:49152
    ds_read_b64_tr_b16 a[166:167], v12 offset:49664
    v_mfma_f32_32x32x16_bf16 v[64:79], a[200:203], a[76:79], v[64:79]
    ds_read_b64_tr_b16 a[168:169], v9 offset:51200
    ds_read_b64_tr_b16 a[170:171], v9 offset:51712
    buffer_load_dwordx4 v6, s[36:39], s81 offen offset:1024  lds
    v_mfma_f32_32x32x16_bf16 v[80:95], a[204:207], a[76:79], v[80:95]
    ds_read_b64_tr_b16 a[172:173], v12 offset:51200
    ds_read_b64_tr_b16 a[174:175], v12 offset:51712
    v_mfma_f32_32x32x16_bf16 v[96:111], a[208:211], a[76:79], v[96:111]
    ds_read_b64_tr_b16 a[176:177], v9 offset:53248
    ds_read_b64_tr_b16 a[178:179], v9 offset:53760
    buffer_load_dwordx4 v5, s[40:43], s81 offen offset:2048  lds
    v_mfma_f32_32x32x16_bf16 v[112:127], a[212:215], a[76:79], v[112:127]
    ds_read_b64_tr_b16 a[180:181], v12 offset:53248
    ds_read_b64_tr_b16 a[182:183], v12 offset:53760
    v_mfma_f32_32x32x16_bf16 v[128:143], a[216:219], a[76:79], v[128:143]
    ds_read_b64_tr_b16 a[184:185], v9 offset:55296
    ds_read_b64_tr_b16 a[186:187], v9 offset:55808
    buffer_load_dwordx4 v6, s[40:43], s81 offen offset:3072  lds
    v_mfma_f32_32x32x16_bf16 v[144:159], a[220:223], a[76:79], v[144:159]
    ds_read_b64_tr_b16 a[188:189], v12 offset:55296
    ds_read_b64_tr_b16 a[190:191], v12 offset:55808
    s_waitcnt lgkmcnt(15)
    v_mfma_f32_32x32x16_bf16 v[32:47], a[224:227], a[80:83], v[32:47]
    s_add_u32 m0, s60, 36864
    s_mul_hi_u32 s5, s81, s61
    ds_read_b64_tr_b16 a[192:193], v10 offset:24576
    ds_read_b64_tr_b16 a[194:195], v10 offset:25088
    buffer_load_dwordx4 v160, s[28:31], s5 offen offset:0  lds
    v_mfma_f32_32x32x16_bf16 v[48:63], a[228:231], a[80:83], v[48:63]
    ds_read_b64_tr_b16 a[196:197], v13 offset:24576
    ds_read_b64_tr_b16 a[198:199], v13 offset:25088
    v_mfma_f32_32x32x16_bf16 v[64:79], a[232:235], a[80:83], v[64:79]
    ds_read_b64_tr_b16 a[200:201], v10 offset:26624
    ds_read_b64_tr_b16 a[202:203], v10 offset:27136
    buffer_load_dwordx4 v161, s[28:31], s5 offen offset:1024  lds
    v_mfma_f32_32x32x16_bf16 v[80:95], a[236:239], a[80:83], v[80:95]
    ds_read_b64_tr_b16 a[204:205], v13 offset:26624
    ds_read_b64_tr_b16 a[206:207], v13 offset:27136
    v_mfma_f32_32x32x16_bf16 v[96:111], a[240:243], a[80:83], v[96:111]
    ds_read_b64_tr_b16 a[208:209], v10 offset:28672
    ds_read_b64_tr_b16 a[210:211], v10 offset:29184
    buffer_load_dwordx4 v162, s[28:31], s5 offen offset:2048  lds
    v_mfma_f32_32x32x16_bf16 v[112:127], a[244:247], a[80:83], v[112:127]
    ds_read_b64_tr_b16 a[212:213], v13 offset:28672
    ds_read_b64_tr_b16 a[214:215], v13 offset:29184
    v_mfma_f32_32x32x16_bf16 v[128:143], a[248:251], a[80:83], v[128:143]
    ds_read_b64_tr_b16 a[216:217], v10 offset:30720
    ds_read_b64_tr_b16 a[218:219], v10 offset:31232
    buffer_load_dwordx4 v163, s[28:31], s5 offen offset:3072  lds
    v_mfma_f32_32x32x16_bf16 v[144:159], a[252:255], a[80:83], v[144:159]
    ds_read_b64_tr_b16 a[220:221], v13 offset:30720
    ds_read_b64_tr_b16 a[222:223], v13 offset:31232
    s_waitcnt lgkmcnt(15)
    v_mfma_f32_32x32x16_bf16 v[32:47], a[160:163], a[84:87], v[32:47]
    ds_read_b64_tr_b16 a[224:225], v11 offset:0
    ds_read_b64_tr_b16 a[226:227], v11 offset:512
    v_mfma_f32_32x32x16_bf16 v[48:63], a[164:167], a[84:87], v[48:63]
    ds_read_b64_tr_b16 a[228:229], v14 offset:0
    ds_read_b64_tr_b16 a[230:231], v14 offset:512
    v_mfma_f32_32x32x16_bf16 v[64:79], a[168:171], a[84:87], v[64:79]
    ds_read_b64_tr_b16 a[232:233], v11 offset:2048
    ds_read_b64_tr_b16 a[234:235], v11 offset:2560
    v_mfma_f32_32x32x16_bf16 v[80:95], a[172:175], a[84:87], v[80:95]
    ds_read_b64_tr_b16 a[236:237], v14 offset:2048
    ds_read_b64_tr_b16 a[238:239], v14 offset:2560
    v_mfma_f32_32x32x16_bf16 v[96:111], a[176:179], a[84:87], v[96:111]
    ds_read_b64_tr_b16 a[240:241], v11 offset:4096
    ds_read_b64_tr_b16 a[242:243], v11 offset:4608
    v_mfma_f32_32x32x16_bf16 v[112:127], a[180:183], a[84:87], v[112:127]
    ds_read_b64_tr_b16 a[244:245], v14 offset:4096
    ds_read_b64_tr_b16 a[246:247], v14 offset:4608
    v_mfma_f32_32x32x16_bf16 v[128:143], a[184:187], a[84:87], v[128:143]
    ds_read_b64_tr_b16 a[248:249], v11 offset:6144
    ds_read_b64_tr_b16 a[250:251], v11 offset:6656
    v_mfma_f32_32x32x16_bf16 v[144:159], a[188:191], a[84:87], v[144:159]
    ds_read_b64_tr_b16 a[252:253], v14 offset:6144
    ds_read_b64_tr_b16 a[254:255], v14 offset:6656
    s_waitcnt lgkmcnt(15)
    v_mfma_f32_32x32x16_bf16 v[32:47], a[192:195], a[88:91], v[32:47]
    s_waitcnt vmcnt(12)
    s_barrier
    s_add_u32 m0, s60, 0
    ds_read_b64_tr_b16 a[160:161], v9 offset:16384
    ds_read_b64_tr_b16 a[162:163], v9 offset:16896
    buffer_load_dwordx4 v7, s[36:39], s82 offen offset:0  lds
    v_mfma_f32_32x32x16_bf16 v[48:63], a[196:199], a[88:91], v[48:63]
    ds_read_b64_tr_b16 a[164:165], v12 offset:16384
    ds_read_b64_tr_b16 a[166:167], v12 offset:16896
    ds_read_b128 a[96:99], v164 offset:0
    v_mfma_f32_32x32x16_bf16 v[64:79], a[200:203], a[88:91], v[64:79]
    ds_read_b64_tr_b16 a[168:169], v9 offset:18432
    ds_read_b64_tr_b16 a[170:171], v9 offset:18944
    ds_read_b128 a[100:103], v165 offset:0
    buffer_load_dwordx4 v8, s[36:39], s82 offen offset:1024  lds
    v_mfma_f32_32x32x16_bf16 v[80:95], a[204:207], a[88:91], v[80:95]
    ds_read_b64_tr_b16 a[172:173], v12 offset:18432
    ds_read_b64_tr_b16 a[174:175], v12 offset:18944
    ds_read_b128 a[104:107], v166 offset:0
    v_mfma_f32_32x32x16_bf16 v[96:111], a[208:211], a[88:91], v[96:111]
    ds_read_b64_tr_b16 a[176:177], v9 offset:20480
    ds_read_b64_tr_b16 a[178:179], v9 offset:20992
    ds_read_b128 a[108:111], v167 offset:0
    buffer_load_dwordx4 v7, s[40:43], s82 offen offset:2048  lds
    v_mfma_f32_32x32x16_bf16 v[112:127], a[212:215], a[88:91], v[112:127]
    ds_read_b64_tr_b16 a[180:181], v12 offset:20480
    ds_read_b64_tr_b16 a[182:183], v12 offset:20992
    v_mfma_f32_32x32x16_bf16 v[128:143], a[216:219], a[88:91], v[128:143]
    ds_read_b64_tr_b16 a[184:185], v9 offset:22528
    ds_read_b64_tr_b16 a[186:187], v9 offset:23040
    buffer_load_dwordx4 v8, s[40:43], s82 offen offset:3072  lds
    v_mfma_f32_32x32x16_bf16 v[144:159], a[220:223], a[88:91], v[144:159]
    s_add_u32 m0, s60, 4096
    ds_read_b64_tr_b16 a[188:189], v12 offset:22528
    ds_read_b64_tr_b16 a[190:191], v12 offset:23040
    s_waitcnt lgkmcnt(15)
    v_mfma_f32_32x32x16_bf16 v[32:47], a[224:227], a[92:95], v[32:47]
    ds_read_b64_tr_b16 a[192:193], v9 offset:57344
    ds_read_b64_tr_b16 a[194:195], v9 offset:57856
    buffer_load_dwordx4 v5, s[36:39], s82 offen offset:0  lds
    v_mfma_f32_32x32x16_bf16 v[48:63], a[228:231], a[92:95], v[48:63]
    ds_read_b64_tr_b16 a[196:197], v12 offset:57344
    ds_read_b64_tr_b16 a[198:199], v12 offset:57856
    v_mfma_f32_32x32x16_bf16 v[64:79], a[232:235], a[92:95], v[64:79]
    ds_read_b64_tr_b16 a[200:201], v9 offset:59392
    ds_read_b64_tr_b16 a[202:203], v9 offset:59904
    buffer_load_dwordx4 v6, s[36:39], s82 offen offset:1024  lds
    v_mfma_f32_32x32x16_bf16 v[80:95], a[236:239], a[92:95], v[80:95]
    ds_read_b64_tr_b16 a[204:205], v12 offset:59392
    ds_read_b64_tr_b16 a[206:207], v12 offset:59904
    v_mfma_f32_32x32x16_bf16 v[96:111], a[240:243], a[92:95], v[96:111]
    ds_read_b64_tr_b16 a[208:209], v9 offset:61440
    ds_read_b64_tr_b16 a[210:211], v9 offset:61952
    buffer_load_dwordx4 v5, s[40:43], s82 offen offset:2048  lds
    v_mfma_f32_32x32x16_bf16 v[112:127], a[244:247], a[92:95], v[112:127]
    ds_read_b64_tr_b16 a[212:213], v12 offset:61440
    ds_read_b64_tr_b16 a[214:215], v12 offset:61952
    v_mfma_f32_32x32x16_bf16 v[128:143], a[248:251], a[92:95], v[128:143]
    ds_read_b64_tr_b16 a[216:217], v9 offset:63488
    ds_read_b64_tr_b16 a[218:219], v9 offset:64000
    buffer_load_dwordx4 v6, s[40:43], s82 offen offset:3072  lds
    v_mfma_f32_32x32x16_bf16 v[144:159], a[252:255], a[92:95], v[144:159]
    ds_read_b64_tr_b16 a[220:221], v12 offset:63488
    ds_read_b64_tr_b16 a[222:223], v12 offset:64000
    s_waitcnt lgkmcnt(15)
    v_mfma_f32_32x32x16_bf16 v[32:47], a[160:163], a[96:99], v[32:47]
    s_add_u32 m0, s60, 32768
    s_mul_hi_u32 s5, s82, s61
    ds_read_b64_tr_b16 a[224:225], v10 offset:32768
    ds_read_b64_tr_b16 a[226:227], v10 offset:33280
    buffer_load_dwordx4 v160, s[28:31], s5 offen offset:0  lds
    v_mfma_f32_32x32x16_bf16 v[48:63], a[164:167], a[96:99], v[48:63]
    ds_read_b64_tr_b16 a[228:229], v13 offset:32768
    ds_read_b64_tr_b16 a[230:231], v13 offset:33280
    v_mfma_f32_32x32x16_bf16 v[64:79], a[168:171], a[96:99], v[64:79]
    ds_read_b64_tr_b16 a[232:233], v10 offset:34816
    ds_read_b64_tr_b16 a[234:235], v10 offset:35328
    buffer_load_dwordx4 v161, s[28:31], s5 offen offset:1024  lds
    v_mfma_f32_32x32x16_bf16 v[80:95], a[172:175], a[96:99], v[80:95]
    ds_read_b64_tr_b16 a[236:237], v13 offset:34816
    ds_read_b64_tr_b16 a[238:239], v13 offset:35328
    v_mfma_f32_32x32x16_bf16 v[96:111], a[176:179], a[96:99], v[96:111]
    ds_read_b64_tr_b16 a[240:241], v10 offset:36864
    ds_read_b64_tr_b16 a[242:243], v10 offset:37376
    buffer_load_dwordx4 v162, s[28:31], s5 offen offset:2048  lds
    v_mfma_f32_32x32x16_bf16 v[112:127], a[180:183], a[96:99], v[112:127]
    ds_read_b64_tr_b16 a[244:245], v13 offset:36864
    ds_read_b64_tr_b16 a[246:247], v13 offset:37376
    v_mfma_f32_32x32x16_bf16 v[128:143], a[184:187], a[96:99], v[128:143]
    ds_read_b64_tr_b16 a[248:249], v10 offset:38912
    ds_read_b64_tr_b16 a[250:251], v10 offset:39424
    buffer_load_dwordx4 v163, s[28:31], s5 offen offset:3072  lds
    v_mfma_f32_32x32x16_bf16 v[144:159], a[188:191], a[96:99], v[144:159]
    ds_read_b64_tr_b16 a[252:253], v13 offset:38912
    ds_read_b64_tr_b16 a[254:255], v13 offset:39424
    s_waitcnt lgkmcnt(15)
    v_mfma_f32_32x32x16_bf16 v[32:47], a[192:195], a[100:103], v[32:47]
    ds_read_b64_tr_b16 a[160:161], v11 offset:8192
    ds_read_b64_tr_b16 a[162:163], v11 offset:8704
    v_mfma_f32_32x32x16_bf16 v[48:63], a[196:199], a[100:103], v[48:63]
    ds_read_b64_tr_b16 a[164:165], v14 offset:8192
    ds_read_b64_tr_b16 a[166:167], v14 offset:8704
    v_mfma_f32_32x32x16_bf16 v[64:79], a[200:203], a[100:103], v[64:79]
    ds_read_b64_tr_b16 a[168:169], v11 offset:10240
    ds_read_b64_tr_b16 a[170:171], v11 offset:10752
    v_mfma_f32_32x32x16_bf16 v[80:95], a[204:207], a[100:103], v[80:95]
    ds_read_b64_tr_b16 a[172:173], v14 offset:10240
    ds_read_b64_tr_b16 a[174:175], v14 offset:10752
    v_mfma_f32_32x32x16_bf16 v[96:111], a[208:211], a[100:103], v[96:111]
    ds_read_b64_tr_b16 a[176:177], v11 offset:12288
    ds_read_b64_tr_b16 a[178:179], v11 offset:12800
    v_mfma_f32_32x32x16_bf16 v[112:127], a[212:215], a[100:103], v[112:127]
    ds_read_b64_tr_b16 a[180:181], v14 offset:12288
    ds_read_b64_tr_b16 a[182:183], v14 offset:12800
    v_mfma_f32_32x32x16_bf16 v[128:143], a[216:219], a[100:103], v[128:143]
    ds_read_b64_tr_b16 a[184:185], v11 offset:14336
    ds_read_b64_tr_b16 a[186:187], v11 offset:14848
    v_mfma_f32_32x32x16_bf16 v[144:159], a[220:223], a[100:103], v[144:159]
    ds_read_b64_tr_b16 a[188:189], v14 offset:14336
    ds_read_b64_tr_b16 a[190:191], v14 offset:14848
    s_waitcnt lgkmcnt(15)
    v_mfma_f32_32x32x16_bf16 v[32:47], a[224:227], a[104:107], v[32:47]
    s_waitcnt vmcnt(12)
    s_barrier
    s_add_u32 m0, s60, 8192
    ds_read_b64_tr_b16 a[192:193], v9 offset:24576
    ds_read_b64_tr_b16 a[194:195], v9 offset:25088
    buffer_load_dwordx4 v7, s[36:39], s83 offen offset:0  lds
    v_mfma_f32_32x32x16_bf16 v[48:63], a[228:231], a[104:107], v[48:63]
    ds_read_b64_tr_b16 a[196:197], v12 offset:24576
    ds_read_b64_tr_b16 a[198:199], v12 offset:25088
    ds_read_b128 a[112:115], v164 offset:4096
    v_mfma_f32_32x32x16_bf16 v[64:79], a[232:235], a[104:107], v[64:79]
    ds_read_b64_tr_b16 a[200:201], v9 offset:26624
    ds_read_b64_tr_b16 a[202:203], v9 offset:27136
    ds_read_b128 a[116:119], v165 offset:4096
    buffer_load_dwordx4 v8, s[36:39], s83 offen offset:1024  lds
    v_mfma_f32_32x32x16_bf16 v[80:95], a[236:239], a[104:107], v[80:95]
    ds_read_b64_tr_b16 a[204:205], v12 offset:26624
    ds_read_b64_tr_b16 a[206:207], v12 offset:27136
    ds_read_b128 a[120:123], v166 offset:4096
    v_mfma_f32_32x32x16_bf16 v[96:111], a[240:243], a[104:107], v[96:111]
    ds_read_b64_tr_b16 a[208:209], v9 offset:28672
    ds_read_b64_tr_b16 a[210:211], v9 offset:29184
    ds_read_b128 a[124:127], v167 offset:4096
    buffer_load_dwordx4 v7, s[40:43], s83 offen offset:2048  lds
    v_mfma_f32_32x32x16_bf16 v[112:127], a[244:247], a[104:107], v[112:127]
    ds_read_b64_tr_b16 a[212:213], v12 offset:28672
    ds_read_b64_tr_b16 a[214:215], v12 offset:29184
    v_mfma_f32_32x32x16_bf16 v[128:143], a[248:251], a[104:107], v[128:143]
    ds_read_b64_tr_b16 a[216:217], v9 offset:30720
    ds_read_b64_tr_b16 a[218:219], v9 offset:31232
    buffer_load_dwordx4 v8, s[40:43], s83 offen offset:3072  lds
    v_mfma_f32_32x32x16_bf16 v[144:159], a[252:255], a[104:107], v[144:159]
    s_add_u32 m0, s60, 12288
    ds_read_b64_tr_b16 a[220:221], v12 offset:30720
    ds_read_b64_tr_b16 a[222:223], v12 offset:31232
    s_waitcnt lgkmcnt(15)
    v_mfma_f32_32x32x16_bf16 v[32:47], a[160:163], a[108:111], v[32:47]
    ds_read_b64_tr_b16 a[224:225], v10 offset:0
    ds_read_b64_tr_b16 a[226:227], v10 offset:512
    buffer_load_dwordx4 v5, s[36:39], s83 offen offset:0  lds
    v_mfma_f32_32x32x16_bf16 v[48:63], a[164:167], a[108:111], v[48:63]
    ds_read_b64_tr_b16 a[228:229], v13 offset:0
    ds_read_b64_tr_b16 a[230:231], v13 offset:512
    v_mfma_f32_32x32x16_bf16 v[64:79], a[168:171], a[108:111], v[64:79]
    ds_read_b64_tr_b16 a[232:233], v10 offset:2048
    ds_read_b64_tr_b16 a[234:235], v10 offset:2560
    buffer_load_dwordx4 v6, s[36:39], s83 offen offset:1024  lds
    v_mfma_f32_32x32x16_bf16 v[80:95], a[172:175], a[108:111], v[80:95]
    ds_read_b64_tr_b16 a[236:237], v13 offset:2048
    ds_read_b64_tr_b16 a[238:239], v13 offset:2560
    v_mfma_f32_32x32x16_bf16 v[96:111], a[176:179], a[108:111], v[96:111]
    ds_read_b64_tr_b16 a[240:241], v10 offset:4096
    ds_read_b64_tr_b16 a[242:243], v10 offset:4608
    buffer_load_dwordx4 v5, s[40:43], s83 offen offset:2048  lds
    v_mfma_f32_32x32x16_bf16 v[112:127], a[180:183], a[108:111], v[112:127]
    ds_read_b64_tr_b16 a[244:245], v13 offset:4096
    ds_read_b64_tr_b16 a[246:247], v13 offset:4608
    v_mfma_f32_32x32x16_bf16 v[128:143], a[184:187], a[108:111], v[128:143]
    ds_read_b64_tr_b16 a[248:249], v10 offset:6144
    ds_read_b64_tr_b16 a[250:251], v10 offset:6656
    buffer_load_dwordx4 v6, s[40:43], s83 offen offset:3072  lds
    v_mfma_f32_32x32x16_bf16 v[144:159], a[188:191], a[108:111], v[144:159]
    ds_read_b64_tr_b16 a[252:253], v13 offset:6144
    ds_read_b64_tr_b16 a[254:255], v13 offset:6656
    s_waitcnt lgkmcnt(15)
    v_mfma_f32_32x32x16_bf16 v[32:47], a[192:195], a[112:115], v[32:47]
    s_add_u32 m0, s60, 36864
    s_mul_hi_u32 s5, s83, s61
    ds_read_b64_tr_b16 a[160:161], v10 offset:40960
    ds_read_b64_tr_b16 a[162:163], v10 offset:41472
    buffer_load_dwordx4 v160, s[28:31], s5 offen offset:0  lds
    v_mfma_f32_32x32x16_bf16 v[48:63], a[196:199], a[112:115], v[48:63]
    ds_read_b64_tr_b16 a[164:165], v13 offset:40960
    ds_read_b64_tr_b16 a[166:167], v13 offset:41472
    v_mfma_f32_32x32x16_bf16 v[64:79], a[200:203], a[112:115], v[64:79]
    ds_read_b64_tr_b16 a[168:169], v10 offset:43008
    ds_read_b64_tr_b16 a[170:171], v10 offset:43520
    buffer_load_dwordx4 v161, s[28:31], s5 offen offset:1024  lds
    v_mfma_f32_32x32x16_bf16 v[80:95], a[204:207], a[112:115], v[80:95]
    ds_read_b64_tr_b16 a[172:173], v13 offset:43008
    ds_read_b64_tr_b16 a[174:175], v13 offset:43520
    v_mfma_f32_32x32x16_bf16 v[96:111], a[208:211], a[112:115], v[96:111]
    ds_read_b64_tr_b16 a[176:177], v10 offset:45056
    ds_read_b64_tr_b16 a[178:179], v10 offset:45568
    buffer_load_dwordx4 v162, s[28:31], s5 offen offset:2048  lds
    v_mfma_f32_32x32x16_bf16 v[112:127], a[212:215], a[112:115], v[112:127]
    ds_read_b64_tr_b16 a[180:181], v13 offset:45056
    ds_read_b64_tr_b16 a[182:183], v13 offset:45568
    v_mfma_f32_32x32x16_bf16 v[128:143], a[216:219], a[112:115], v[128:143]
    ds_read_b64_tr_b16 a[184:185], v10 offset:47104
    ds_read_b64_tr_b16 a[186:187], v10 offset:47616
    buffer_load_dwordx4 v163, s[28:31], s5 offen offset:3072  lds
    v_mfma_f32_32x32x16_bf16 v[144:159], a[220:223], a[112:115], v[144:159]
    ds_read_b64_tr_b16 a[188:189], v13 offset:47104
    ds_read_b64_tr_b16 a[190:191], v13 offset:47616
    s_waitcnt lgkmcnt(15)
    v_mfma_f32_32x32x16_bf16 v[32:47], a[224:227], a[116:119], v[32:47]
    ds_read_b64_tr_b16 a[192:193], v11 offset:16384
    ds_read_b64_tr_b16 a[194:195], v11 offset:16896
    v_mfma_f32_32x32x16_bf16 v[48:63], a[228:231], a[116:119], v[48:63]
    ds_read_b64_tr_b16 a[196:197], v14 offset:16384
    ds_read_b64_tr_b16 a[198:199], v14 offset:16896
    v_mfma_f32_32x32x16_bf16 v[64:79], a[232:235], a[116:119], v[64:79]
    ds_read_b64_tr_b16 a[200:201], v11 offset:18432
    ds_read_b64_tr_b16 a[202:203], v11 offset:18944
    v_mfma_f32_32x32x16_bf16 v[80:95], a[236:239], a[116:119], v[80:95]
    ds_read_b64_tr_b16 a[204:205], v14 offset:18432
    ds_read_b64_tr_b16 a[206:207], v14 offset:18944
    v_mfma_f32_32x32x16_bf16 v[96:111], a[240:243], a[116:119], v[96:111]
    ds_read_b64_tr_b16 a[208:209], v11 offset:20480
    ds_read_b64_tr_b16 a[210:211], v11 offset:20992
    v_mfma_f32_32x32x16_bf16 v[112:127], a[244:247], a[116:119], v[112:127]
    ds_read_b64_tr_b16 a[212:213], v14 offset:20480
    ds_read_b64_tr_b16 a[214:215], v14 offset:20992
    v_mfma_f32_32x32x16_bf16 v[128:143], a[248:251], a[116:119], v[128:143]
    ds_read_b64_tr_b16 a[216:217], v11 offset:22528
    ds_read_b64_tr_b16 a[218:219], v11 offset:23040
    v_mfma_f32_32x32x16_bf16 v[144:159], a[252:255], a[116:119], v[144:159]
    ds_read_b64_tr_b16 a[220:221], v14 offset:22528
    ds_read_b64_tr_b16 a[222:223], v14 offset:23040
    s_waitcnt lgkmcnt(15)
    v_mfma_f32_32x32x16_bf16 v[32:47], a[160:163], a[120:123], v[32:47]
    s_waitcnt vmcnt(12)
    s_barrier
    s_add_u32 m0, s60, 16384
    ds_read_b64_tr_b16 a[224:225], v9 offset:0
    ds_read_b64_tr_b16 a[226:227], v9 offset:512
    buffer_load_dwordx4 v2, s[32:35], s64 offen offset:0  lds
    v_mfma_f32_32x32x16_bf16 v[48:63], a[164:167], a[120:123], v[48:63]
    ds_read_b64_tr_b16 a[228:229], v12 offset:0
    ds_read_b64_tr_b16 a[230:231], v12 offset:512
    ds_read_b128 a[128:131], v164 offset:0
    s_sub_u32 s97, s89, 13926400
    s_andn2_b32 s97, s97, 0x1800
    s_add_u32 s97, s97, 13926400
    buffer_load_dword v31, off, s[44:47], s97 offset:0 sc1
    v_mfma_f32_32x32x16_bf16 v[64:79], a[168:171], a[120:123], v[64:79]
    ds_read_b64_tr_b16 a[232:233], v9 offset:2048
    ds_read_b64_tr_b16 a[234:235], v9 offset:2560
    ds_read_b128 a[132:135], v165 offset:0
    buffer_load_dwordx4 v3, s[32:35], s64 offen offset:1024  lds
    v_mfma_f32_32x32x16_bf16 v[80:95], a[172:175], a[120:123], v[80:95]
    ds_read_b64_tr_b16 a[236:237], v12 offset:2048
    ds_read_b64_tr_b16 a[238:239], v12 offset:2560
    ds_read_b128 a[136:139], v166 offset:0
    v_mfma_f32_32x32x16_bf16 v[96:111], a[176:179], a[120:123], v[96:111]
    ds_read_b64_tr_b16 a[240:241], v9 offset:4096
    ds_read_b64_tr_b16 a[242:243], v9 offset:4608
    ds_read_b128 a[140:143], v167 offset:0
    buffer_load_dwordx4 v4, s[32:35], s64 offen offset:2048  lds
    v_mfma_f32_32x32x16_bf16 v[112:127], a[180:183], a[120:123], v[112:127]
    s_add_u32 m0, s60, 19456
    ds_read_b64_tr_b16 a[244:245], v12 offset:4096
    ds_read_b64_tr_b16 a[246:247], v12 offset:4608
    v_mfma_f32_32x32x16_bf16 v[128:143], a[184:187], a[120:123], v[128:143]
    ds_read_b64_tr_b16 a[248:249], v9 offset:6144
    ds_read_b64_tr_b16 a[250:251], v9 offset:6656
    buffer_load_dwordx4 v2, s[32:35], s65 offen offset:0  lds
    v_mfma_f32_32x32x16_bf16 v[144:159], a[188:191], a[120:123], v[144:159]
    ds_read_b64_tr_b16 a[252:253], v12 offset:6144
    ds_read_b64_tr_b16 a[254:255], v12 offset:6656
    s_waitcnt lgkmcnt(15)
    v_mfma_f32_32x32x16_bf16 v[32:47], a[192:195], a[124:127], v[32:47]
    ds_read_b64_tr_b16 a[160:161], v9 offset:40960
    ds_read_b64_tr_b16 a[162:163], v9 offset:41472
    buffer_load_dwordx4 v3, s[32:35], s65 offen offset:1024  lds
    v_mfma_f32_32x32x16_bf16 v[48:63], a[196:199], a[124:127], v[48:63]
    ds_read_b64_tr_b16 a[164:165], v12 offset:40960
    ds_read_b64_tr_b16 a[166:167], v12 offset:41472
    v_mfma_f32_32x32x16_bf16 v[64:79], a[200:203], a[124:127], v[64:79]
    ds_read_b64_tr_b16 a[168:169], v9 offset:43008
    ds_read_b64_tr_b16 a[170:171], v9 offset:43520
    buffer_load_dwordx4 v4, s[32:35], s65 offen offset:2048  lds
    v_mfma_f32_32x32x16_bf16 v[80:95], a[204:207], a[124:127], v[80:95]
    ds_read_b64_tr_b16 a[172:173], v12 offset:43008
    ds_read_b64_tr_b16 a[174:175], v12 offset:43520
    v_mfma_f32_32x32x16_bf16 v[96:111], a[208:211], a[124:127], v[96:111]
    ds_read_b64_tr_b16 a[176:177], v9 offset:45056
    ds_read_b64_tr_b16 a[178:179], v9 offset:45568
    v_mfma_f32_32x32x16_bf16 v[112:127], a[212:215], a[124:127], v[112:127]
    ds_read_b64_tr_b16 a[180:181], v12 offset:45056
    ds_read_b64_tr_b16 a[182:183], v12 offset:45568
    v_mfma_f32_32x32x16_bf16 v[128:143], a[216:219], a[124:127], v[128:143]
    ds_read_b64_tr_b16 a[184:185], v9 offset:47104
    ds_read_b64_tr_b16 a[186:187], v9 offset:47616
    v_mfma_f32_32x32x16_bf16 v[144:159], a[220:223], a[124:127], v[144:159]
    ds_read_b64_tr_b16 a[188:189], v12 offset:47104
    ds_read_b64_tr_b16 a[190:191], v12 offset:47616
    s_waitcnt lgkmcnt(15)
    v_mfma_f32_32x32x16_bf16 v[32:47], a[224:227], a[128:131], v[32:47]
    ds_read_b64_tr_b16 a[192:193], v10 offset:16384
    ds_read_b64_tr_b16 a[194:195], v10 offset:16896
    buffer_load_dword v196, off, s[44:47], s91 offset:4 sc1
    v_mfma_f32_32x32x16_bf16 v[48:63], a[228:231], a[128:131], v[48:63]
    ds_read_b64_tr_b16 a[196:197], v13 offset:16384
    ds_read_b64_tr_b16 a[198:199], v13 offset:16896
    v_mfma_f32_32x32x16_bf16 v[64:79], a[232:235], a[128:131], v[64:79]
    ds_read_b64_tr_b16 a[200:201], v10 offset:18432
    ds_read_b64_tr_b16 a[202:203], v10 offset:18944
    v_mfma_f32_32x32x16_bf16 v[80:95], a[236:239], a[128:131], v[80:95]
    ds_read_b64_tr_b16 a[204:205], v13 offset:18432
    ds_read_b64_tr_b16 a[206:207], v13 offset:18944
    v_mfma_f32_32x32x16_bf16 v[96:111], a[240:243], a[128:131], v[96:111]
    ds_read_b64_tr_b16 a[208:209], v10 offset:20480
    ds_read_b64_tr_b16 a[210:211], v10 offset:20992
    v_mfma_f32_32x32x16_bf16 v[112:127], a[244:247], a[128:131], v[112:127]
    ds_read_b64_tr_b16 a[212:213], v13 offset:20480
    ds_read_b64_tr_b16 a[214:215], v13 offset:20992
    v_mfma_f32_32x32x16_bf16 v[128:143], a[248:251], a[128:131], v[128:143]
    ds_read_b64_tr_b16 a[216:217], v10 offset:22528
    ds_read_b64_tr_b16 a[218:219], v10 offset:23040
    v_mfma_f32_32x32x16_bf16 v[144:159], a[252:255], a[128:131], v[144:159]
    ds_read_b64_tr_b16 a[220:221], v13 offset:22528
    ds_read_b64_tr_b16 a[222:223], v13 offset:23040
    s_waitcnt lgkmcnt(15)
    v_mfma_f32_32x32x16_bf16 v[32:47], a[160:163], a[132:135], v[32:47]
    ds_read_b64_tr_b16 a[224:225], v10 offset:57344
    ds_read_b64_tr_b16 a[226:227], v10 offset:57856
    s_waitcnt vmcnt(6)
    v_readfirstlane_b32 s98, v31
    s_cmp_ge_u32 s98, 4456448
    s_cbranch_scc0 SPIN22
RET22:
    v_mfma_f32_32x32x16_bf16 v[48:63], a[164:167], a[132:135], v[48:63]
    ds_read_b64_tr_b16 a[228:229], v13 offset:57344
    ds_read_b64_tr_b16 a[230:231], v13 offset:57856
    buffer_load_dwordx4 v[228:231], v15, s[44:47], s8 offen offset:0 sc1
    v_mfma_f32_32x32x16_bf16 v[64:79], a[168:171], a[132:135], v[64:79]
    ds_read_b64_tr_b16 a[232:233], v10 offset:59392
    ds_read_b64_tr_b16 a[234:235], v10 offset:59904
    v_mfma_f32_32x32x16_bf16 v[80:95], a[172:175], a[132:135], v[80:95]
    ds_read_b64_tr_b16 a[236:237], v13 offset:59392
    ds_read_b64_tr_b16 a[238:239], v13 offset:59904
    buffer_load_dwordx4 v[232:235], v15, s[44:47], s8 offen offset:1024 sc1
    v_mfma_f32_32x32x16_bf16 v[96:111], a[176:179], a[132:135], v[96:111]
    ds_read_b64_tr_b16 a[240:241], v10 offset:61440
    ds_read_b64_tr_b16 a[242:243], v10 offset:61952
    v_mfma_f32_32x32x16_bf16 v[112:127], a[180:183], a[132:135], v[112:127]
    ds_read_b64_tr_b16 a[244:245], v13 offset:61440
    ds_read_b64_tr_b16 a[246:247], v13 offset:61952
    buffer_load_dwordx4 v[236:239], v15, s[44:47], s8 offen offset:2048 sc1
    v_mfma_f32_32x32x16_bf16 v[128:143], a[184:187], a[132:135], v[128:143]
    ds_read_b64_tr_b16 a[248:249], v10 offset:63488
    ds_read_b64_tr_b16 a[250:251], v10 offset:64000
    v_mfma_f32_32x32x16_bf16 v[144:159], a[188:191], a[132:135], v[144:159]
    ds_read_b64_tr_b16 a[252:253], v13 offset:63488
    ds_read_b64_tr_b16 a[254:255], v13 offset:64000
    buffer_load_dwordx4 v[240:243], v15, s[44:47], s8 offen offset:3072 sc1
    s_waitcnt lgkmcnt(15)
    v_mfma_f32_32x32x16_bf16 v[32:47], a[192:195], a[136:139], v[32:47]
    s_barrier
    ds_read_b64_tr_b16 a[160:161], v9 offset:8192
    ds_read_b64_tr_b16 a[162:163], v9 offset:8704
    v_mfma_f32_32x32x16_bf16 v[48:63], a[196:199], a[136:139], v[48:63]
    ds_read_b64_tr_b16 a[164:165], v12 offset:8192
    ds_read_b64_tr_b16 a[166:167], v12 offset:8704
    ds_read_b128 a[144:147], v164 offset:4096
    buffer_load_dwordx4 v[244:247], v16, s[44:47], s8 offen offset:0 sc1
    v_mfma_f32_32x32x16_bf16 v[64:79], a[200:203], a[136:139], v[64:79]
    ds_read_b64_tr_b16 a[168:169], v9 offset:10240
    ds_read_b64_tr_b16 a[170:171], v9 offset:10752
    ds_read_b128 a[148:151], v165 offset:4096
    v_mfma_f32_32x32x16_bf16 v[80:95], a[204:207], a[136:139], v[80:95]
    ds_read_b64_tr_b16 a[172:173], v12 offset:10240
    ds_read_b64_tr_b16 a[174:175], v12 offset:10752
    ds_read_b128 a[152:155], v166 offset:4096
    buffer_load_dwordx4 v[248:251], v15, s[44:47], s9 offen offset:0 sc1
    v_mfma_f32_32x32x16_bf16 v[96:111], a[208:211], a[136:139], v[96:111]
    ds_read_b64_tr_b16 a[176:177], v9 offset:12288
    ds_read_b64_tr_b16 a[178:179], v9 offset:12800
    ds_read_b128 a[156:159], v167 offset:4096
    v_mfma_f32_32x32x16_bf16 v[112:127], a[212:215], a[136:139], v[112:127]
    ds_read_b64_tr_b16 a[180:181], v12 offset:12288
    ds_read_b64_tr_b16 a[182:183], v12 offset:12800
    buffer_load_dwordx4 v[252:255], v15, s[44:47], s9 offen offset:1024 sc1
    v_mfma_f32_32x32x16_bf16 v[128:143], a[216:219], a[136:139], v[128:143]
    ds_read_b64_tr_b16 a[184:185], v9 offset:14336
    ds_read_b64_tr_b16 a[186:187], v9 offset:14848
    v_mfma_f32_32x32x16_bf16 v[144:159], a[220:223], a[136:139], v[144:159]
    ds_read_b64_tr_b16 a[188:189], v12 offset:14336
    ds_read_b64_tr_b16 a[190:191], v12 offset:14848
    s_waitcnt lgkmcnt(15)
    v_mfma_f32_32x32x16_bf16 v[32:47], a[224:227], a[140:143], v[32:47]
    ds_read_b64_tr_b16 a[192:193], v9 offset:49152
    ds_read_b64_tr_b16 a[194:195], v9 offset:49664
    s_waitcnt vmcnt(7)
    v_readfirstlane_b32 s98, v196
    s_cmp_ge_u32 s98, 2621440
    s_cbranch_scc0 SPIN23
RET23:
    buffer_load_dword v192, v30, s[44:47], s63 offen sc1
    v_mfma_f32_32x32x16_bf16 v[48:63], a[228:231], a[140:143], v[48:63]
    ds_read_b64_tr_b16 a[196:197], v12 offset:49152
    ds_read_b64_tr_b16 a[198:199], v12 offset:49664
    buffer_load_dword v212, v30, s[44:47], s62 offen offset:0 sc1
    buffer_load_dword v216, v30, s[44:47], s62 offen offset:256 sc1
    v_mfma_f32_32x32x16_bf16 v[64:79], a[232:235], a[140:143], v[64:79]
    ds_read_b64_tr_b16 a[200:201], v9 offset:51200
    ds_read_b64_tr_b16 a[202:203], v9 offset:51712
    buffer_load_dword v220, v30, s[44:47], s62 offen offset:512 sc1
    buffer_load_dword v224, v30, s[44:47], s62 offen offset:768 sc1
    v_mfma_f32_32x32x16_bf16 v[80:95], a[236:239], a[140:143], v[80:95]
    ds_read_b64_tr_b16 a[204:205], v12 offset:51200
    ds_read_b64_tr_b16 a[206:207], v12 offset:51712
    v_mfma_f32_32x32x16_bf16 v[96:111], a[240:243], a[140:143], v[96:111]
    ds_read_b64_tr_b16 a[208:209], v9 offset:53248
    ds_read_b64_tr_b16 a[210:211], v9 offset:53760
    v_mfma_f32_32x32x16_bf16 v[112:127], a[244:247], a[140:143], v[112:127]
    ds_read_b64_tr_b16 a[212:213], v12 offset:53248
    ds_read_b64_tr_b16 a[214:215], v12 offset:53760
    v_mfma_f32_32x32x16_bf16 v[128:143], a[248:251], a[140:143], v[128:143]
    ds_read_b64_tr_b16 a[216:217], v9 offset:55296
    ds_read_b64_tr_b16 a[218:219], v9 offset:55808
    v_mfma_f32_32x32x16_bf16 v[144:159], a[252:255], a[140:143], v[144:159]
    ds_read_b64_tr_b16 a[220:221], v12 offset:55296
    ds_read_b64_tr_b16 a[222:223], v12 offset:55808
    s_waitcnt lgkmcnt(15)
    v_mfma_f32_32x32x16_bf16 v[32:47], a[160:163], a[144:147], v[32:47]
    ds_read_b64_tr_b16 a[224:225], v10 offset:24576
    ds_read_b64_tr_b16 a[226:227], v10 offset:25088
    v_mfma_f32_32x32x16_bf16 v[48:63], a[164:167], a[144:147], v[48:63]
    ds_read_b64_tr_b16 a[228:229], v13 offset:24576
    ds_read_b64_tr_b16 a[230:231], v13 offset:25088
    v_mfma_f32_32x32x16_bf16 v[64:79], a[168:171], a[144:147], v[64:79]
    ds_read_b64_tr_b16 a[232:233], v10 offset:26624
    ds_read_b64_tr_b16 a[234:235], v10 offset:27136
    v_mfma_f32_32x32x16_bf16 v[80:95], a[172:175], a[144:147], v[80:95]
    ds_read_b64_tr_b16 a[236:237], v13 offset:26624
    ds_read_b64_tr_b16 a[238:239], v13 offset:27136
    v_mfma_f32_32x32x16_bf16 v[96:111], a[176:179], a[144:147], v[96:111]
    ds_read_b64_tr_b16 a[240:241], v10 offset:28672
    ds_read_b64_tr_b16 a[242:243], v10 offset:29184
    v_mfma_f32_32x32x16_bf16 v[112:127], a[180:183], a[144:147], v[112:127]
    ds_read_b64_tr_b16 a[244:245], v13 offset:28672
    ds_read_b64_tr_b16 a[246:247], v13 offset:29184
    v_mfma_f32_32x32x16_bf16 v[128:143], a[184:187], a[144:147], v[128:143]
    ds_read_b64_tr_b16 a[248:249], v10 offset:30720
    ds_read_b64_tr_b16 a[250:251], v10 offset:31232
    v_mfma_f32_32x32x16_bf16 v[144:159], a[188:191], a[144:147], v[144:159]
    ds_read_b64_tr_b16 a[252:253], v13 offset:30720
    ds_read_b64_tr_b16 a[254:255], v13 offset:31232
    s_waitcnt lgkmcnt(15)
    v_mfma_f32_32x32x16_bf16 v[32:47], a[192:195], a[148:151], v[32:47]
    ds_read_b64_tr_b16 a[160:161], v11 offset:0
    ds_read_b64_tr_b16 a[162:163], v11 offset:512
    v_mfma_f32_32x32x16_bf16 v[48:63], a[196:199], a[148:151], v[48:63]
    ds_read_b64_tr_b16 a[164:165], v14 offset:0
    ds_read_b64_tr_b16 a[166:167], v14 offset:512
    v_mfma_f32_32x32x16_bf16 v[64:79], a[200:203], a[148:151], v[64:79]
    ds_read_b64_tr_b16 a[168:169], v11 offset:2048
    ds_read_b64_tr_b16 a[170:171], v11 offset:2560
    v_mfma_f32_32x32x16_bf16 v[80:95], a[204:207], a[148:151], v[80:95]
    ds_read_b64_tr_b16 a[172:173], v14 offset:2048
    ds_read_b64_tr_b16 a[174:175], v14 offset:2560
    v_mfma_f32_32x32x16_bf16 v[96:111], a[208:211], a[148:151], v[96:111]
    ds_read_b64_tr_b16 a[176:177], v11 offset:4096
    ds_read_b64_tr_b16 a[178:179], v11 offset:4608
    v_mfma_f32_32x32x16_bf16 v[112:127], a[212:215], a[148:151], v[112:127]
    ds_read_b64_tr_b16 a[180:181], v14 offset:4096
    ds_read_b64_tr_b16 a[182:183], v14 offset:4608
    v_mfma_f32_32x32x16_bf16 v[128:143], a[216:219], a[148:151], v[128:143]
    ds_read_b64_tr_b16 a[184:185], v11 offset:6144
    ds_read_b64_tr_b16 a[186:187], v11 offset:6656
    v_mfma_f32_32x32x16_bf16 v[144:159], a[220:223], a[148:151], v[144:159]
    ds_read_b64_tr_b16 a[188:189], v14 offset:6144
    ds_read_b64_tr_b16 a[190:191], v14 offset:6656
    v_mov_b32 v12, v168
    v_add_u32 v13, 65536, v168
    v_add_u32 v14, 131072, v168
    s_waitcnt lgkmcnt(15)
    v_mfma_f32_32x32x16_bf16 v[32:47], a[224:227], a[152:155], v[32:47]
    s_barrier
    s_add_u32 m0, s60, 0
    ds_read_b64_tr_b16 a[192:193], v12 offset:16384
    buffer_load_dwordx4 v2, s[32:35], s66 offen offset:0  lds
    v_mfma_f32_32x32x16_bf16 v[48:63], a[228:231], a[152:155], v[48:63]
    ds_read_b64_tr_b16 a[194:195], v12 offset:17152
    v_mfma_f32_32x32x16_bf16 v[64:79], a[232:235], a[152:155], v[64:79]
    ds_read_b64_tr_b16 a[196:197], v12 offset:16448
    buffer_load_dwordx4 v3, s[32:35], s66 offen offset:1024  lds
    v_mfma_f32_32x32x16_bf16 v[80:95], a[236:239], a[152:155], v[80:95]
    ds_read_b64_tr_b16 a[198:199], v12 offset:17216
    v_mfma_f32_32x32x16_bf16 v[96:111], a[240:243], a[152:155], v[96:111]
    ds_read_b64_tr_b16 a[200:201], v12 offset:16512
    buffer_load_dwordx4 v4, s[32:35], s66 offen offset:2048  lds
    v_mfma_f32_32x32x16_bf16 v[112:127], a[244:247], a[152:155], v[112:127]
    s_add_u32 m0, s60, 3072
    ds_read_b64_tr_b16 a[202:203], v12 offset:17280
    v_mfma_f32_32x32x16_bf16 v[128:143], a[248:251], a[152:155], v[128:143]
    buffer_load_dwordx4 v2, s[32:35], s67 offen offset:0  lds
    v_mfma_f32_32x32x16_bf16 v[144:159], a[252:255], a[152:155], v[144:159]
    s_waitcnt lgkmcnt(6)
    v_mfma_f32_32x32x16_bf16 v[32:47], a[160:163], a[156:159], v[32:47]
    ds_read_b64_tr_b16 a[224:225], v12 offset:57344
    buffer_load_dwordx4 v3, s[32:35], s67 offen offset:1024  lds
    s_waitcnt vmcnt(5)
    v_mov_b32 v193, v192
    s_nop 1
    v_permlane32_swap_b32 v192, v193
    s_nop 1
    v_mfma_f32_32x32x16_bf16 v[48:63], a[164:167], a[156:159], v[48:63]
    ds_read_b64_tr_b16 a[226:227], v12 offset:58112
    v_mul_f32 v192, 0xbacccccd, v192
    v_mul_f32 v193, 0x3acccccd, v193
    v_fma_f32 v193, -v192, v192, v193
    v_max_f32 v193, 0, v193
    v_add_f32 v193, 0x3727c5ac, v193
    v_mfma_f32_32x32x16_bf16 v[64:79], a[168:171], a[156:159], v[64:79]
    ds_read_b64_tr_b16 a[228:229], v12 offset:57408
    buffer_load_dwordx4 v4, s[32:35], s67 offen offset:2048  lds
    v_rsq_f32 v18, v193
    v_mfma_f32_32x32x16_bf16 v[80:95], a[172:175], a[156:159], v[80:95]
    ds_read_b64_tr_b16 a[230:231], v12 offset:58176
    v_cvt_pk_bf16_f32 v194, v192, v192
    v_mul_f32 v193, v193, v18
    v_mul_f32 v193, 0x358637bd, v193
    v_lshlrev_b32 v195, 16, v194
    v_sub_f32 v195, v192, v195
    v_mfma_f32_32x32x16_bf16 v[96:111], a[176:179], a[156:159], v[96:111]
    ds_read_b64_tr_b16 a[232:233], v12 offset:57472
    v_cvt_pk_bf16_f32 v195, v195, v193
    v_mul_f32 v19, 0x3fb8aa3b, v18
    v_mul_f32 v22, v18, v18
    v_and_b32 v20, 0xffff0000, v195
    v_mov_b32 v23, v22
    v_mfma_f32_32x32x16_bf16 v[112:127], a[180:183], a[156:159], v[112:127]
    ds_read_b64_tr_b16 a[234:235], v12 offset:58240
    v_cmp_gt_u32 vcc, 32, v0
    v_mov_b32 v192, 0
    s_nop 0
    v_cndmask_b32 v24, v192, v194, vcc
    v_cndmask_b32 v25, v192, v195, vcc
    v_mfma_f32_32x32x16_bf16 v[128:143], a[184:187], a[156:159], v[128:143]
    v_cndmask_b32 v26, v194, v192, vcc
    v_cndmask_b32 v27, v195, v192, vcc
    v_cvt_pk_bf16_f32 v215, v212, 0
    v_lshlrev_b32 v213, 16, v215
    v_sub_f32 v213, v212, v213
    v_cvt_pk_bf16_f32 v214, v212, v213
    v_mfma_f32_32x32x16_bf16 v[144:159], a[188:191], a[156:159], v[144:159]
    v_cvt_pk_bf16_f32 v219, v216, 0
    v_lshlrev_b32 v217, 16, v219
    v_sub_f32 v217, v216, v217
    v_cvt_pk_bf16_f32 v218, v216, v217
    v_cvt_pk_bf16_f32 v223, v220, 0
    v_lshlrev_b32 v221, 16, v223
    v_sub_f32 v221, v220, v221
    v_cvt_pk_bf16_f32 v222, v220, v221
    v_cvt_pk_bf16_f32 v227, v224, 0
    v_lshlrev_b32 v225, 16, v227
    v_sub_f32 v225, v224, v225
    v_cvt_pk_bf16_f32 v226, v224, v225
    s_nop 1
    v_mfma_f32_32x32x8_bf16 v[32:47], v[214:215], v[24:25], v[32:47]
    v_mfma_f32_32x32x8_bf16 v[48:63], v[214:215], v[26:27], v[48:63]
    v_mfma_f32_32x32x8_bf16 v[64:79], v[218:219], v[24:25], v[64:79]
    v_mfma_f32_32x32x8_bf16 v[80:95], v[218:219], v[26:27], v[80:95]
    v_mfma_f32_32x32x8_bf16 v[96:111], v[222:223], v[24:25], v[96:111]
    v_mfma_f32_32x32x8_bf16 v[112:127], v[222:223], v[26:27], v[112:127]
    v_mfma_f32_32x32x8_bf16 v[128:143], v[226:227], v[24:25], v[128:143]
    v_mfma_f32_32x32x8_bf16 v[144:159], v[226:227], v[26:27], v[144:159]
    s_lshr_b32 s7, s87, 1
    s_mul_i32 s4, s7, 20480
    s_nop 4
    v_pk_mul_f32 v[32:33], v[32:33], v[64:65]
    v_pk_mul_f32 v[34:35], v[34:35], v[66:67]
    v_pk_mul_f32 v[36:37], v[36:37], v[68:69]
    v_pk_mul_f32 v[38:39], v[38:39], v[70:71]
    v_pk_mul_f32 v[32:33], v[32:33], v[22:23]
    v_pk_mul_f32 v[34:35], v[34:35], v[22:23]
    v_pk_mul_f32 v[36:37], v[36:37], v[22:23]
    v_pk_mul_f32 v[38:39], v[38:39], v[22:23]
    v_cvt_pk_bf16_f32 v64, v32, v33
    v_cvt_pk_bf16_f32 v65, v34, v35
    v_cvt_pk_bf16_f32 v66, v36, v37
    v_cvt_pk_bf16_f32 v67, v38, v39
    s_add_u32 s7, s4, 0
    buffer_store_dwordx4 v[64:67], v1, s[44:47], s7 offen offset:0 sc1
    v_pk_mul_f32 v[40:41], v[40:41], v[72:73]
    v_pk_mul_f32 v[42:43], v[42:43], v[74:75]
    v_pk_mul_f32 v[44:45], v[44:45], v[76:77]
    v_pk_mul_f32 v[46:47], v[46:47], v[78:79]
    v_pk_mul_f32 v[40:41], v[40:41], v[22:23]
    v_pk_mul_f32 v[42:43], v[42:43], v[22:23]
    v_pk_mul_f32 v[44:45], v[44:45], v[22:23]
    v_pk_mul_f32 v[46:47], v[46:47], v[22:23]
    v_cvt_pk_bf16_f32 v72, v40, v41
    v_cvt_pk_bf16_f32 v73, v42, v43
    v_cvt_pk_bf16_f32 v74, v44, v45
    v_cvt_pk_bf16_f32 v75, v46, v47
    s_add_u32 s7, s4, 0
    buffer_store_dwordx4 v[72:75], v1, s[44:47], s7 offen offset:512 sc1
    v_pk_mul_f32 v[48:49], v[48:49], v[80:81]
    v_pk_mul_f32 v[50:51], v[50:51], v[82:83]
    v_pk_mul_f32 v[52:53], v[52:53], v[84:85]
    v_pk_mul_f32 v[54:55], v[54:55], v[86:87]
    v_pk_mul_f32 v[48:49], v[48:49], v[22:23]
    v_pk_mul_f32 v[50:51], v[50:51], v[22:23]
    v_pk_mul_f32 v[52:53], v[52:53], v[22:23]
    v_pk_mul_f32 v[54:55], v[54:55], v[22:23]
    v_cvt_pk_bf16_f32 v80, v48, v49
    v_cvt_pk_bf16_f32 v81, v50, v51
    v_cvt_pk_bf16_f32 v82, v52, v53
    v_cvt_pk_bf16_f32 v83, v54, v55
    s_add_u32 s7, s4, 5120
    buffer_store_dwordx4 v[80:83], v1, s[44:47], s7 offen offset:0 sc1
    v_pk_mul_f32 v[56:57], v[56:57], v[88:89]
    v_pk_mul_f32 v[58:59], v[58:59], v[90:91]
    v_pk_mul_f32 v[60:61], v[60:61], v[92:93]
    v_pk_mul_f32 v[62:63], v[62:63], v[94:95]
    v_pk_mul_f32 v[56:57], v[56:57], v[22:23]
    v_pk_mul_f32 v[58:59], v[58:59], v[22:23]
    v_pk_mul_f32 v[60:61], v[60:61], v[22:23]
    v_pk_mul_f32 v[62:63], v[62:63], v[22:23]
    v_cvt_pk_bf16_f32 v88, v56, v57
    v_cvt_pk_bf16_f32 v89, v58, v59
    v_cvt_pk_bf16_f32 v90, v60, v61
    v_cvt_pk_bf16_f32 v91, v62, v63
    s_add_u32 s7, s4, 5120
    buffer_store_dwordx4 v[88:91], v1, s[44:47], s7 offen offset:512 sc1
    v_pk_mul_f32 v[96:97], v[96:97], v[128:129]
    v_pk_mul_f32 v[98:99], v[98:99], v[130:131]
    v_pk_mul_f32 v[100:101], v[100:101], v[132:133]
    v_pk_mul_f32 v[102:103], v[102:103], v[134:135]
    v_pk_mul_f32 v[96:97], v[96:97], v[22:23]
    v_pk_mul_f32 v[98:99], v[98:99], v[22:23]
    v_pk_mul_f32 v[100:101], v[100:101], v[22:23]
    v_pk_mul_f32 v[102:103], v[102:103], v[22:23]
    v_cvt_pk_bf16_f32 v128, v96, v97
    v_cvt_pk_bf16_f32 v129, v98, v99
    v_cvt_pk_bf16_f32 v130, v100, v101
    v_cvt_pk_bf16_f32 v131, v102, v103
    s_add_u32 s7, s4, 10240
    buffer_store_dwordx4 v[128:131], v1, s[44:47], s7 offen offset:0 sc1
    v_pk_mul_f32 v[104:105], v[104:105], v[136:137]
    v_pk_mul_f32 v[106:107], v[106:107], v[138:139]
    v_pk_mul_f32 v[108:109], v[108:109], v[140:141]
    v_pk_mul_f32 v[110:111], v[110:111], v[142:143]
    v_pk_mul_f32 v[104:105], v[104:105], v[22:23]
    v_pk_mul_f32 v[106:107], v[106:107], v[22:23]
    v_pk_mul_f32 v[108:109], v[108:109], v[22:23]
    v_pk_mul_f32 v[110:111], v[110:111], v[22:23]
    v_cvt_pk_bf16_f32 v136, v104, v105
    v_cvt_pk_bf16_f32 v137, v106, v107
    v_cvt_pk_bf16_f32 v138, v108, v109
    v_cvt_pk_bf16_f32 v139, v110, v111
    s_add_u32 s7, s4, 10240
    buffer_store_dwordx4 v[136:139], v1, s[44:47], s7 offen offset:512 sc1
    v_pk_mul_f32 v[112:113], v[112:113], v[144:145]
    v_pk_mul_f32 v[114:115], v[114:115], v[146:147]
    v_pk_mul_f32 v[116:117], v[116:117], v[148:149]
    v_pk_mul_f32 v[118:119], v[118:119], v[150:151]
    v_pk_mul_f32 v[112:113], v[112:113], v[22:23]
    v_pk_mul_f32 v[114:115], v[114:115], v[22:23]
    v_pk_mul_f32 v[116:117], v[116:117], v[22:23]
    v_pk_mul_f32 v[118:119], v[118:119], v[22:23]
    v_cvt_pk_bf16_f32 v144, v112, v113
    v_cvt_pk_bf16_f32 v145, v114, v115
    v_cvt_pk_bf16_f32 v146, v116, v117
    v_cvt_pk_bf16_f32 v147, v118, v119
    s_add_u32 s7, s4, 15360
    buffer_store_dwordx4 v[144:147], v1, s[44:47], s7 offen offset:0 sc1
    v_pk_mul_f32 v[120:121], v[120:121], v[152:153]
    v_pk_mul_f32 v[122:123], v[122:123], v[154:155]
    v_pk_mul_f32 v[124:125], v[124:125], v[156:157]
    v_pk_mul_f32 v[126:127], v[126:127], v[158:159]
    v_pk_mul_f32 v[120:121], v[120:121], v[22:23]
    v_pk_mul_f32 v[122:123], v[122:123], v[22:23]
    v_pk_mul_f32 v[124:125], v[124:125], v[22:23]
    v_pk_mul_f32 v[126:127], v[126:127], v[22:23]
    v_cvt_pk_bf16_f32 v152, v120, v121
    v_cvt_pk_bf16_f32 v153, v122, v123
    v_cvt_pk_bf16_f32 v154, v124, v125
    v_cvt_pk_bf16_f32 v155, v126, v127
    s_add_u32 s7, s4, 15360
    buffer_store_dwordx4 v[152:155], v1, s[44:47], s7 offen offset:512 sc1
    s_waitcnt lgkmcnt(6)
    v_mfma_f32_32x32x16_bf16 v[160:175], a[192:195], a[0:3], 0
    ds_read_b64_tr_b16 a[160:161], v13 offset:32768
    ds_read_b64_tr_b16 a[162:163], v13 offset:33536
    buffer_load_dwordx4 v[32:35], v16, s[44:47], s14 offen offset:0 sc1
    v_mfma_f32_32x32x16_bf16 v[176:191], a[196:199], a[0:3], 0
    ds_read_b64_tr_b16 a[164:165], v13 offset:32832
    ds_read_b64_tr_b16 a[166:167], v13 offset:33600
    v_mfma_f32_32x32x16_bf16 v[192:207], a[200:203], a[0:3], 0
    ds_read_b64_tr_b16 a[168:169], v13 offset:32896
    ds_read_b64_tr_b16 a[170:171], v13 offset:33664
    buffer_load_dwordx4 v[36:39], v15, s[44:47], s15 offen offset:0 sc1
    s_waitcnt lgkmcnt(6)
    v_mfma_f32_32x32x16_bf16 v[160:175], a[224:227], a[4:7], v[160:175]
    ds_read_b64_tr_b16 a[192:193], v14 offset:8192
    ds_read_b64_tr_b16 a[194:195], v14 offset:8960
    v_mfma_f32_32x32x16_bf16 v[176:191], a[228:231], a[4:7], v[176:191]
    ds_read_b64_tr_b16 a[196:197], v14 offset:8256
    ds_read_b64_tr_b16 a[198:199], v14 offset:9024
    buffer_load_dwordx4 a[172:175], v15, s[44:47], s9 offen offset:2048 sc1
    v_mfma_f32_32x32x16_bf16 v[192:207], a[232:235], a[4:7], v[192:207]
    ds_read_b64_tr_b16 a[200:201], v14 offset:8320
    ds_read_b64_tr_b16 a[202:203], v14 offset:9088
    s_waitcnt lgkmcnt(6)
    v_mfma_f32_32x32x16_bf16 v[160:175], a[160:163], a[8:11], v[160:175]
    s_barrier
    s_add_u32 m0, s60, 8192
    ds_read_b64_tr_b16 a[224:225], v12 offset:19456
    ds_read_b64_tr_b16 a[226:227], v12 offset:20224
    buffer_load_dwordx4 v2, s[32:35], s68 offen offset:0  lds
    v_mfma_f32_32x32x16_bf16 v[176:191], a[164:167], a[8:11], v[176:191]
    ds_read_b64_tr_b16 a[228:229], v12 offset:19520
    ds_read_b64_tr_b16 a[230:231], v12 offset:20288
    buffer_load_dword v212, v30, s[44:47], s62 offen offset:1024 sc1
    buffer_load_dword v216, v30, s[44:47], s62 offen offset:1280 sc1
    v_mfma_f32_32x32x16_bf16 v[192:207], a[168:171], a[8:11], v[192:207]
    ds_read_b64_tr_b16 a[232:233], v12 offset:19584
    ds_read_b64_tr_b16 a[234:235], v12 offset:20352
    buffer_load_dwordx4 v3, s[32:35], s68 offen offset:1024  lds
    s_waitcnt lgkmcnt(6)
    v_mfma_f32_32x32x16_bf16 v[160:175], a[192:195], a[12:15], v[160:175]
    ds_read_b64_tr_b16 a[160:161], v12 offset:60416
    ds_read_b64_tr_b16 a[162:163], v12 offset:61184
    v_mfma_f32_32x32x16_bf16 v[176:191], a[196:199], a[12:15], v[176:191]
    ds_read_b64_tr_b16 a[164:165], v12 offset:60480
    ds_read_b64_tr_b16 a[166:167], v12 offset:61248
    buffer_load_dwordx4 v4, s[32:35], s68 offen offset:2048  lds
    v_mfma_f32_32x32x16_bf16 v[192:207], a[200:203], a[12:15], v[192:207]
    ds_read_b64_tr_b16 a[168:169], v12 offset:60544
    ds_read_b64_tr_b16 a[170:171], v12 offset:61312
    s_waitcnt lgkmcnt(6)
    v_mfma_f32_32x32x16_bf16 v[160:175], a[224:227], a[16:19], v[160:175]
    ds_read_b64_tr_b16 a[192:193], v13 offset:35840
    ds_read_b64_tr_b16 a[194:195], v13 offset:36608
    buffer_load_dwordx4 a[176:179], v15, s[44:47], s9 offen offset:3072 sc1
    v_mfma_f32_32x32x16_bf16 v[176:191], a[228:231], a[16:19], v[176:191]
    ds_read_b64_tr_b16 a[196:197], v13 offset:35904
    ds_read_b64_tr_b16 a[198:199], v13 offset:36672
    v_mfma_f32_32x32x16_bf16 v[192:207], a[232:235], a[16:19], v[192:207]
    ds_read_b64_tr_b16 a[200:201], v13 offset:35968
    ds_read_b64_tr_b16 a[202:203], v13 offset:36736
    buffer_load_dwordx4 a[180:183], v16, s[44:47], s9 offen offset:0 sc1
    s_waitcnt lgkmcnt(6)
    v_mfma_f32_32x32x16_bf16 v[160:175], a[160:163], a[20:23], v[160:175]
    ds_read_b64_tr_b16 a[224:225], v14 offset:11264
    ds_read_b64_tr_b16 a[226:227], v14 offset:12032
    v_mfma_f32_32x32x16_bf16 v[176:191], a[164:167], a[20:23], v[176:191]
    ds_read_b64_tr_b16 a[228:229], v14 offset:11328
    ds_read_b64_tr_b16 a[230:231], v14 offset:12096
    buffer_load_dwordx4 a[184:187], v15, s[44:47], s10 offen offset:0 sc1
    v_mfma_f32_32x32x16_bf16 v[192:207], a[168:171], a[20:23], v[192:207]
    ds_read_b64_tr_b16 a[232:233], v14 offset:11392
    ds_read_b64_tr_b16 a[234:235], v14 offset:12160
    s_waitcnt lgkmcnt(6)
    v_mfma_f32_32x32x16_bf16 v[160:175], a[192:195], a[24:27], v[160:175]
    s_waitcnt vmcnt(22)
    s_barrier
    s_add_u32 m0, s60, 11264
    ds_read_b64_tr_b16 a[160:161], v12 offset:0
    ds_read_b64_tr_b16 a[162:163], v12 offset:768
    buffer_load_dwordx4 v2, s[32:35], s69 offen offset:0  lds
    v_mfma_f32_32x32x16_bf16 v[176:191], a[196:199], a[24:27], v[176:191]
    ds_read_b64_tr_b16 a[164:165], v12 offset:64
    ds_read_b64_tr_b16 a[166:167], v12 offset:832
    v_mfma_f32_32x32x16_bf16 v[192:207], a[200:203], a[24:27], v[192:207]
    ds_read_b64_tr_b16 a[168:169], v12 offset:128
    ds_read_b64_tr_b16 a[170:171], v12 offset:896
    buffer_load_dwordx4 v3, s[32:35], s69 offen offset:1024  lds
    s_waitcnt lgkmcnt(6)
    v_mfma_f32_32x32x16_bf16 v[160:175], a[224:227], a[28:31], v[160:175]
    ds_read_b64_tr_b16 a[192:193], v12 offset:40960
    ds_read_b64_tr_b16 a[194:195], v12 offset:41728
    v_mfma_f32_32x32x16_bf16 v[176:191], a[228:231], a[28:31], v[176:191]
    ds_read_b64_tr_b16 a[196:197], v12 offset:41024
    ds_read_b64_tr_b16 a[198:199], v12 offset:41792
    buffer_load_dwordx4 v4, s[32:35], s69 offen offset:2048  lds
    v_mfma_f32_32x32x16_bf16 v[192:207], a[232:235], a[28:31], v[192:207]
    ds_read_b64_tr_b16 a[200:201], v12 offset:41088
    ds_read_b64_tr_b16 a[202:203], v12 offset:41856
    s_waitcnt lgkmcnt(6)
    v_mfma_f32_32x32x16_bf16 v[160:175], a[160:163], a[32:35], v[160:175]
    ds_read_b64_tr_b16 a[224:225], v13 offset:16384
    ds_read_b64_tr_b16 a[226:227], v13 offset:17152
    buffer_load_dwordx4 a[188:191], v15, s[44:47], s10 offen offset:1024 sc1
    v_mfma_f32_32x32x16_bf16 v[176:191], a[164:167], a[32:35], v[176:191]
    ds_read_b64_tr_b16 a[228:229], v13 offset:16448
    ds_read_b64_tr_b16 a[230:231], v13 offset:17216
    v_mfma_f32_32x32x16_bf16 v[192:207], a[168:171], a[32:35], v[192:207]
    ds_read_b64_tr_b16 a[232:233], v13 offset:16512
    ds_read_b64_tr_b16 a[234:235], v13 offset:17280
    buffer_load_dwordx4 a[204:207], v15, s[44:47], s10 offen offset:2048 sc1
    s_waitcnt lgkmcnt(6)
    v_mfma_f32_32x32x16_bf16 v[160:175], a[192:195], a[36:39], v[160:175]
    ds_read_b64_tr_b16 a[160:161], v13 offset:57344
    ds_read_b64_tr_b16 a[162:163], v13 offset:58112
    v_mfma_f32_32x32x16_bf16 v[176:191], a[196:199], a[36:39], v[176:191]
    ds_read_b64_tr_b16 a[164:165], v13 offset:57408
    ds_read_b64_tr_b16 a[166:167], v13 offset:58176
    buffer_load_dwordx4 a[208:211], v15, s[44:47], s10 offen offset:3072 sc1
    v_mfma_f32_32x32x16_bf16 v[192:207], a[200:203], a[36:39], v[192:207]
    ds_read_b64_tr_b16 a[168:169], v13 offset:57472
    ds_read_b64_tr_b16 a[170:171], v13 offset:58240
    s_waitcnt lgkmcnt(6)
    v_mfma_f32_32x32x16_bf16 v[160:175], a[224:227], a[40:43], v[160:175]
    s_waitcnt vmcnt(25)
    s_barrier
    s_add_u32 m0, s60, 16384
    ds_read_b64_tr_b16 a[192:193], v12 offset:3072
    ds_read_b64_tr_b16 a[194:195], v12 offset:3840
    buffer_load_dwordx4 v2, s[32:35], s70 offen offset:0  lds
    v_mfma_f32_32x32x16_bf16 v[176:191], a[228:231], a[40:43], v[176:191]
    ds_read_b64_tr_b16 a[196:197], v12 offset:3136
    ds_read_b64_tr_b16 a[198:199], v12 offset:3904
    v_mfma_f32_32x32x16_bf16 v[192:207], a[232:235], a[40:43], v[192:207]
    ds_read_b64_tr_b16 a[200:201], v12 offset:3200
    ds_read_b64_tr_b16 a[202:203], v12 offset:3968
    buffer_load_dwordx4 v3, s[32:35], s70 offen offset:1024  lds
    s_waitcnt lgkmcnt(6)
    v_mfma_f32_32x32x16_bf16 v[160:175], a[160:163], a[44:47], v[160:175]
    ds_read_b64_tr_b16 a[224:225], v12 offset:44032
    ds_read_b64_tr_b16 a[226:227], v12 offset:44800
    v_mfma_f32_32x32x16_bf16 v[176:191], a[164:167], a[44:47], v[176:191]
    ds_read_b64_tr_b16 a[228:229], v12 offset:44096
    ds_read_b64_tr_b16 a[230:231], v12 offset:44864
    buffer_load_dwordx4 v4, s[32:35], s70 offen offset:2048  lds
    v_mfma_f32_32x32x16_bf16 v[192:207], a[168:171], a[44:47], v[192:207]
    ds_read_b64_tr_b16 a[232:233], v12 offset:44160
    ds_read_b64_tr_b16 a[234:235], v12 offset:44928
    s_waitcnt lgkmcnt(6)
    v_mfma_f32_32x32x16_bf16 v[160:175], a[192:195], a[48:51], v[160:175]
    ds_read_b64_tr_b16 a[160:161], v13 offset:19456
    ds_read_b64_tr_b16 a[162:163], v13 offset:20224
    s_waitcnt vmcnt(14)
    v_cvt_pk_bf16_f32 v215, v212, 1.0
    v_lshlrev_b32 v213, 16, v215
    v_sub_f32 v213, v212, v213
    v_mfma_f32_32x32x16_bf16 v[176:191], a[196:199], a[48:51], v[176:191]
    ds_read_b64_tr_b16 a[164:165], v13 offset:19520
    ds_read_b64_tr_b16 a[166:167], v13 offset:20288
    v_cvt_pk_bf16_f32 v214, v212, v213
    v_cvt_pk_bf16_f32 v219, v216, 1.0
    v_lshlrev_b32 v217, 16, v219
    v_sub_f32 v217, v216, v217
    v_mfma_f32_32x32x16_bf16 v[192:207], a[200:203], a[48:51], v[192:207]
    ds_read_b64_tr_b16 a[168:169], v13 offset:19584
    ds_read_b64_tr_b16 a[170:171], v13 offset:20352
    v_cvt_pk_bf16_f32 v218, v216, v217
    s_waitcnt lgkmcnt(6)
    v_mfma_f32_32x32x16_bf16 v[160:175], a[224:227], a[52:55], v[160:175]
    ds_read_b64_tr_b16 a[192:193], v13 offset:60416
    ds_read_b64_tr_b16 a[194:195], v13 offset:61184
    v_mfma_f32_32x32x8_bf16 v[160:175], v[214:215], v[24:25], v[160:175]
    v_mfma_f32_32x32x16_bf16 v[176:191], a[228:231], a[52:55], v[176:191]
    ds_read_b64_tr_b16 a[196:197], v13 offset:60480
    ds_read_b64_tr_b16 a[198:199], v13 offset:61248
    v_mfma_f32_32x32x8_bf16 v[176:191], v[214:215], v[26:27], v[176:191]
    v_mfma_f32_32x32x16_bf16 v[192:207], a[232:235], a[52:55], v[192:207]
    ds_read_b64_tr_b16 a[200:201], v13 offset:60544
    ds_read_b64_tr_b16 a[202:203], v13 offset:61312
    v_mfma_f32_32x32x8_bf16 v[192:207], v[218:219], v[24:25], v[192:207]
    s_waitcnt lgkmcnt(6)
    v_mfma_f32_32x32x16_bf16 v[160:175], a[160:163], a[56:59], v[160:175]
    s_waitcnt vmcnt(12)
    s_barrier
    s_add_u32 m0, s60, 0
    ds_read_b64_tr_b16 a[224:225], v12 offset:8192
    ds_read_b64_tr_b16 a[226:227], v12 offset:8960
    buffer_load_dwordx4 v2, s[32:35], s71 offen offset:0  lds
    v_mfma_f32_32x32x16_bf16 v[176:191], a[164:167], a[56:59], v[176:191]
    ds_read_b64_tr_b16 a[228:229], v12 offset:8256
    ds_read_b64_tr_b16 a[230:231], v12 offset:9024
    v_mfma_f32_32x32x16_bf16 v[192:207], a[168:171], a[56:59], v[192:207]
    ds_read_b64_tr_b16 a[232:233], v12 offset:8320
    ds_read_b64_tr_b16 a[234:235], v12 offset:9088
    buffer_load_dwordx4 v3, s[32:35], s71 offen offset:1024  lds
    s_waitcnt lgkmcnt(6)
    v_mfma_f32_32x32x16_bf16 v[160:175], a[192:195], a[60:63], v[160:175]
    ds_read_b64_tr_b16 a[160:161], v12 offset:49152
    ds_read_b64_tr_b16 a[162:163], v12 offset:49920
    v_mfma_f32_32x32x16_bf16 v[176:191], a[196:199], a[60:63], v[176:191]
    ds_read_b64_tr_b16 a[164:165], v12 offset:49216
    ds_read_b64_tr_b16 a[166:167], v12 offset:49984
    buffer_load_dwordx4 v4, s[32:35], s71 offen offset:2048  lds
    v_mfma_f32_32x32x16_bf16 v[192:207], a[200:203], a[60:63], v[192:207]
    ds_read_b64_tr_b16 a[168:169], v12 offset:49280
    ds_read_b64_tr_b16 a[170:171], v12 offset:50048
    s_waitcnt lgkmcnt(6)
    v_mfma_f32_32x32x16_bf16 v[160:175], a[224:227], a[64:67], v[160:175]
    ds_read_b64_tr_b16 a[192:193], v13 offset:24576
    ds_read_b64_tr_b16 a[194:195], v13 offset:25344
    buffer_load_dwordx4 a[212:215], v16, s[44:47], s10 offen offset:0 sc1
    v_mfma_f32_32x32x16_bf16 v[176:191], a[228:231], a[64:67], v[176:191]
    ds_read_b64_tr_b16 a[196:197], v13 offset:24640
    ds_read_b64_tr_b16 a[198:199], v13 offset:25408
    v_mfma_f32_32x32x16_bf16 v[192:207], a[232:235], a[64:67], v[192:207]
    ds_read_b64_tr_b16 a[200:201], v13 offset:24704
    ds_read_b64_tr_b16 a[202:203], v13 offset:25472
    buffer_load_dwordx4 a[216:219], v15, s[44:47], s11 offen offset:0 sc1
    s_waitcnt lgkmcnt(6)
    v_mfma_f32_32x32x16_bf16 v[160:175], a[160:163], a[68:71], v[160:175]
    ds_read_b64_tr_b16 a[224:225], v14 offset:0
    ds_read_b64_tr_b16 a[226:227], v14 offset:768
    v_mfma_f32_32x32x16_bf16 v[176:191], a[164:167], a[68:71], v[176:191]
    ds_read_b64_tr_b16 a[228:229], v14 offset:64
    ds_read_b64_tr_b16 a[230:231], v14 offset:832
    buffer_load_dwordx4 a[220:223], v15, s[44:47], s11 offen offset:1024 sc1
    v_mfma_f32_32x32x16_bf16 v[192:207], a[168:171], a[68:71], v[192:207]
    ds_read_b64_tr_b16 a[232:233], v14 offset:128
    ds_read_b64_tr_b16 a[234:235], v14 offset:896
    s_waitcnt lgkmcnt(6)
    v_mfma_f32_32x32x16_bf16 v[160:175], a[192:195], a[72:75], v[160:175]
    s_waitcnt vmcnt(12)
    s_barrier
    s_add_u32 m0, s60, 3072
    ds_read_b64_tr_b16 a[160:161], v12 offset:11264
    ds_read_b64_tr_b16 a[162:163], v12 offset:12032
    buffer_load_dwordx4 v2, s[32:35], s72 offen offset:0  lds
    v_mfma_f32_32x32x16_bf16 v[176:191], a[196:199], a[72:75], v[176:191]
    ds_read_b64_tr_b16 a[164:165], v12 offset:11328
    ds_read_b64_tr_b16 a[166:167], v12 offset:12096
    s_cmp_eq_u32 s3, 0
    s_cselect_b32 s7, s90, 2146435072
    v_lshlrev_b32 v5, 8, v0
    s_mov_b64 exec, 0xffff
    buffer_atomic_add v11, v5, s[44:47], s7 offen offset:4 sc1
    s_mov_b64 exec, -1
    v_mfma_f32_32x32x16_bf16 v[192:207], a[200:203], a[72:75], v[192:207]
    ds_read_b64_tr_b16 a[168:169], v12 offset:11392
    ds_read_b64_tr_b16 a[170:171], v12 offset:12160
    buffer_load_dwordx4 v3, s[32:35], s72 offen offset:1024  lds
    s_waitcnt lgkmcnt(6)
    v_mfma_f32_32x32x16_bf16 v[160:175], a[224:227], a[76:79], v[160:175]
    ds_read_b64_tr_b16 a[192:193], v12 offset:52224
    ds_read_b64_tr_b16 a[194:195], v12 offset:52992
    v_mfma_f32_32x32x16_bf16 v[176:191], a[228:231], a[76:79], v[176:191]
    ds_read_b64_tr_b16 a[196:197], v12 offset:52288
    ds_read_b64_tr_b16 a[198:199], v12 offset:53056
    buffer_load_dwordx4 v4, s[32:35], s72 offen offset:2048  lds
    v_mfma_f32_32x32x16_bf16 v[192:207], a[232:235], a[76:79], v[192:207]
    ds_read_b64_tr_b16 a[200:201], v12 offset:52352
    ds_read_b64_tr_b16 a[202:203], v12 offset:53120
    s_waitcnt lgkmcnt(6)
    v_mfma_f32_32x32x16_bf16 v[160:175], a[160:163], a[80:83], v[160:175]
    ds_read_b64_tr_b16 a[224:225], v13 offset:27648
    ds_read_b64_tr_b16 a[226:227], v13 offset:28416
    s_getpc_b64 s[100:101]
PC2B:
    s_sub_u32 s100, s100, PC2B - LTAB - 13312
    s_subb_u32 s101, s101, 0
    v_lshlrev_b32 v7, 4, v0
    global_load_dwordx4 v[220:223], v7, s[100:101] offset:0
    global_load_dwordx4 v[224:227], v7, s[100:101] offset:1024
    global_load_dwordx4 v[208:211], v7, s[100:101] offset:2048
    v_mfma_f32_32x32x16_bf16 v[176:191], a[164:167], a[80:83], v[176:191]
    ds_read_b64_tr_b16 a[228:229], v13 offset:27712
    ds_read_b64_tr_b16 a[230:231], v13 offset:28480
    buffer_load_dwordx4 a[236:239], v15, s[44:47], s11 offen offset:2048 sc1
    v_mfma_f32_32x32x16_bf16 v[192:207], a[168:171], a[80:83], v[192:207]
    ds_read_b64_tr_b16 a[232:233], v13 offset:27776
    ds_read_b64_tr_b16 a[234:235], v13 offset:28544
    s_waitcnt lgkmcnt(6)
    v_mfma_f32_32x32x16_bf16 v[160:175], a[192:195], a[84:87], v[160:175]
    ds_read_b64_tr_b16 a[160:161], v14 offset:3072
    ds_read_b64_tr_b16 a[162:163], v14 offset:3840
    buffer_load_dwordx4 a[240:243], v15, s[44:47], s11 offen offset:3072 sc1
    v_mfma_f32_32x32x16_bf16 v[176:191], a[196:199], a[84:87], v[176:191]
    ds_read_b64_tr_b16 a[164:165], v14 offset:3136
    ds_read_b64_tr_b16 a[166:167], v14 offset:3904
    v_mfma_f32_32x32x16_bf16 v[192:207], a[200:203], a[84:87], v[192:207]
    ds_read_b64_tr_b16 a[168:169], v14 offset:3200
    ds_read_b64_tr_b16 a[170:171], v14 offset:3968
    buffer_load_dwordx4 a[244:247], v16, s[44:47], s11 offen offset:0 sc1
    s_waitcnt lgkmcnt(6)
    v_mfma_f32_32x32x16_bf16 v[160:175], a[224:227], a[88:91], v[160:175]
    s_waitcnt vmcnt(16)
    s_barrier
    s_add_u32 m0, s60, 8192
    ds_read_b64_tr_b16 a[192:193], v12 offset:16384
    ds_read_b64_tr_b16 a[194:195], v12 offset:17152
    buffer_load_dwordx4 v2, s[32:35], s73 offen offset:0  lds
    v_mfma_f32_32x32x16_bf16 v[176:191], a[228:231], a[88:91], v[176:191]
    ds_read_b64_tr_b16 a[196:197], v12 offset:16448
    ds_read_b64_tr_b16 a[198:199], v12 offset:17216
    v_mfma_f32_32x32x16_bf16 v[192:207], a[232:235], a[88:91], v[192:207]
    ds_read_b64_tr_b16 a[200:201], v12 offset:16512
    ds_read_b64_tr_b16 a[202:203], v12 offset:17280
    buffer_load_dwordx4 v3, s[32:35], s73 offen offset:1024  lds
    s_waitcnt lgkmcnt(6)
    v_mfma_f32_32x32x16_bf16 v[160:175], a[160:163], a[92:95], v[160:175]
    ds_read_b64_tr_b16 a[224:225], v12 offset:57344
    ds_read_b64_tr_b16 a[226:227], v12 offset:58112
    v_mfma_f32_32x32x16_bf16 v[176:191], a[164:167], a[92:95], v[176:191]
    ds_read_b64_tr_b16 a[228:229], v12 offset:57408
    ds_read_b64_tr_b16 a[230:231], v12 offset:58176
    buffer_load_dwordx4 v4, s[32:35], s73 offen offset:2048  lds
    v_mfma_f32_32x32x16_bf16 v[192:207], a[168:171], a[92:95], v[192:207]
    ds_read_b64_tr_b16 a[232:233], v12 offset:57472
    ds_read_b64_tr_b16 a[234:235], v12 offset:58240
    s_waitcnt lgkmcnt(6)
    v_mfma_f32_32x32x16_bf16 v[160:175], a[192:195], a[96:99], v[160:175]
    ds_read_b64_tr_b16 a[160:161], v13 offset:32768
    ds_read_b64_tr_b16 a[162:163], v13 offset:33536
    buffer_load_dwordx4 a[248:251], v15, s[44:47], s12 offen offset:0 sc1
    v_mfma_f32_32x32x16_bf16 v[176:191], a[196:199], a[96:99], v[176:191]
    ds_read_b64_tr_b16 a[164:165], v13 offset:32832
    ds_read_b64_tr_b16 a[166:167], v13 offset:33600
    v_mfma_f32_32x32x16_bf16 v[192:207], a[200:203], a[96:99], v[192:207]
    ds_read_b64_tr_b16 a[168:169], v13 offset:32896
    ds_read_b64_tr_b16 a[170:171], v13 offset:33664
    buffer_load_dwordx4 a[252:255], v15, s[44:47], s12 offen offset:1024 sc1
    s_waitcnt lgkmcnt(6)
    v_mfma_f32_32x32x16_bf16 v[160:175], a[224:227], a[100:103], v[160:175]
    ds_read_b64_tr_b16 a[192:193], v14 offset:8192
    ds_read_b64_tr_b16 a[194:195], v14 offset:8960
    v_mfma_f32_32x32x16_bf16 v[176:191], a[228:231], a[100:103], v[176:191]
    ds_read_b64_tr_b16 a[196:197], v14 offset:8256
    ds_read_b64_tr_b16 a[198:199], v14 offset:9024
    buffer_load_dwordx4 a[0:3], v15, s[44:47], s12 offen offset:2048 sc1
    v_mfma_f32_32x32x16_bf16 v[192:207], a[232:235], a[100:103], v[192:207]
    ds_read_b64_tr_b16 a[200:201], v14 offset:8320
    ds_read_b64_tr_b16 a[202:203], v14 offset:9088
    s_waitcnt lgkmcnt(6)
    v_mfma_f32_32x32x16_bf16 v[160:175], a[160:163], a[104:107], v[160:175]
    s_waitcnt vmcnt(19)
    s_barrier
    ds_read_b64_tr_b16 a[224:225], v12 offset:0
    ds_read_b64_tr_b16 a[226:227], v12 offset:768
    s_waitcnt vmcnt(9)
    s_mul_i32 s7, s3, 1792
    s_add_u32 s95, s95, s7
    v_subrev_u32 v21, s3, v208
    v_mov_b32 v31, 2146435072
    v_mfma_f32_32x32x16_bf16 v[176:191], a[164:167], a[104:107], v[176:191]
    ds_read_b64_tr_b16 a[228:229], v12 offset:64
    ds_read_b64_tr_b16 a[230:231], v12 offset:832
    v_add_u32 v28, 0, v21
    v_cmp_gt_u32 vcc, 5, v28
    v_mul_u32_u24 v28, 336, v28
    v_add_u32 v28, v28, v227
    v_cndmask_b32 v7, v31, v28, vcc
    v_mfma_f32_32x32x16_bf16 v[192:207], a[168:171], a[104:107], v[192:207]
    ds_read_b64_tr_b16 a[232:233], v12 offset:128
    ds_read_b64_tr_b16 a[234:235], v12 offset:896
    v_add_u32 v28, 2, v21
    v_cmp_gt_u32 vcc, 5, v28
    v_mul_u32_u24 v28, 336, v28
    v_add_u32 v28, v28, v227
    v_cndmask_b32 v9, v31, v28, vcc
    s_waitcnt lgkmcnt(6)
    v_mfma_f32_32x32x16_bf16 v[160:175], a[192:195], a[108:111], v[160:175]
    ds_read_b64_tr_b16 a[160:161], v12 offset:40960
    ds_read_b64_tr_b16 a[162:163], v12 offset:41728
    v_add_u32 v28, 4, v21
    v_cmp_gt_u32 vcc, 5, v28
    v_mul_u32_u24 v28, 336, v28
    v_add_u32 v28, v28, v227
    v_cndmask_b32 v10, v31, v28, vcc
    v_mfma_f32_32x32x16_bf16 v[176:191], a[196:199], a[108:111], v[176:191]
    ds_read_b64_tr_b16 a[164:165], v12 offset:41024
    ds_read_b64_tr_b16 a[166:167], v12 offset:41792
    v_add_u32 v28, 6, v21
    v_cmp_gt_u32 vcc, 5, v28
    v_mul_u32_u24 v28, 336, v28
    v_add_u32 v28, v28, v227
    v_cndmask_b32 v17, v31, v28, vcc
    v_mfma_f32_32x32x16_bf16 v[192:207], a[200:203], a[108:111], v[192:207]
    ds_read_b64_tr_b16 a[168:169], v12 offset:41088
    ds_read_b64_tr_b16 a[170:171], v12 offset:41856
    s_lshr_b32 s7, s87, 1
    s_mul_i32 s4, s7, 10240
    s_add_u32 s4, s4, 245760
    s_lshr_b32 s5, s7, 1
    s_mul_i32 s5, s5, 5120
    s_waitcnt lgkmcnt(6)
    v_mfma_f32_32x32x16_bf16 v[160:175], a[224:227], a[112:115], v[160:175]
    ds_read_b64_tr_b16 a[192:193], v13 offset:16384
    ds_read_b64_tr_b16 a[194:195], v13 offset:17152
    s_bfe_u32 s7, s87, 0x10001
    s_lshl_b32 s7, s7, 9
    s_add_u32 s5, s5, s7
    s_add_u32 s5, s5, 327680
    v_mfma_f32_32x32x16_bf16 v[176:191], a[228:231], a[112:115], v[176:191]
    ds_read_b64_tr_b16 a[196:197], v13 offset:16448
    ds_read_b64_tr_b16 a[198:199], v13 offset:17216
    s_lshl_b32 s7, s3, 11
    v_lshlrev_b32 v26, 4, v0
    v_add_u32 v27, s7, v26
    v_cmp_eq_u32 vcc, 0, v208
    v_mfma_f32_32x32x16_bf16 v[192:207], a[232:235], a[112:115], v[192:207]
    ds_read_b64_tr_b16 a[200:201], v13 offset:16512
    ds_read_b64_tr_b16 a[202:203], v13 offset:17280
    v_mov_b32 v136, v19
    v_mov_b32 v137, v19
    v_mov_b32 v138, v18
    v_mov_b32 v139, v18
    s_waitcnt lgkmcnt(6)
    v_mfma_f32_32x32x16_bf16 v[160:175], a[160:163], a[116:119], v[160:175]
    ds_read_b64_tr_b16 a[224:225], v13 offset:57344
    ds_read_b64_tr_b16 a[226:227], v13 offset:58112
    buffer_load_dwordx4 a[4:7], v15, s[44:47], s12 offen offset:3072 sc1
    v_mfma_f32_32x32x16_bf16 v[176:191], a[164:167], a[116:119], v[176:191]
    ds_read_b64_tr_b16 a[228:229], v13 offset:57408
    ds_read_b64_tr_b16 a[230:231], v13 offset:58176
    v_mfma_f32_32x32x16_bf16 v[192:207], a[168:171], a[116:119], v[192:207]
    ds_read_b64_tr_b16 a[232:233], v13 offset:57472
    ds_read_b64_tr_b16 a[234:235], v13 offset:58240
    buffer_load_dwordx4 a[8:11], v16, s[44:47], s12 offen offset:0 sc1
    s_waitcnt lgkmcnt(6)
    v_mfma_f32_32x32x16_bf16 v[160:175], a[192:195], a[120:123], v[160:175]
    s_barrier
    ds_read_b64_tr_b16 a[160:161], v12 offset:3072
    ds_read_b64_tr_b16 a[162:163], v12 offset:3840
    v_mfma_f32_32x32x16_bf16 v[176:191], a[196:199], a[120:123], v[176:191]
    ds_read_b64_tr_b16 a[164:165], v12 offset:3136
    ds_read_b64_tr_b16 a[166:167], v12 offset:3904
    buffer_load_dwordx4 a[12:15], v15, s[44:47], s13 offen offset:0 sc1
    v_mfma_f32_32x32x16_bf16 v[192:207], a[200:203], a[120:123], v[192:207]
    ds_read_b64_tr_b16 a[168:169], v12 offset:3200
    ds_read_b64_tr_b16 a[170:171], v12 offset:3968
    s_waitcnt lgkmcnt(6)
    v_mfma_f32_32x32x16_bf16 v[160:175], a[224:227], a[124:127], v[160:175]
    ds_read_b64_tr_b16 a[192:193], v12 offset:44032
    ds_read_b64_tr_b16 a[194:195], v12 offset:44800
    buffer_load_dwordx4 a[16:19], v15, s[44:47], s13 offen offset:1024 sc1
    v_mfma_f32_32x32x16_bf16 v[176:191], a[228:231], a[124:127], v[176:191]
    ds_read_b64_tr_b16 a[196:197], v12 offset:44096
    ds_read_b64_tr_b16 a[198:199], v12 offset:44864
    v_mfma_f32_32x32x16_bf16 v[192:207], a[232:235], a[124:127], v[192:207]
    ds_read_b64_tr_b16 a[200:201], v12 offset:44160
    ds_read_b64_tr_b16 a[202:203], v12 offset:44928
    buffer_load_dwordx4 a[20:23], v15, s[44:47], s13 offen offset:2048 sc1
    s_waitcnt lgkmcnt(6)
    v_mfma_f32_32x32x16_bf16 v[160:175], a[160:163], a[128:131], v[160:175]
    ds_read_b64_tr_b16 a[224:225], v13 offset:19456
    ds_read_b64_tr_b16 a[226:227], v13 offset:20224
    v_mfma_f32_32x32x16_bf16 v[176:191], a[164:167], a[128:131], v[176:191]
    ds_read_b64_tr_b16 a[228:229], v13 offset:19520
    ds_read_b64_tr_b16 a[230:231], v13 offset:20288
    buffer_load_dwordx4 a[24:27], v15, s[44:47], s13 offen offset:3072 sc1
    v_mfma_f32_32x32x16_bf16 v[192:207], a[168:171], a[128:131], v[192:207]
    ds_read_b64_tr_b16 a[232:233], v13 offset:19584
    ds_read_b64_tr_b16 a[234:235], v13 offset:20352
    s_waitcnt lgkmcnt(6)
    v_mfma_f32_32x32x16_bf16 v[160:175], a[192:195], a[132:135], v[160:175]
    ds_read_b64_tr_b16 a[160:161], v13 offset:60416
    ds_read_b64_tr_b16 a[162:163], v13 offset:61184
    buffer_load_dword v6, off, s[44:47], s89 offset:4 sc1
    buffer_load_dword v8, off, s[44:47], s91 offset:0 sc1
    v_mfma_f32_32x32x16_bf16 v[176:191], a[196:199], a[132:135], v[176:191]
    ds_read_b64_tr_b16 a[164:165], v13 offset:60480
    ds_read_b64_tr_b16 a[166:167], v13 offset:61248
    buffer_load_dwordx4 a[28:31], v16, s[44:47], s13 offen offset:0 sc1
    v_mfma_f32_32x32x16_bf16 v[192:207], a[200:203], a[132:135], v[192:207]
    ds_read_b64_tr_b16 a[168:169], v13 offset:60544
    ds_read_b64_tr_b16 a[170:171], v13 offset:61312
    s_waitcnt lgkmcnt(6)
    v_mfma_f32_32x32x16_bf16 v[160:175], a[224:227], a[136:139], v[160:175]
    s_waitcnt vmcnt(12)
    s_barrier
    ds_read_b64_tr_b16 a[192:193], v12 offset:8192
    ds_read_b64_tr_b16 a[194:195], v12 offset:8960
    buffer_load_dwordx4 a[32:35], v15, s[44:47], s14 offen offset:0 sc1
    v_mfma_f32_32x32x16_bf16 v[176:191], a[228:231], a[136:139], v[176:191]
    ds_read_b64_tr_b16 a[196:197], v12 offset:8256
    ds_read_b64_tr_b16 a[198:199], v12 offset:9024
    v_mfma_f32_32x32x16_bf16 v[192:207], a[232:235], a[136:139], v[192:207]
    ds_read_b64_tr_b16 a[200:201], v12 offset:8320
    ds_read_b64_tr_b16 a[202:203], v12 offset:9088
    buffer_load_dwordx4 a[36:39], v15, s[44:47], s14 offen offset:1024 sc1
    s_waitcnt lgkmcnt(6)
    v_mfma_f32_32x32x16_bf16 v[160:175], a[160:163], a[140:143], v[160:175]
    ds_read_b64_tr_b16 a[224:225], v12 offset:49152
    ds_read_b64_tr_b16 a[226:227], v12 offset:49920
    v_mfma_f32_32x32x16_bf16 v[176:191], a[164:167], a[140:143], v[176:191]
    ds_read_b64_tr_b16 a[228:229], v12 offset:49216
    ds_read_b64_tr_b16 a[230:231], v12 offset:49984
    buffer_load_dwordx4 a[40:43], v15, s[44:47], s14 offen offset:2048 sc1
    v_mfma_f32_32x32x16_bf16 v[192:207], a[168:171], a[140:143], v[192:207]
    ds_read_b64_tr_b16 a[232:233], v12 offset:49280
    ds_read_b64_tr_b16 a[234:235], v12 offset:50048
    s_waitcnt lgkmcnt(6)
    v_mfma_f32_32x32x16_bf16 v[160:175], a[192:195], a[144:147], v[160:175]
    ds_read_b64_tr_b16 a[160:161], v13 offset:24576
    ds_read_b64_tr_b16 a[162:163], v13 offset:25344
    s_waitcnt vmcnt(4)
    v_readfirstlane_b32 s98, v8
    s_cmp_ge_u32 s98, 2097152
    s_cbranch_scc0 SPIN24
RET24:
    v_mfma_f32_32x32x16_bf16 v[176:191], a[196:199], a[144:147], v[176:191]
    ds_read_b64_tr_b16 a[164:165], v13 offset:24640
    ds_read_b64_tr_b16 a[166:167], v13 offset:25408
    buffer_load_dwordx4 v[96:99], v7, s[44:47], s95 offen sc1
    v_mfma_f32_32x32x16_bf16 v[192:207], a[200:203], a[144:147], v[192:207]
    ds_read_b64_tr_b16 a[168:169], v13 offset:24704
    ds_read_b64_tr_b16 a[170:171], v13 offset:25472
    buffer_load_dwordx4 v[100:103], v9, s[44:47], s95 offen sc1
    s_waitcnt lgkmcnt(6)
    v_mfma_f32_32x32x16_bf16 v[160:175], a[224:227], a[148:151], v[160:175]
    ds_read_b64_tr_b16 a[192:193], v14 offset:0
    ds_read_b64_tr_b16 a[194:195], v14 offset:768
    buffer_load_dwordx4 v[104:107], v10, s[44:47], s95 offen sc1
    v_mfma_f32_32x32x16_bf16 v[176:191], a[228:231], a[148:151], v[176:191]
    ds_read_b64_tr_b16 a[196:197], v14 offset:64
    ds_read_b64_tr_b16 a[198:199], v14 offset:832
    buffer_load_dwordx4 v[108:111], v17, s[44:47], s95 offen sc1
    v_mfma_f32_32x32x16_bf16 v[192:207], a[232:235], a[148:151], v[192:207]
    ds_read_b64_tr_b16 a[200:201], v14 offset:128
    ds_read_b64_tr_b16 a[202:203], v14 offset:896
    s_waitcnt lgkmcnt(6)
    v_mfma_f32_32x32x16_bf16 v[160:175], a[160:163], a[152:155], v[160:175]
    v_readfirstlane_b32 s98, v6
    s_cmp_ge_u32 s98, 1048576
    s_cbranch_scc0 SPIN25
RET25:
    v_lshlrev_b32 v6, 4, v0
    v_add_u32 v6, s93, v6
    s_add_u32 s7, s3, 0
    s_and_b32 s7, s7, 3
    s_lshl_b32 s7, s7, 10
    v_add_u32 v2, s7, v6
    s_add_u32 s7, s3, 1
    s_and_b32 s7, s7, 3
    s_lshl_b32 s7, s7, 10
    v_add_u32 v3, s7, v6
    s_add_u32 s7, s3, 2
    s_and_b32 s7, s7, 3
    s_lshl_b32 s7, s7, 10
    v_add_u32 v4, s7, v6
    s_add_u32 s7, s3, 3
    s_and_b32 s7, s7, 3
    s_lshl_b32 s7, s7, 10
    v_add_u32 v5, s7, v6
    v_mfma_f32_32x32x16_bf16 v[176:191], a[164:167], a[152:155], v[176:191]
    buffer_load_dwordx4 v[48:51], v2, s[44:47], s8 offen sc1
    v_mfma_f32_32x32x16_bf16 v[192:207], a[168:171], a[152:155], v[192:207]
    buffer_load_dwordx4 v[52:55], v3, s[44:47], s8 offen sc1
    s_waitcnt lgkmcnt(0)
    v_mfma_f32_32x32x16_bf16 v[160:175], a[192:195], a[156:159], v[160:175]
    buffer_load_dwordx4 v[56:59], v4, s[44:47], s8 offen sc1
    v_mfma_f32_32x32x16_bf16 v[176:191], a[196:199], a[156:159], v[176:191]
    buffer_load_dwordx4 v[60:63], v5, s[44:47], s8 offen sc1
    v_mfma_f32_32x32x16_bf16 v[192:207], a[200:203], a[156:159], v[192:207]
    buffer_load_dwordx4 v[64:67], v2, s[44:47], s9 offen sc1
    buffer_load_dwordx4 v[68:71], v3, s[44:47], s9 offen sc1
    buffer_load_dwordx4 v[72:75], v4, s[44:47], s9 offen sc1
    buffer_load_dwordx4 v[76:79], v5, s[44:47], s9 offen sc1
    buffer_load_dwordx4 v[80:83], v2, s[44:47], s10 offen sc1
    buffer_load_dwordx4 v[84:87], v3, s[44:47], s10 offen sc1
    buffer_load_dwordx4 v[88:91], v4, s[44:47], s10 offen sc1
    buffer_load_dwordx4 v[92:95], v5, s[44:47], s10 offen sc1
    s_mul_i32 s7, s3, 20480
    s_add_u32 s94, s94, s7
    s_nop 8
    v_pk_mul_f32 v[128:129], v[160:161], v[136:137]
    v_pk_mul_f32 v[130:131], v[162:163], v[136:137]
    v_pk_mul_f32 v[132:133], v[164:165], v[136:137]
    v_pk_mul_f32 v[134:135], v[166:167], v[136:137]
    v_exp_f32_e64 v128, v128 clamp
    v_max_f32 v160, v20, v160
    v_exp_f32_e64 v129, v129 clamp
    v_max_f32 v161, v20, v161
    v_exp_f32_e64 v130, v130 clamp
    v_max_f32 v162, v20, v162
    v_exp_f32_e64 v131, v131 clamp
    v_max_f32 v163, v20, v163
    v_exp_f32_e64 v132, v132 clamp
    v_max_f32 v164, v20, v164
    v_exp_f32_e64 v133, v133 clamp
    v_max_f32 v165, v20, v165
    v_exp_f32_e64 v134, v134 clamp
    v_max_f32 v166, v20, v166
    v_exp_f32_e64 v135, v135 clamp
    v_max_f32 v167, v20, v167
    v_pk_fma_f32 v[160:161], v[160:161], v[138:139], v[128:129]
    v_pk_fma_f32 v[162:163], v[162:163], v[138:139], v[130:131]
    v_pk_fma_f32 v[164:165], v[164:165], v[138:139], v[132:133]
    v_pk_fma_f32 v[166:167], v[166:167], v[138:139], v[134:135]
    v_cvt_pk_bf16_f32 v160, v160, v161
    v_cvt_pk_bf16_f32 v161, v162, v163
    v_cvt_pk_bf16_f32 v162, v164, v165
    v_cvt_pk_bf16_f32 v163, v166, v167
    buffer_load_dwordx4 a[44:47], v15, s[44:47], s14 offen offset:3072 sc1
    buffer_load_dwordx4 v[40:43], v15, s[44:47], s15 offen offset:1024 sc1
    v_pk_mul_f32 v[128:129], v[168:169], v[136:137]
    v_pk_mul_f32 v[130:131], v[170:171], v[136:137]
    v_pk_mul_f32 v[132:133], v[172:173], v[136:137]
    v_pk_mul_f32 v[134:135], v[174:175], v[136:137]
    v_exp_f32_e64 v128, v128 clamp
    v_max_f32 v168, v20, v168
    v_exp_f32_e64 v129, v129 clamp
    v_max_f32 v169, v20, v169
    v_exp_f32_e64 v130, v130 clamp
    v_max_f32 v170, v20, v170
    v_exp_f32_e64 v131, v131 clamp
    v_max_f32 v171, v20, v171
    v_exp_f32_e64 v132, v132 clamp
    v_max_f32 v172, v20, v172
    v_exp_f32_e64 v133, v133 clamp
    v_max_f32 v173, v20, v173
    v_exp_f32_e64 v134, v134 clamp
    v_max_f32 v174, v20, v174
    v_exp_f32_e64 v135, v135 clamp
    v_max_f32 v175, v20, v175
    v_pk_fma_f32 v[168:169], v[168:169], v[138:139], v[128:129]
    v_pk_fma_f32 v[170:171], v[170:171], v[138:139], v[130:131]
    v_pk_fma_f32 v[172:173], v[172:173], v[138:139], v[132:133]
    v_pk_fma_f32 v[174:175], v[174:175], v[138:139], v[134:135]
    v_cvt_pk_bf16_f32 v164, v168, v169
    v_cvt_pk_bf16_f32 v165, v170, v171
    v_cvt_pk_bf16_f32 v166, v172, v173
    v_cvt_pk_bf16_f32 v167, v174, v175
    buffer_load_dwordx4 v[44:47], v15, s[44:47], s15 offen offset:2048 sc1
    buffer_load_dwordx4 a[48:51], v15, s[44:47], s15 offen offset:3072 sc1
    s_waitcnt vmcnt(16)
    v_cvt_pk_bf16_f32 v96, v96, v97
    v_cvt_pk_bf16_f32 v97, v98, v99
    v_cvt_pk_bf16_f32 v98, v100, v101
    v_cvt_pk_bf16_f32 v99, v102, v103
    v_cvt_pk_bf16_f32 v100, v104, v105
    v_cvt_pk_bf16_f32 v101, v106, v107
    v_cvt_pk_bf16_f32 v102, v108, v109
    v_cvt_pk_bf16_f32 v103, v110, v111
    ds_write_b128 v27, v[96:99] offset:11264
    ds_write_b128 v27, v[100:103] offset:12288
    v_pk_mul_f32 v[128:129], v[176:177], v[136:137]
    v_pk_mul_f32 v[130:131], v[178:179], v[136:137]
    v_pk_mul_f32 v[132:133], v[180:181], v[136:137]
    v_pk_mul_f32 v[134:135], v[182:183], v[136:137]
    v_exp_f32_e64 v128, v128 clamp
    v_max_f32 v176, v20, v176
    v_exp_f32_e64 v129, v129 clamp
    v_max_f32 v177, v20, v177
    v_exp_f32_e64 v130, v130 clamp
    v_max_f32 v178, v20, v178
    v_exp_f32_e64 v131, v131 clamp
    v_max_f32 v179, v20, v179
    v_exp_f32_e64 v132, v132 clamp
    v_max_f32 v180, v20, v180
    v_exp_f32_e64 v133, v133 clamp
    v_max_f32 v181, v20, v181
    v_exp_f32_e64 v134, v134 clamp
    v_max_f32 v182, v20, v182
    v_exp_f32_e64 v135, v135 clamp
    v_max_f32 v183, v20, v183
    v_pk_fma_f32 v[176:177], v[176:177], v[138:139], v[128:129]
    v_pk_fma_f32 v[178:179], v[178:179], v[138:139], v[130:131]
    v_pk_fma_f32 v[180:181], v[180:181], v[138:139], v[132:133]
    v_pk_fma_f32 v[182:183], v[182:183], v[138:139], v[134:135]
    v_cvt_pk_bf16_f32 v168, v176, v177
    v_cvt_pk_bf16_f32 v169, v178, v179
    v_cvt_pk_bf16_f32 v170, v180, v181
    v_cvt_pk_bf16_f32 v171, v182, v183
    buffer_load_dwordx4 a[52:55], v16, s[44:47], s15 offen offset:0 sc1
    buffer_load_dwordx4 a[56:59], v15, s[44:47], s16 offen offset:0 sc1
    s_waitcnt lgkmcnt(0)
    s_barrier
    ds_read_b128 v[96:99], v26 offset:11264
    ds_read_b128 v[100:103], v26 offset:12288
    ds_read_b128 v[104:107], v26 offset:13312
    ds_read_b128 v[108:111], v26 offset:14336
    ds_read_b128 v[112:115], v26 offset:15360
    ds_read_b128 v[116:119], v26 offset:16384
    ds_read_b128 v[120:123], v26 offset:17408
    ds_read_b128 v[124:127], v26 offset:18432
    v_pk_mul_f32 v[128:129], v[184:185], v[136:137]
    v_pk_mul_f32 v[130:131], v[186:187], v[136:137]
    v_pk_mul_f32 v[132:133], v[188:189], v[136:137]
    v_pk_mul_f32 v[134:135], v[190:191], v[136:137]
    v_exp_f32_e64 v128, v128 clamp
    v_max_f32 v184, v20, v184
    v_exp_f32_e64 v129, v129 clamp
    v_max_f32 v185, v20, v185
    v_exp_f32_e64 v130, v130 clamp
    v_max_f32 v186, v20, v186
    v_exp_f32_e64 v131, v131 clamp
    v_max_f32 v187, v20, v187
    v_exp_f32_e64 v132, v132 clamp
    v_max_f32 v188, v20, v188
    v_exp_f32_e64 v133, v133 clamp
    v_max_f32 v189, v20, v189
    v_exp_f32_e64 v134, v134 clamp
    v_max_f32 v190, v20, v190
    v_exp_f32_e64 v135, v135 clamp
    v_max_f32 v191, v20, v191
    v_pk_fma_f32 v[184:185], v[184:185], v[138:139], v[128:129]
    v_pk_fma_f32 v[186:187], v[186:187], v[138:139], v[130:131]
    v_pk_fma_f32 v[188:189], v[188:189], v[138:139], v[132:133]
    v_pk_fma_f32 v[190:191], v[190:191], v[138:139], v[134:135]
    v_cvt_pk_bf16_f32 v172, v184, v185
    v_cvt_pk_bf16_f32 v173, v186, v187
    v_cvt_pk_bf16_f32 v174, v188, v189
    v_cvt_pk_bf16_f32 v175, v190, v191
    buffer_load_dwordx4 a[60:63], v15, s[44:47], s16 offen offset:1024 sc1
    buffer_load_dwordx4 a[64:67], v15, s[44:47], s16 offen offset:2048 sc1
    v_pk_mul_f32 v[128:129], v[192:193], v[136:137]
    v_pk_mul_f32 v[130:131], v[194:195], v[136:137]
    v_pk_mul_f32 v[132:133], v[196:197], v[136:137]
    v_pk_mul_f32 v[134:135], v[198:199], v[136:137]
    v_exp_f32_e64 v128, v128 clamp
    v_max_f32 v192, v20, v192
    v_exp_f32_e64 v129, v129 clamp
    v_max_f32 v193, v20, v193
    v_exp_f32_e64 v130, v130 clamp
    v_max_f32 v194, v20, v194
    v_exp_f32_e64 v131, v131 clamp
    v_max_f32 v195, v20, v195
    v_exp_f32_e64 v132, v132 clamp
    v_max_f32 v196, v20, v196
    v_exp_f32_e64 v133, v133 clamp
    v_max_f32 v197, v20, v197
    v_exp_f32_e64 v134, v134 clamp
    v_max_f32 v198, v20, v198
    v_exp_f32_e64 v135, v135 clamp
    v_max_f32 v199, v20, v199
    v_pk_fma_f32 v[192:193], v[192:193], v[138:139], v[128:129]
    v_pk_fma_f32 v[194:195], v[194:195], v[138:139], v[130:131]
    v_pk_fma_f32 v[196:197], v[196:197], v[138:139], v[132:133]
    v_pk_fma_f32 v[198:199], v[198:199], v[138:139], v[134:135]
    v_cvt_pk_bf16_f32 v176, v192, v193
    v_cvt_pk_bf16_f32 v177, v194, v195
    v_cvt_pk_bf16_f32 v178, v196, v197
    v_cvt_pk_bf16_f32 v179, v198, v199
    buffer_load_dwordx4 a[68:71], v15, s[44:47], s16 offen offset:3072 sc1
    buffer_load_dwordx4 a[72:75], v16, s[44:47], s16 offen offset:0 sc1
    s_waitcnt lgkmcnt(6)
    v_mfma_f32_32x32x16_bf16 v[128:143], v[96:99], v[160:163], 0
    v_mfma_f32_32x32x16_bf16 v[128:143], v[100:103], v[164:167], v[128:143]
    s_waitcnt lgkmcnt(4)
    v_mfma_f32_32x32x16_bf16 v[144:159], v[104:107], v[164:167], 0
    v_mfma_f32_32x32x16_bf16 v[144:159], v[108:111], v[168:171], v[144:159]
    v_mov_b32 v17, v220
    v_mov_b32 v18, v221
    v_mov_b32 v19, v222
    v_mov_b32 v20, v223
    v_mov_b32 v21, v224
    v_mov_b32 v24, v225
    v_mov_b32 v25, v226
    s_nop 2
    v_add_f32 v140, 0x358637bd, v140
    v_rcp_f32 v140, v140
    s_nop 0
    v_mul_f32 v128, v128, v140
    v_mul_f32 v129, v129, v140
    v_mul_f32 v130, v130, v140
    v_mul_f32 v131, v131, v140
    v_mul_f32 v132, v132, v140
    v_mul_f32 v133, v133, v140
    v_mul_f32 v134, v134, v140
    v_mul_f32 v135, v135, v140
    v_mul_f32 v136, v136, v140
    v_mul_f32 v137, v137, v140
    v_mul_f32 v138, v138, v140
    v_mul_f32 v139, v139, v140
    v_cvt_pk_bf16_f32 v128, v128, v129
    v_cvt_pk_bf16_f32 v129, v130, v131
    v_cvt_pk_bf16_f32 v130, v132, v133
    v_cvt_pk_bf16_f32 v131, v134, v135
    v_cvt_pk_bf16_f32 v96, v136, v137
    v_cvt_pk_bf16_f32 v97, v138, v139
    buffer_store_dwordx4 v[128:131], v1, s[44:47], s4 offen offset:0 sc1
    s_nop 1
    s_waitcnt lgkmcnt(2)
    v_mfma_f32_32x32x16_bf16 v[128:143], v[112:115], v[168:171], 0
    v_mfma_f32_32x32x16_bf16 v[128:143], v[116:119], v[172:175], v[128:143]
    v_add_f32 v156, 0x358637bd, v156
    v_rcp_f32 v156, v156
    s_nop 0
    v_mul_f32 v144, v144, v156
    v_mul_f32 v145, v145, v156
    v_mul_f32 v146, v146, v156
    v_mul_f32 v147, v147, v156
    v_mul_f32 v148, v148, v156
    v_mul_f32 v149, v149, v156
    v_mul_f32 v150, v150, v156
    v_mul_f32 v151, v151, v156
    v_mul_f32 v152, v152, v156
    v_mul_f32 v153, v153, v156
    v_mul_f32 v154, v154, v156
    v_mul_f32 v155, v155, v156
    v_cvt_pk_bf16_f32 v144, v144, v145
    v_cvt_pk_bf16_f32 v145, v146, v147
    v_cvt_pk_bf16_f32 v146, v148, v149
    v_cvt_pk_bf16_f32 v147, v150, v151
    v_cvt_pk_bf16_f32 v98, v152, v153
    v_cvt_pk_bf16_f32 v99, v154, v155
    buffer_store_dwordx4 v[144:147], v1, s[44:47], s4 offen offset:512 sc1
    s_add_u32 s4, s4, 5120
    s_nop 1
    s_waitcnt lgkmcnt(0)
    v_mfma_f32_32x32x16_bf16 v[144:159], v[120:123], v[172:175], 0
    v_mfma_f32_32x32x16_bf16 v[144:159], v[124:127], v[176:179], v[144:159]
    v_add_f32 v140, 0x358637bd, v140
    v_rcp_f32 v140, v140
    s_nop 0
    v_mul_f32 v128, v128, v140
    v_mul_f32 v129, v129, v140
    v_mul_f32 v130, v130, v140
    v_mul_f32 v131, v131, v140
    v_mul_f32 v132, v132, v140
    v_mul_f32 v133, v133, v140
    v_mul_f32 v134, v134, v140
    v_mul_f32 v135, v135, v140
    v_mul_f32 v136, v136, v140
    v_mul_f32 v137, v137, v140
    v_mul_f32 v138, v138, v140
    v_mul_f32 v139, v139, v140
    v_cvt_pk_bf16_f32 v128, v128, v129
    v_cvt_pk_bf16_f32 v129, v130, v131
    v_cvt_pk_bf16_f32 v130, v132, v133
    v_cvt_pk_bf16_f32 v131, v134, v135
    v_cvt_pk_bf16_f32 v100, v136, v137
    v_cvt_pk_bf16_f32 v101, v138, v139
    buffer_store_dwordx4 v[128:131], v1, s[44:47], s4 offen offset:0 sc1
    v_add_f32 v156, 0x358637bd, v156
    v_rcp_f32 v156, v156
    s_nop 0
    v_mul_f32 v144, v144, v156
    v_mul_f32 v145, v145, v156
    v_mul_f32 v146, v146, v156
    v_mul_f32 v147, v147, v156
    v_mul_f32 v148, v148, v156
    v_mul_f32 v149, v149, v156
    v_mul_f32 v150, v150, v156
    v_mul_f32 v151, v151, v156
    v_mul_f32 v152, v152, v156
    v_mul_f32 v153, v153, v156
    v_mul_f32 v154, v154, v156
    v_mul_f32 v155, v155, v156
    v_cvt_pk_bf16_f32 v144, v144, v145
    v_cvt_pk_bf16_f32 v145, v146, v147
    v_cvt_pk_bf16_f32 v146, v148, v149
    v_cvt_pk_bf16_f32 v147, v150, v151
    v_cvt_pk_bf16_f32 v102, v152, v153
    v_cvt_pk_bf16_f32 v103, v154, v155
    buffer_store_dwordx4 v[144:147], v1, s[44:47], s4 offen offset:512 sc1
    v_cndmask_b32 v96, v100, v96, vcc
    v_cndmask_b32 v97, v101, v97, vcc
    v_cndmask_b32 v98, v102, v98, vcc
    v_cndmask_b32 v99, v103, v99, vcc
    buffer_store_dwordx4 v[96:99], v1, s[44:47], s5 offen offset:0 sc1
    v_add_u32 v26, s60, v26
    s_add_u32 s7, s3, 0
    s_and_b32 s7, s7, 3
    s_mul_i32 s7, s7, 20608
    s_add_u32 s7, s7, 0
    v_add_u32 v9, s7, v25
    s_add_u32 s7, s3, 1
    s_and_b32 s7, s7, 3
    s_mul_i32 s7, s7, 20608
    s_add_u32 s7, s7, 5152
    v_add_u32 v10, s7, v25
    s_add_u32 s7, s3, 2
    s_and_b32 s7, s7, 3
    s_mul_i32 s7, s7, 20608
    s_add_u32 s7, s7, 10304
    v_add_u32 v12, s7, v25
    s_add_u32 s7, s3, 3
    s_and_b32 s7, s7, 3
    s_mul_i32 s7, s7, 20608
    s_add_u32 s7, s7, 15456
    v_add_u32 v13, s7, v25
    s_mul_i32 s7, s3, 20608
    v_add_u32 v20, s7, v20
    v_add_u32 v21, s7, v21
    v_add_u32 v24, s7, v24
    s_waitcnt vmcnt(23)
    v_mfma_f32_16x16x32_bf16 a[160:163], v[228:231], v[48:51], 0
    buffer_load_dwordx4 a[76:79], v15, s[44:47], s17 offen offset:0 sc1
    v_mfma_f32_16x16x32_bf16 a[200:203], v[228:231], v[52:55], 0
    buffer_load_dwordx4 a[80:83], v15, s[44:47], s17 offen offset:1024 sc1
    v_mfma_f32_16x16x32_bf16 a[120:123], v[228:231], v[56:59], 0
    buffer_load_dwordx4 a[84:87], v15, s[44:47], s17 offen offset:2048 sc1
    v_mfma_f32_16x16x32_bf16 a[140:143], v[228:231], v[60:63], 0
    buffer_load_dwordx4 a[88:91], v15, s[44:47], s17 offen offset:3072 sc1
    v_mfma_f32_16x16x32_bf16 a[164:167], v[232:235], v[48:51], 0
    buffer_load_dwordx4 a[92:95], v16, s[44:47], s17 offen offset:0 sc1
    v_mfma_f32_16x16x32_bf16 a[224:227], v[232:235], v[52:55], 0
    v_mfma_f32_16x16x32_bf16 a[124:127], v[232:235], v[56:59], 0
    v_mfma_f32_16x16x32_bf16 a[144:147], v[232:235], v[60:63], 0
    v_mfma_f32_16x16x32_bf16 a[168:171], v[236:239], v[48:51], 0
    v_mfma_f32_16x16x32_bf16 a[228:231], v[236:239], v[52:55], 0
    v_mfma_f32_16x16x32_bf16 a[128:131], v[236:239], v[56:59], 0
    v_mfma_f32_16x16x32_bf16 a[148:151], v[236:239], v[60:63], 0
    v_mfma_f32_16x16x32_bf16 a[192:195], v[240:243], v[48:51], 0
    v_mfma_f32_16x16x32_bf16 a[232:235], v[240:243], v[52:55], 0
    v_mfma_f32_16x16x32_bf16 a[132:135], v[240:243], v[56:59], 0
    v_mfma_f32_16x16x32_bf16 a[152:155], v[240:243], v[60:63], 0
    v_mfma_f32_16x16x32_bf16 a[196:199], v[244:247], v[48:51], 0
    v_mfma_f32_16x16x32_bf16 a[116:119], v[244:247], v[52:55], 0
    v_mfma_f32_16x16x32_bf16 a[136:139], v[244:247], v[56:59], 0
    v_mfma_f32_16x16x32_bf16 a[156:159], v[244:247], v[60:63], 0
    s_waitcnt vmcnt(24)
    v_mfma_f32_16x16x32_bf16 a[160:163], v[248:251], v[64:67], a[160:163]
    buffer_load_dwordx4 v[48:51], v2, s[44:47], s11 offen sc1
    v_mfma_f32_16x16x32_bf16 a[200:203], v[248:251], v[68:71], a[200:203]
    buffer_load_dwordx4 v[52:55], v3, s[44:47], s11 offen sc1
    v_mfma_f32_16x16x32_bf16 a[120:123], v[248:251], v[72:75], a[120:123]
    buffer_load_dwordx4 v[56:59], v4, s[44:47], s11 offen sc1
    v_mfma_f32_16x16x32_bf16 a[140:143], v[248:251], v[76:79], a[140:143]
    buffer_load_dwordx4 v[60:63], v5, s[44:47], s11 offen sc1
    v_mfma_f32_16x16x32_bf16 a[164:167], v[252:255], v[64:67], a[164:167]
    buffer_load_dwordx4 a[96:99], v15, s[44:47], s18 offen offset:0 sc1
    v_mfma_f32_16x16x32_bf16 a[224:227], v[252:255], v[68:71], a[224:227]
    buffer_load_dwordx4 a[100:103], v15, s[44:47], s18 offen offset:1024 sc1
    v_mfma_f32_16x16x32_bf16 a[124:127], v[252:255], v[72:75], a[124:127]
    buffer_load_dwordx4 a[104:107], v15, s[44:47], s18 offen offset:2048 sc1
    v_mfma_f32_16x16x32_bf16 a[144:147], v[252:255], v[76:79], a[144:147]
    buffer_load_dwordx4 a[108:111], v15, s[44:47], s18 offen offset:3072 sc1
    v_mfma_f32_16x16x32_bf16 a[168:171], a[172:175], v[64:67], a[168:171]
    buffer_load_dwordx4 a[112:115], v16, s[44:47], s18 offen offset:0 sc1
    v_mfma_f32_16x16x32_bf16 a[228:231], a[172:175], v[68:71], a[228:231]
    v_mfma_f32_16x16x32_bf16 a[128:131], a[172:175], v[72:75], a[128:131]
    v_mfma_f32_16x16x32_bf16 a[148:151], a[172:175], v[76:79], a[148:151]
    v_mfma_f32_16x16x32_bf16 a[192:195], a[176:179], v[64:67], a[192:195]
    v_mfma_f32_16x16x32_bf16 a[232:235], a[176:179], v[68:71], a[232:235]
    v_mfma_f32_16x16x32_bf16 a[132:135], a[176:179], v[72:75], a[132:135]
    v_mfma_f32_16x16x32_bf16 a[152:155], a[176:179], v[76:79], a[152:155]
    v_mfma_f32_16x16x32_bf16 a[196:199], a[180:183], v[64:67], a[196:199]
    v_mfma_f32_16x16x32_bf16 a[116:119], a[180:183], v[68:71], a[116:119]
    v_mfma_f32_16x16x32_bf16 a[136:139], a[180:183], v[72:75], a[136:139]
    v_mfma_f32_16x16x32_bf16 a[156:159], a[180:183], v[76:79], a[156:159]
    s_waitcnt vmcnt(14)
    s_barrier
    s_cmp_eq_u32 s3, 0
    s_cselect_b32 s7, s90, 2146435072
    v_lshlrev_b32 v31, 8, v0
    s_mov_b64 exec, 0xffff
    buffer_atomic_add v11, v31, s[44:47], s7 offen offset:12 sc1
    s_mov_b64 exec, -1
    v_mfma_f32_16x16x32_bf16 a[160:163], a[184:187], v[80:83], a[160:163]
    buffer_load_dwordx4 v[64:67], v2, s[44:47], s12 offen sc1
    v_mfma_f32_16x16x32_bf16 a[200:203], a[184:187], v[84:87], a[200:203]
    buffer_load_dwordx4 v[68:71], v3, s[44:47], s12 offen sc1
    v_mfma_f32_16x16x32_bf16 a[120:123], a[184:187], v[88:91], a[120:123]
    buffer_load_dwordx4 v[72:75], v4, s[44:47], s12 offen sc1
    v_mfma_f32_16x16x32_bf16 a[140:143], a[184:187], v[92:95], a[140:143]
    buffer_load_dwordx4 v[76:79], v5, s[44:47], s12 offen sc1
    v_mfma_f32_16x16x32_bf16 a[164:167], a[188:191], v[80:83], a[164:167]
    buffer_load_dwordx4 v[160:163], v17, s[28:31], s94 offen
    v_mfma_f32_16x16x32_bf16 a[224:227], a[188:191], v[84:87], a[224:227]
    buffer_load_dwordx4 v[164:167], v18, s[28:31], s94 offen
    v_mfma_f32_16x16x32_bf16 a[124:127], a[188:191], v[88:91], a[124:127]
    buffer_load_dwordx4 v[168:171], v19, s[28:31], s94 offen
    v_mfma_f32_16x16x32_bf16 a[144:147], a[188:191], v[92:95], a[144:147]
    buffer_load_dwordx4 v[208:211], v15, s[44:47], s19 offen offset:0 sc1
    v_mfma_f32_16x16x32_bf16 a[168:171], a[204:207], v[80:83], a[168:171]
    buffer_load_dwordx4 v[212:215], v15, s[44:47], s19 offen offset:1024 sc1
    v_mfma_f32_16x16x32_bf16 a[228:231], a[204:207], v[84:87], a[228:231]
    buffer_load_dwordx4 v[216:219], v15, s[44:47], s19 offen offset:2048 sc1
    v_mfma_f32_16x16x32_bf16 a[128:131], a[204:207], v[88:91], a[128:131]
    buffer_load_dwordx4 v[220:223], v15, s[44:47], s19 offen offset:3072 sc1
    v_mfma_f32_16x16x32_bf16 a[148:151], a[204:207], v[92:95], a[148:151]
    buffer_load_dwordx4 v[224:227], v16, s[44:47], s19 offen offset:0 sc1
    v_mfma_f32_16x16x32_bf16 a[192:195], a[208:211], v[80:83], a[192:195]
    v_mfma_f32_16x16x32_bf16 a[232:235], a[208:211], v[84:87], a[232:235]
    v_mfma_f32_16x16x32_bf16 a[132:135], a[208:211], v[88:91], a[132:135]
    v_mfma_f32_16x16x32_bf16 a[152:155], a[208:211], v[92:95], a[152:155]
    v_mfma_f32_16x16x32_bf16 a[196:199], a[212:215], v[80:83], a[196:199]
    v_mfma_f32_16x16x32_bf16 a[116:119], a[212:215], v[84:87], a[116:119]
    v_mfma_f32_16x16x32_bf16 a[136:139], a[212:215], v[88:91], a[136:139]
    v_mfma_f32_16x16x32_bf16 a[156:159], a[212:215], v[92:95], a[156:159]
    s_waitcnt vmcnt(18)
    v_mfma_f32_16x16x32_bf16 a[160:163], a[216:219], v[48:51], a[160:163]
    buffer_load_dwordx4 v[80:83], v2, s[44:47], s13 offen sc1
    v_mfma_f32_16x16x32_bf16 a[200:203], a[216:219], v[52:55], a[200:203]
    buffer_load_dwordx4 v[84:87], v3, s[44:47], s13 offen sc1
    v_mfma_f32_16x16x32_bf16 a[120:123], a[216:219], v[56:59], a[120:123]
    buffer_load_dwordx4 v[88:91], v4, s[44:47], s13 offen sc1
    v_mfma_f32_16x16x32_bf16 a[140:143], a[216:219], v[60:63], a[140:143]
    buffer_load_dwordx4 v[92:95], v5, s[44:47], s13 offen sc1
    v_mfma_f32_16x16x32_bf16 a[164:167], a[220:223], v[48:51], a[164:167]
    buffer_load_dwordx4 v[96:99], v15, s[44:47], s20 offen offset:0 sc1
    v_mfma_f32_16x16x32_bf16 a[224:227], a[220:223], v[52:55], a[224:227]
    buffer_load_dwordx4 v[100:103], v15, s[44:47], s20 offen offset:1024 sc1
    v_mfma_f32_16x16x32_bf16 a[124:127], a[220:223], v[56:59], a[124:127]
    buffer_load_dwordx4 v[104:107], v15, s[44:47], s20 offen offset:2048 sc1
    v_mfma_f32_16x16x32_bf16 a[144:147], a[220:223], v[60:63], a[144:147]
    buffer_load_dwordx4 v[108:111], v15, s[44:47], s20 offen offset:3072 sc1
    v_mfma_f32_16x16x32_bf16 a[168:171], a[236:239], v[48:51], a[168:171]
    buffer_load_dwordx4 v[112:115], v16, s[44:47], s20 offen offset:0 sc1
    v_mfma_f32_16x16x32_bf16 a[228:231], a[236:239], v[52:55], a[228:231]
    v_mfma_f32_16x16x32_bf16 a[128:131], a[236:239], v[56:59], a[128:131]
    v_mfma_f32_16x16x32_bf16 a[148:151], a[236:239], v[60:63], a[148:151]
    v_mfma_f32_16x16x32_bf16 a[192:195], a[240:243], v[48:51], a[192:195]
    v_mfma_f32_16x16x32_bf16 a[232:235], a[240:243], v[52:55], a[232:235]
    v_mfma_f32_16x16x32_bf16 a[132:135], a[240:243], v[56:59], a[132:135]
    v_mfma_f32_16x16x32_bf16 a[152:155], a[240:243], v[60:63], a[152:155]
    v_mfma_f32_16x16x32_bf16 a[196:199], a[244:247], v[48:51], a[196:199]
    v_mfma_f32_16x16x32_bf16 a[116:119], a[244:247], v[52:55], a[116:119]
    v_mfma_f32_16x16x32_bf16 a[136:139], a[244:247], v[56:59], a[136:139]
    v_mfma_f32_16x16x32_bf16 a[156:159], a[244:247], v[60:63], a[156:159]
    s_waitcnt vmcnt(17)
    v_mfma_f32_16x16x32_bf16 a[160:163], a[248:251], v[64:67], a[160:163]
    buffer_load_dword v22, off, s[44:47], s89 offset:8 sc1
    v_mfma_f32_16x16x32_bf16 a[200:203], a[248:251], v[68:71], a[200:203]
    buffer_load_dwordx4 v[48:51], v2, s[44:47], s14 offen sc1
    v_mfma_f32_16x16x32_bf16 a[120:123], a[248:251], v[72:75], a[120:123]
    buffer_load_dwordx4 v[52:55], v3, s[44:47], s14 offen sc1
    v_mfma_f32_16x16x32_bf16 a[140:143], a[248:251], v[76:79], a[140:143]
    buffer_load_dwordx4 v[56:59], v4, s[44:47], s14 offen sc1
    v_mfma_f32_16x16x32_bf16 a[164:167], a[252:255], v[64:67], a[164:167]
    buffer_load_dwordx4 v[60:63], v5, s[44:47], s14 offen sc1
    v_mfma_f32_16x16x32_bf16 a[224:227], a[252:255], v[68:71], a[224:227]
    buffer_load_dwordx4 v[116:119], v15, s[44:47], s21 offen offset:0 sc1
    v_mfma_f32_16x16x32_bf16 a[124:127], a[252:255], v[72:75], a[124:127]
    buffer_load_dwordx4 v[120:123], v15, s[44:47], s21 offen offset:1024 sc1
    v_mfma_f32_16x16x32_bf16 a[144:147], a[252:255], v[76:79], a[144:147]
    buffer_load_dwordx4 v[124:127], v15, s[44:47], s21 offen offset:2048 sc1
    v_mfma_f32_16x16x32_bf16 a[168:171], a[0:3], v[64:67], a[168:171]
    buffer_load_dwordx4 v[128:131], v15, s[44:47], s21 offen offset:3072 sc1
    v_mfma_f32_16x16x32_bf16 a[228:231], a[0:3], v[68:71], a[228:231]
    buffer_load_dwordx4 v[132:135], v16, s[44:47], s21 offen offset:0 sc1
    v_mfma_f32_16x16x32_bf16 a[128:131], a[0:3], v[72:75], a[128:131]
    v_mfma_f32_16x16x32_bf16 a[148:151], a[0:3], v[76:79], a[148:151]
    v_mfma_f32_16x16x32_bf16 a[192:195], a[4:7], v[64:67], a[192:195]
    v_mfma_f32_16x16x32_bf16 a[232:235], a[4:7], v[68:71], a[232:235]
    v_mfma_f32_16x16x32_bf16 a[132:135], a[4:7], v[72:75], a[132:135]
    v_mfma_f32_16x16x32_bf16 a[152:155], a[4:7], v[76:79], a[152:155]
    v_mfma_f32_16x16x32_bf16 a[196:199], a[8:11], v[64:67], a[196:199]
    v_mfma_f32_16x16x32_bf16 a[116:119], a[8:11], v[68:71], a[116:119]
    v_mfma_f32_16x16x32_bf16 a[136:139], a[8:11], v[72:75], a[136:139]
    v_mfma_f32_16x16x32_bf16 a[156:159], a[8:11], v[76:79], a[156:159]
    s_waitcnt vmcnt(15)
    v_mfma_f32_16x16x32_bf16 a[160:163], a[12:15], v[80:83], a[160:163]
    buffer_load_dwordx4 v[64:67], v2, s[44:47], s15 offen sc1
    v_mfma_f32_16x16x32_bf16 a[200:203], a[12:15], v[84:87], a[200:203]
    buffer_load_dwordx4 v[68:71], v3, s[44:47], s15 offen sc1
    v_mfma_f32_16x16x32_bf16 a[120:123], a[12:15], v[88:91], a[120:123]
    buffer_load_dwordx4 v[72:75], v4, s[44:47], s15 offen sc1
    v_mfma_f32_16x16x32_bf16 a[140:143], a[12:15], v[92:95], a[140:143]
    buffer_load_dwordx4 v[76:79], v5, s[44:47], s15 offen sc1
    v_mfma_f32_16x16x32_bf16 a[164:167], a[16:19], v[80:83], a[164:167]
    buffer_load_dwordx4 v[136:139], v15, s[44:47], s22 offen offset:0 sc1
    v_mfma_f32_16x16x32_bf16 a[224:227], a[16:19], v[84:87], a[224:227]
    buffer_load_dwordx4 v[140:143], v15, s[44:47], s22 offen offset:1024 sc1
    v_mfma_f32_16x16x32_bf16 a[124:127], a[16:19], v[88:91], a[124:127]
    buffer_load_dwordx4 v[144:147], v15, s[44:47], s22 offen offset:2048 sc1
    v_mfma_f32_16x16x32_bf16 a[144:147], a[16:19], v[92:95], a[144:147]
    buffer_load_dwordx4 v[148:151], v15, s[44:47], s22 offen offset:3072 sc1
    v_mfma_f32_16x16x32_bf16 a[168:171], a[20:23], v[80:83], a[168:171]
    buffer_load_dwordx4 v[152:155], v16, s[44:47], s22 offen offset:0 sc1
    v_mfma_f32_16x16x32_bf16 a[228:231], a[20:23], v[84:87], a[228:231]
    v_mfma_f32_16x16x32_bf16 a[128:131], a[20:23], v[88:91], a[128:131]
    v_mfma_f32_16x16x32_bf16 a[148:151], a[20:23], v[92:95], a[148:151]
    v_mfma_f32_16x16x32_bf16 a[192:195], a[24:27], v[80:83], a[192:195]
    v_mfma_f32_16x16x32_bf16 a[232:235], a[24:27], v[84:87], a[232:235]
    v_mfma_f32_16x16x32_bf16 a[132:135], a[24:27], v[88:91], a[132:135]
    v_mfma_f32_16x16x32_bf16 a[152:155], a[24:27], v[92:95], a[152:155]
    v_mfma_f32_16x16x32_bf16 a[196:199], a[28:31], v[80:83], a[196:199]
    v_mfma_f32_16x16x32_bf16 a[116:119], a[28:31], v[84:87], a[116:119]
    v_mfma_f32_16x16x32_bf16 a[136:139], a[28:31], v[88:91], a[136:139]
    v_mfma_f32_16x16x32_bf16 a[156:159], a[28:31], v[92:95], a[156:159]
    s_waitcnt vmcnt(18)
    v_readfirstlane_b32 s98, v22
    s_cmp_ge_u32 s98, 1048576
    s_cbranch_scc0 SPIN26
RET26:
    s_waitcnt vmcnt(14)
    v_mfma_f32_16x16x32_bf16 a[160:163], a[32:35], v[48:51], a[160:163]
    buffer_load_dwordx4 a[248:251], v2, s[44:47], s16 offen sc1
    v_mfma_f32_16x16x32_bf16 a[200:203], a[32:35], v[52:55], a[200:203]
    buffer_load_dwordx4 a[252:255], v3, s[44:47], s16 offen sc1
    v_mfma_f32_16x16x32_bf16 a[120:123], a[32:35], v[56:59], a[120:123]
    buffer_load_dwordx4 a[0:3], v4, s[44:47], s16 offen sc1
    v_mfma_f32_16x16x32_bf16 a[140:143], a[32:35], v[60:63], a[140:143]
    buffer_load_dwordx4 a[4:7], v5, s[44:47], s16 offen sc1
    v_mfma_f32_16x16x32_bf16 a[164:167], a[36:39], v[48:51], a[164:167]
    buffer_load_dwordx4 a[8:11], v2, s[44:47], s17 offen sc1
    v_mfma_f32_16x16x32_bf16 a[224:227], a[36:39], v[52:55], a[224:227]
    buffer_load_dwordx4 a[12:15], v3, s[44:47], s17 offen sc1
    v_mfma_f32_16x16x32_bf16 a[124:127], a[36:39], v[56:59], a[124:127]
    buffer_load_dwordx4 a[16:19], v4, s[44:47], s17 offen sc1
    v_mfma_f32_16x16x32_bf16 a[144:147], a[36:39], v[60:63], a[144:147]
    buffer_load_dwordx4 a[20:23], v5, s[44:47], s17 offen sc1
    v_mfma_f32_16x16x32_bf16 a[168:171], a[40:43], v[48:51], a[168:171]
    buffer_load_dwordx4 v[156:159], v15, s[44:47], s23 offen offset:0 sc1
    v_mfma_f32_16x16x32_bf16 a[228:231], a[40:43], v[52:55], a[228:231]
    buffer_load_dwordx4 v[172:175], v15, s[44:47], s23 offen offset:1024 sc1
    v_mfma_f32_16x16x32_bf16 a[128:131], a[40:43], v[56:59], a[128:131]
    buffer_load_dwordx4 v[176:179], v15, s[44:47], s23 offen offset:2048 sc1
    v_mfma_f32_16x16x32_bf16 a[148:151], a[40:43], v[60:63], a[148:151]
    buffer_load_dwordx4 v[180:183], v15, s[44:47], s23 offen offset:3072 sc1
    v_mfma_f32_16x16x32_bf16 a[192:195], a[44:47], v[48:51], a[192:195]
    buffer_load_dwordx4 v[184:187], v16, s[44:47], s23 offen offset:0 sc1
    v_mfma_f32_16x16x32_bf16 a[232:235], a[44:47], v[52:55], a[232:235]
    v_mfma_f32_16x16x32_bf16 a[132:135], a[44:47], v[56:59], a[132:135]
    v_mfma_f32_16x16x32_bf16 a[152:155], a[44:47], v[60:63], a[152:155]
    v_mfma_f32_16x16x32_bf16 a[196:199], v[32:35], v[48:51], a[196:199]
    v_mfma_f32_16x16x32_bf16 a[116:119], v[32:35], v[52:55], a[116:119]
    v_mfma_f32_16x16x32_bf16 a[136:139], v[32:35], v[56:59], a[136:139]
    v_mfma_f32_16x16x32_bf16 a[156:159], v[32:35], v[60:63], a[156:159]
    s_waitcnt vmcnt(18)
    v_mfma_f32_16x16x32_bf16 a[160:163], v[36:39], v[64:67], a[160:163]
    buffer_load_dword v22, off, s[44:47], s89 offset:12 sc1
    v_mfma_f32_16x16x32_bf16 a[200:203], v[36:39], v[68:71], a[200:203]
    buffer_load_dwordx4 a[24:27], v2, s[44:47], s18 offen sc1
    v_mfma_f32_16x16x32_bf16 a[120:123], v[36:39], v[72:75], a[120:123]
    buffer_load_dwordx4 a[28:31], v3, s[44:47], s18 offen sc1
    v_mfma_f32_16x16x32_bf16 a[140:143], v[36:39], v[76:79], a[140:143]
    buffer_load_dwordx4 a[32:35], v4, s[44:47], s18 offen sc1
    v_mfma_f32_16x16x32_bf16 a[164:167], v[40:43], v[64:67], a[164:167]
    buffer_load_dwordx4 a[36:39], v5, s[44:47], s18 offen sc1
    v_mfma_f32_16x16x32_bf16 a[224:227], v[40:43], v[68:71], a[224:227]
    buffer_load_dwordx4 v[188:191], v15, s[44:47], s84 offen offset:0 sc1
    v_mfma_f32_16x16x32_bf16 a[124:127], v[40:43], v[72:75], a[124:127]
    buffer_load_dwordx4 v[192:195], v15, s[44:47], s84 offen offset:1024 sc1
    v_mfma_f32_16x16x32_bf16 a[144:147], v[40:43], v[76:79], a[144:147]
    buffer_load_dwordx4 v[196:199], v15, s[44:47], s84 offen offset:2048 sc1
    v_mfma_f32_16x16x32_bf16 a[168:171], v[44:47], v[64:67], a[168:171]
    buffer_load_dwordx4 v[200:203], v15, s[44:47], s84 offen offset:3072 sc1
    v_mfma_f32_16x16x32_bf16 a[228:231], v[44:47], v[68:71], a[228:231]
    buffer_load_dwordx4 v[204:207], v16, s[44:47], s84 offen offset:0 sc1
    v_mfma_f32_16x16x32_bf16 a[128:131], v[44:47], v[72:75], a[128:131]
    v_mfma_f32_16x16x32_bf16 a[148:151], v[44:47], v[76:79], a[148:151]
    v_mfma_f32_16x16x32_bf16 a[192:195], a[48:51], v[64:67], a[192:195]
    v_mfma_f32_16x16x32_bf16 a[232:235], a[48:51], v[68:71], a[232:235]
    v_mfma_f32_16x16x32_bf16 a[132:135], a[48:51], v[72:75], a[132:135]
    v_mfma_f32_16x16x32_bf16 a[152:155], a[48:51], v[76:79], a[152:155]
    v_mfma_f32_16x16x32_bf16 a[196:199], a[52:55], v[64:67], a[196:199]
    v_mfma_f32_16x16x32_bf16 a[116:119], a[52:55], v[68:71], a[116:119]
    v_mfma_f32_16x16x32_bf16 a[136:139], a[52:55], v[72:75], a[136:139]
    v_mfma_f32_16x16x32_bf16 a[156:159], a[52:55], v[76:79], a[156:159]
    s_waitcnt vmcnt(19)
    v_mfma_f32_16x16x32_bf16 a[160:163], a[56:59], a[248:251], a[160:163]
    buffer_load_dwordx4 a[40:43], v2, s[44:47], s19 offen sc1
    v_mfma_f32_16x16x32_bf16 a[200:203], a[56:59], a[252:255], a[200:203]
    buffer_load_dwordx4 a[44:47], v3, s[44:47], s19 offen sc1
    v_mfma_f32_16x16x32_bf16 a[120:123], a[56:59], a[0:3], a[120:123]
    buffer_load_dwordx4 v[32:35], v4, s[44:47], s19 offen sc1
    v_mfma_f32_16x16x32_bf16 a[140:143], a[56:59], a[4:7], a[140:143]
    buffer_load_dwordx4 v[36:39], v5, s[44:47], s19 offen sc1
    v_mfma_f32_16x16x32_bf16 a[164:167], a[60:63], a[248:251], a[164:167]
    v_mfma_f32_16x16x32_bf16 a[224:227], a[60:63], a[252:255], a[224:227]
    v_mfma_f32_16x16x32_bf16 a[124:127], a[60:63], a[0:3], a[124:127]
    v_mfma_f32_16x16x32_bf16 a[144:147], a[60:63], a[4:7], a[144:147]
    v_mfma_f32_16x16x32_bf16 a[168:171], a[64:67], a[248:251], a[168:171]
    v_mfma_f32_16x16x32_bf16 a[228:231], a[64:67], a[252:255], a[228:231]
    v_mfma_f32_16x16x32_bf16 a[128:131], a[64:67], a[0:3], a[128:131]
    v_mfma_f32_16x16x32_bf16 a[148:151], a[64:67], a[4:7], a[148:151]
    v_mfma_f32_16x16x32_bf16 a[192:195], a[68:71], a[248:251], a[192:195]
    v_mfma_f32_16x16x32_bf16 a[232:235], a[68:71], a[252:255], a[232:235]
    v_mfma_f32_16x16x32_bf16 a[132:135], a[68:71], a[0:3], a[132:135]
    v_mfma_f32_16x16x32_bf16 a[152:155], a[68:71], a[4:7], a[152:155]
    v_mfma_f32_16x16x32_bf16 a[196:199], a[72:75], a[248:251], a[196:199]
    v_mfma_f32_16x16x32_bf16 a[116:119], a[72:75], a[252:255], a[116:119]
    v_mfma_f32_16x16x32_bf16 a[136:139], a[72:75], a[0:3], a[136:139]
    v_mfma_f32_16x16x32_bf16 a[156:159], a[72:75], a[4:7], a[156:159]
    s_waitcnt vmcnt(13)
    v_readfirstlane_b32 s98, v22
    s_cmp_ge_u32 s98, 1048576
    s_cbranch_scc0 SPIN27
RET27:
    v_mfma_f32_16x16x32_bf16 a[160:163], a[76:79], a[8:11], a[160:163]
    buffer_load_dwordx4 v[40:43], v2, s[44:47], s20 offen sc1
    v_mfma_f32_16x16x32_bf16 a[200:203], a[76:79], a[12:15], a[200:203]
    buffer_load_dwordx4 v[44:47], v3, s[44:47], s20 offen sc1
    v_mfma_f32_16x16x32_bf16 a[120:123], a[76:79], a[16:19], a[120:123]
    buffer_load_dwordx4 a[48:51], v4, s[44:47], s20 offen sc1
    v_mfma_f32_16x16x32_bf16 a[140:143], a[76:79], a[20:23], a[140:143]
    buffer_load_dwordx4 a[52:55], v5, s[44:47], s20 offen sc1
    v_mfma_f32_16x16x32_bf16 a[164:167], a[80:83], a[8:11], a[164:167]
    buffer_load_dwordx4 a[56:59], v2, s[44:47], s21 offen sc1
    v_mfma_f32_16x16x32_bf16 a[224:227], a[80:83], a[12:15], a[224:227]
    buffer_load_dwordx4 a[60:63], v3, s[44:47], s21 offen sc1
    v_mfma_f32_16x16x32_bf16 a[124:127], a[80:83], a[16:19], a[124:127]
    buffer_load_dwordx4 a[64:67], v4, s[44:47], s21 offen sc1
    v_mfma_f32_16x16x32_bf16 a[144:147], a[80:83], a[20:23], a[144:147]
    buffer_load_dwordx4 a[68:71], v5, s[44:47], s21 offen sc1
    v_mfma_f32_16x16x32_bf16 a[168:171], a[84:87], a[8:11], a[168:171]
    v_mfma_f32_16x16x32_bf16 a[228:231], a[84:87], a[12:15], a[228:231]
    v_mfma_f32_16x16x32_bf16 a[128:131], a[84:87], a[16:19], a[128:131]
    v_mfma_f32_16x16x32_bf16 a[148:151], a[84:87], a[20:23], a[148:151]
    v_mfma_f32_16x16x32_bf16 a[192:195], a[88:91], a[8:11], a[192:195]
    v_mfma_f32_16x16x32_bf16 a[232:235], a[88:91], a[12:15], a[232:235]
    v_mfma_f32_16x16x32_bf16 a[132:135], a[88:91], a[16:19], a[132:135]
    v_mfma_f32_16x16x32_bf16 a[152:155], a[88:91], a[20:23], a[152:155]
    v_mfma_f32_16x16x32_bf16 a[196:199], a[92:95], a[8:11], a[196:199]
    v_mfma_f32_16x16x32_bf16 a[116:119], a[92:95], a[12:15], a[116:119]
    v_mfma_f32_16x16x32_bf16 a[136:139], a[92:95], a[16:19], a[136:139]
    v_mfma_f32_16x16x32_bf16 a[156:159], a[92:95], a[20:23], a[156:159]
    s_waitcnt vmcnt(17)
    v_mfma_f32_16x16x32_bf16 a[160:163], a[96:99], a[24:27], a[160:163]
    buffer_load_dwordx4 a[72:75], v2, s[44:47], s22 offen sc1
    v_mfma_f32_16x16x32_bf16 a[200:203], a[96:99], a[28:31], a[200:203]
    buffer_load_dwordx4 a[76:79], v3, s[44:47], s22 offen sc1
    v_mfma_f32_16x16x32_bf16 a[120:123], a[96:99], a[32:35], a[120:123]
    buffer_load_dwordx4 a[80:83], v4, s[44:47], s22 offen sc1
    v_mfma_f32_16x16x32_bf16 a[140:143], a[96:99], a[36:39], a[140:143]
    buffer_load_dwordx4 a[84:87], v5, s[44:47], s22 offen sc1
    v_mfma_f32_16x16x32_bf16 a[164:167], a[100:103], a[24:27], a[164:167]
    v_mfma_f32_16x16x32_bf16 a[224:227], a[100:103], a[28:31], a[224:227]
    v_mfma_f32_16x16x32_bf16 a[124:127], a[100:103], a[32:35], a[124:127]
    v_mfma_f32_16x16x32_bf16 a[144:147], a[100:103], a[36:39], a[144:147]
    v_mfma_f32_16x16x32_bf16 a[168:171], a[104:107], a[24:27], a[168:171]
    v_mfma_f32_16x16x32_bf16 a[228:231], a[104:107], a[28:31], a[228:231]
    v_mfma_f32_16x16x32_bf16 a[128:131], a[104:107], a[32:35], a[128:131]
    v_mfma_f32_16x16x32_bf16 a[148:151], a[104:107], a[36:39], a[148:151]
    v_mfma_f32_16x16x32_bf16 a[192:195], a[108:111], a[24:27], a[192:195]
    v_mfma_f32_16x16x32_bf16 a[232:235], a[108:111], a[28:31], a[232:235]
    v_mfma_f32_16x16x32_bf16 a[132:135], a[108:111], a[32:35], a[132:135]
    v_mfma_f32_16x16x32_bf16 a[152:155], a[108:111], a[36:39], a[152:155]
    v_mfma_f32_16x16x32_bf16 a[196:199], a[112:115], a[24:27], a[196:199]
    v_mfma_f32_16x16x32_bf16 a[116:119], a[112:115], a[28:31], a[116:119]
    v_mfma_f32_16x16x32_bf16 a[136:139], a[112:115], a[32:35], a[136:139]
    v_mfma_f32_16x16x32_bf16 a[156:159], a[112:115], a[36:39], a[156:159]
    s_waitcnt vmcnt(12)
    v_mfma_f32_16x16x32_bf16 a[160:163], v[208:211], a[40:43], a[160:163]
    buffer_load_dwordx4 a[88:91], v2, s[44:47], s23 offen sc1
    v_mfma_f32_16x16x32_bf16 a[200:203], v[208:211], a[44:47], a[200:203]
    buffer_load_dwordx4 a[92:95], v3, s[44:47], s23 offen sc1
    v_mfma_f32_16x16x32_bf16 a[120:123], v[208:211], v[32:35], a[120:123]
    buffer_load_dwordx4 a[96:99], v4, s[44:47], s23 offen sc1
    v_mfma_f32_16x16x32_bf16 a[140:143], v[208:211], v[36:39], a[140:143]
    buffer_load_dwordx4 a[100:103], v5, s[44:47], s23 offen sc1
    v_mfma_f32_16x16x32_bf16 a[164:167], v[212:215], a[40:43], a[164:167]
    v_mfma_f32_16x16x32_bf16 a[224:227], v[212:215], a[44:47], a[224:227]
    v_mfma_f32_16x16x32_bf16 a[124:127], v[212:215], v[32:35], a[124:127]
    v_mfma_f32_16x16x32_bf16 a[144:147], v[212:215], v[36:39], a[144:147]
    v_mfma_f32_16x16x32_bf16 a[168:171], v[216:219], a[40:43], a[168:171]
    v_mfma_f32_16x16x32_bf16 a[228:231], v[216:219], a[44:47], a[228:231]
    v_mfma_f32_16x16x32_bf16 a[128:131], v[216:219], v[32:35], a[128:131]
    v_mfma_f32_16x16x32_bf16 a[148:151], v[216:219], v[36:39], a[148:151]
    v_mfma_f32_16x16x32_bf16 a[192:195], v[220:223], a[40:43], a[192:195]
    v_mfma_f32_16x16x32_bf16 a[232:235], v[220:223], a[44:47], a[232:235]
    v_mfma_f32_16x16x32_bf16 a[132:135], v[220:223], v[32:35], a[132:135]
    v_mfma_f32_16x16x32_bf16 a[152:155], v[220:223], v[36:39], a[152:155]
    v_mfma_f32_16x16x32_bf16 a[196:199], v[224:227], a[40:43], a[196:199]
    v_mfma_f32_16x16x32_bf16 a[116:119], v[224:227], a[44:47], a[116:119]
    v_mfma_f32_16x16x32_bf16 a[136:139], v[224:227], v[32:35], a[136:139]
    v_mfma_f32_16x16x32_bf16 a[156:159], v[224:227], v[36:39], a[156:159]
    s_mov_b32 s5, 0xffff0000
    s_waitcnt vmcnt(12)
    v_mfma_f32_16x16x32_bf16 a[160:163], v[96:99], v[40:43], a[160:163]
    buffer_load_dwordx4 a[104:107], v2, s[44:47], s84 offen sc1
    v_mfma_f32_16x16x32_bf16 a[200:203], v[96:99], v[44:47], a[200:203]
    buffer_load_dwordx4 a[108:111], v3, s[44:47], s84 offen sc1
    v_mfma_f32_16x16x32_bf16 a[120:123], v[96:99], a[48:51], a[120:123]
    buffer_load_dwordx4 a[112:115], v4, s[44:47], s84 offen sc1
    v_mfma_f32_16x16x32_bf16 a[140:143], v[96:99], a[52:55], a[140:143]
    buffer_load_dwordx4 v[208:211], v5, s[44:47], s84 offen sc1
    v_mfma_f32_16x16x32_bf16 a[164:167], v[100:103], v[40:43], a[164:167]
    v_lshlrev_b32 v48, 16, v160
    v_and_b32 v49, s5, v160
    v_mfma_f32_16x16x32_bf16 a[224:227], v[100:103], v[44:47], a[224:227]
    v_lshlrev_b32 v50, 16, v161
    v_and_b32 v51, s5, v161
    v_mfma_f32_16x16x32_bf16 a[124:127], v[100:103], a[48:51], a[124:127]
    v_lshlrev_b32 v52, 16, v162
    v_and_b32 v53, s5, v162
    v_mfma_f32_16x16x32_bf16 a[144:147], v[100:103], a[52:55], a[144:147]
    v_lshlrev_b32 v54, 16, v163
    v_and_b32 v55, s5, v163
    v_mfma_f32_16x16x32_bf16 a[168:171], v[104:107], v[40:43], a[168:171]
    v_lshlrev_b32 v56, 16, v164
    v_and_b32 v57, s5, v164
    v_mfma_f32_16x16x32_bf16 a[228:231], v[104:107], v[44:47], a[228:231]
    v_lshlrev_b32 v58, 16, v165
    v_and_b32 v59, s5, v165
    v_mfma_f32_16x16x32_bf16 a[128:131], v[104:107], a[48:51], a[128:131]
    v_lshlrev_b32 v60, 16, v166
    v_and_b32 v61, s5, v166
    v_mfma_f32_16x16x32_bf16 a[148:151], v[104:107], a[52:55], a[148:151]
    v_lshlrev_b32 v62, 16, v167
    v_and_b32 v63, s5, v167
    v_mfma_f32_16x16x32_bf16 a[192:195], v[108:111], v[40:43], a[192:195]
    v_lshlrev_b32 v64, 16, v168
    v_and_b32 v65, s5, v168
    v_mfma_f32_16x16x32_bf16 a[232:235], v[108:111], v[44:47], a[232:235]
    v_lshlrev_b32 v66, 16, v169
    v_and_b32 v67, s5, v169
    v_mfma_f32_16x16x32_bf16 a[132:135], v[108:111], a[48:51], a[132:135]
    v_lshlrev_b32 v68, 16, v170
    v_and_b32 v69, s5, v170
    v_mfma_f32_16x16x32_bf16 a[152:155], v[108:111], a[52:55], a[152:155]
    v_lshlrev_b32 v70, 16, v171
    v_and_b32 v71, s5, v171
    v_mfma_f32_16x16x32_bf16 a[196:199], v[112:115], v[40:43], a[196:199]
    v_mfma_f32_16x16x32_bf16 a[116:119], v[112:115], v[44:47], a[116:119]
    v_mfma_f32_16x16x32_bf16 a[136:139], v[112:115], a[48:51], a[136:139]
    v_mfma_f32_16x16x32_bf16 a[156:159], v[112:115], a[52:55], a[156:159]
    s_waitcnt vmcnt(12)
    v_mfma_f32_16x16x32_bf16 a[160:163], v[116:119], a[56:59], a[160:163]
    v_mfma_f32_16x16x32_bf16 a[200:203], v[116:119], a[60:63], a[200:203]
    v_mfma_f32_16x16x32_bf16 a[120:123], v[116:119], a[64:67], a[120:123]
    v_mfma_f32_16x16x32_bf16 a[140:143], v[116:119], a[68:71], a[140:143]
    v_mfma_f32_16x16x32_bf16 a[164:167], v[120:123], a[56:59], a[164:167]
    v_mfma_f32_16x16x32_bf16 a[224:227], v[120:123], a[60:63], a[224:227]
    v_mfma_f32_16x16x32_bf16 a[124:127], v[120:123], a[64:67], a[124:127]
    v_mfma_f32_16x16x32_bf16 a[144:147], v[120:123], a[68:71], a[144:147]
    v_mfma_f32_16x16x32_bf16 a[168:171], v[124:127], a[56:59], a[168:171]
    v_mfma_f32_16x16x32_bf16 a[228:231], v[124:127], a[60:63], a[228:231]
    v_mfma_f32_16x16x32_bf16 a[128:131], v[124:127], a[64:67], a[128:131]
    v_mfma_f32_16x16x32_bf16 a[148:151], v[124:127], a[68:71], a[148:151]
    v_mfma_f32_16x16x32_bf16 a[192:195], v[128:131], a[56:59], a[192:195]
    v_mfma_f32_16x16x32_bf16 a[232:235], v[128:131], a[60:63], a[232:235]
    v_mfma_f32_16x16x32_bf16 a[132:135], v[128:131], a[64:67], a[132:135]
    v_mfma_f32_16x16x32_bf16 a[152:155], v[128:131], a[68:71], a[152:155]
    v_mfma_f32_16x16x32_bf16 a[196:199], v[132:135], a[56:59], a[196:199]
    v_mfma_f32_16x16x32_bf16 a[116:119], v[132:135], a[60:63], a[116:119]
    v_mfma_f32_16x16x32_bf16 a[136:139], v[132:135], a[64:67], a[136:139]
    v_mfma_f32_16x16x32_bf16 a[156:159], v[132:135], a[68:71], a[156:159]
    s_waitcnt vmcnt(8)
    s_waitcnt vmcnt(4)
    s_waitcnt vmcnt(0)
    v_mfma_f32_16x16x32_bf16 a[200:203], v[136:139], a[76:79], a[200:203]
    v_mfma_f32_16x16x32_bf16 a[200:203], v[156:159], a[92:95], a[200:203]
    v_mfma_f32_16x16x32_bf16 a[200:203], v[188:191], a[108:111], a[200:203]
    v_mfma_f32_16x16x32_bf16 a[224:227], v[140:143], a[76:79], a[224:227]
    v_mfma_f32_16x16x32_bf16 a[224:227], v[172:175], a[92:95], a[224:227]
    v_mfma_f32_16x16x32_bf16 a[224:227], v[192:195], a[108:111], a[224:227]
    v_mfma_f32_16x16x32_bf16 a[228:231], v[144:147], a[76:79], a[228:231]
    v_mfma_f32_16x16x32_bf16 a[228:231], v[176:179], a[92:95], a[228:231]
    v_mfma_f32_16x16x32_bf16 a[228:231], v[196:199], a[108:111], a[228:231]
    v_mfma_f32_16x16x32_bf16 a[232:235], v[148:151], a[76:79], a[232:235]
    v_mfma_f32_16x16x32_bf16 a[232:235], v[180:183], a[92:95], a[232:235]
    ds_write_b128 v10, a[200:203] offset:0
    v_mfma_f32_16x16x32_bf16 a[232:235], v[200:203], a[108:111], a[232:235]
    v_mfma_f32_16x16x32_bf16 a[116:119], v[152:155], a[76:79], a[116:119]
    v_mfma_f32_16x16x32_bf16 a[116:119], v[184:187], a[92:95], a[116:119]
    ds_write_b128 v10, a[224:227] offset:32
    v_mfma_f32_16x16x32_bf16 a[116:119], v[204:207], a[108:111], a[116:119]
    v_mfma_f32_16x16x32_bf16 a[120:123], v[136:139], a[80:83], a[120:123]
    v_mfma_f32_16x16x32_bf16 a[120:123], v[156:159], a[96:99], a[120:123]
    ds_write_b128 v10, a[228:231] offset:64
    v_mfma_f32_16x16x32_bf16 a[120:123], v[188:191], a[112:115], a[120:123]
    v_mfma_f32_16x16x32_bf16 a[124:127], v[140:143], a[80:83], a[124:127]
    v_mfma_f32_16x16x32_bf16 a[124:127], v[172:175], a[96:99], a[124:127]
    ds_write_b128 v10, a[232:235] offset:96
    v_mfma_f32_16x16x32_bf16 a[124:127], v[192:195], a[112:115], a[124:127]
    v_mfma_f32_16x16x32_bf16 a[128:131], v[144:147], a[80:83], a[128:131]
    v_mfma_f32_16x16x32_bf16 a[128:131], v[176:179], a[96:99], a[128:131]
    ds_write_b128 v10, a[116:119] offset:128
    v_mfma_f32_16x16x32_bf16 a[128:131], v[196:199], a[112:115], a[128:131]
    v_mfma_f32_16x16x32_bf16 a[132:135], v[148:151], a[80:83], a[132:135]
    v_mfma_f32_16x16x32_bf16 a[132:135], v[180:183], a[96:99], a[132:135]
    ds_write_b128 v12, a[120:123] offset:0
    v_mfma_f32_16x16x32_bf16 a[132:135], v[200:203], a[112:115], a[132:135]
    v_mfma_f32_16x16x32_bf16 a[136:139], v[152:155], a[80:83], a[136:139]
    v_mfma_f32_16x16x32_bf16 a[136:139], v[184:187], a[96:99], a[136:139]
    ds_write_b128 v12, a[124:127] offset:32
    v_mfma_f32_16x16x32_bf16 a[136:139], v[204:207], a[112:115], a[136:139]
    v_mfma_f32_16x16x32_bf16 a[140:143], v[136:139], a[84:87], a[140:143]
    v_mfma_f32_16x16x32_bf16 a[140:143], v[156:159], a[100:103], a[140:143]
    ds_write_b128 v12, a[128:131] offset:64
    v_mfma_f32_16x16x32_bf16 a[140:143], v[188:191], v[208:211], a[140:143]
    v_mfma_f32_16x16x32_bf16 a[144:147], v[140:143], a[84:87], a[144:147]
    v_mfma_f32_16x16x32_bf16 a[144:147], v[172:175], a[100:103], a[144:147]
    ds_write_b128 v12, a[132:135] offset:96
    v_mfma_f32_16x16x32_bf16 a[144:147], v[192:195], v[208:211], a[144:147]
    v_mfma_f32_16x16x32_bf16 a[148:151], v[144:147], a[84:87], a[148:151]
    v_mfma_f32_16x16x32_bf16 a[148:151], v[176:179], a[100:103], a[148:151]
    ds_write_b128 v12, a[136:139] offset:128
    v_mfma_f32_16x16x32_bf16 a[148:151], v[196:199], v[208:211], a[148:151]
    v_mfma_f32_16x16x32_bf16 a[152:155], v[148:151], a[84:87], a[152:155]
    v_mfma_f32_16x16x32_bf16 a[152:155], v[180:183], a[100:103], a[152:155]
    ds_write_b128 v13, a[140:143] offset:0
    v_mfma_f32_16x16x32_bf16 a[152:155], v[200:203], v[208:211], a[152:155]
    v_mfma_f32_16x16x32_bf16 a[156:159], v[152:155], a[84:87], a[156:159]
    v_mfma_f32_16x16x32_bf16 a[156:159], v[184:187], a[100:103], a[156:159]
    ds_write_b128 v13, a[144:147] offset:32
    v_mfma_f32_16x16x32_bf16 a[156:159], v[204:207], v[208:211], a[156:159]
    v_mfma_f32_16x16x32_bf16 a[160:163], v[136:139], a[72:75], a[160:163]
    v_mfma_f32_16x16x32_bf16 a[160:163], v[156:159], a[88:91], a[160:163]
    ds_write_b128 v13, a[148:151] offset:64
    v_mfma_f32_16x16x32_bf16 a[160:163], v[188:191], a[104:107], a[160:163]
    v_mfma_f32_16x16x32_bf16 a[164:167], v[140:143], a[72:75], a[164:167]
    v_mfma_f32_16x16x32_bf16 a[164:167], v[172:175], a[88:91], a[164:167]
    ds_write_b128 v13, a[152:155] offset:96
    v_mfma_f32_16x16x32_bf16 a[164:167], v[192:195], a[104:107], a[164:167]
    v_mfma_f32_16x16x32_bf16 a[168:171], v[144:147], a[72:75], a[168:171]
    v_mfma_f32_16x16x32_bf16 a[168:171], v[176:179], a[88:91], a[168:171]
    ds_write_b128 v13, a[156:159] offset:128
    v_mfma_f32_16x16x32_bf16 a[168:171], v[196:199], a[104:107], a[168:171]
    v_mfma_f32_16x16x32_bf16 a[192:195], v[148:151], a[72:75], a[192:195]
    v_mfma_f32_16x16x32_bf16 a[192:195], v[180:183], a[88:91], a[192:195]
    ds_write_b128 v9, a[160:163] offset:0
    v_mfma_f32_16x16x32_bf16 a[192:195], v[200:203], a[104:107], a[192:195]
    v_mfma_f32_16x16x32_bf16 a[196:199], v[152:155], a[72:75], a[196:199]
    v_mfma_f32_16x16x32_bf16 a[196:199], v[184:187], a[88:91], a[196:199]
    ds_write_b128 v9, a[164:167] offset:32
    v_mfma_f32_16x16x32_bf16 a[196:199], v[204:207], a[104:107], a[196:199]
    s_nop 3
    ds_write_b128 v9, a[168:171] offset:64
    ds_write_b128 v9, a[192:195] offset:96
    s_nop 2
    ds_write_b128 v9, a[196:199] offset:128
    s_waitcnt lgkmcnt(0)
    s_barrier
    ds_read_b128 v[96:99], v20 offset:0
    ds_read_b128 v[100:103], v20 offset:2576
    ds_read_b128 v[104:107], v20 offset:5152
    ds_read_b128 v[108:111], v20 offset:7728
    ds_read_b128 v[112:115], v20 offset:10304
    ds_read_b128 v[116:119], v20 offset:12880
    ds_read_b128 v[120:123], v20 offset:15456
    ds_read_b128 v[124:127], v20 offset:18032
    ds_read_b128 v[128:131], v21 offset:0
    ds_read_b128 v[132:135], v21 offset:2576
    ds_read_b128 v[136:139], v21 offset:5152
    ds_read_b128 v[140:143], v21 offset:7728
    ds_read_b128 v[144:147], v21 offset:10304
    ds_read_b128 v[148:151], v21 offset:12880
    ds_read_b128 v[152:155], v21 offset:15456
    ds_read_b128 v[156:159], v21 offset:18032
    s_waitcnt lgkmcnt(8)
    ds_read_b128 v[208:211], v24 offset:0
    ds_read_b128 v[212:215], v24 offset:2576
    ds_read_b128 v[216:219], v24 offset:5152
    ds_read_b128 v[220:223], v24 offset:7728
    ds_read_b128 v[224:227], v24 offset:10304
    ds_read_b128 v[228:231], v24 offset:12880
    ds_read_b128 v[232:235], v24 offset:15456
    ds_read_b128 v[236:239], v24 offset:18032
    v_pk_add_f32 v[48:49], v[48:49], v[96:97]
    v_pk_add_f32 v[50:51], v[50:51], v[98:99]
    v_pk_add_f32 v[52:53], v[52:53], v[100:101]
    v_pk_add_f32 v[54:55], v[54:55], v[102:103]
    v_pk_add_f32 v[48:49], v[48:49], v[104:105]
    v_pk_add_f32 v[50:51], v[50:51], v[106:107]
    v_pk_add_f32 v[52:53], v[52:53], v[108:109]
    v_pk_add_f32 v[54:55], v[54:55], v[110:111]
    v_pk_add_f32 v[48:49], v[48:49], v[112:113]
    v_pk_add_f32 v[50:51], v[50:51], v[114:115]
    v_pk_add_f32 v[52:53], v[52:53], v[116:117]
    v_pk_add_f32 v[54:55], v[54:55], v[118:119]
    v_pk_add_f32 v[48:49], v[48:49], v[120:121]
    v_pk_add_f32 v[50:51], v[50:51], v[122:123]
    v_pk_add_f32 v[52:53], v[52:53], v[124:125]
    v_pk_add_f32 v[54:55], v[54:55], v[126:127]
    v_cvt_pk_bf16_f32 v160, v48, v49
    v_cvt_pk_bf16_f32 v161, v50, v51
    v_cvt_pk_bf16_f32 v162, v52, v53
    v_cvt_pk_bf16_f32 v163, v54, v55
    buffer_store_dwordx4 v[160:163], v17, s[56:59], s94 offen
    s_waitcnt lgkmcnt(8)
    v_pk_add_f32 v[56:57], v[56:57], v[128:129]
    v_pk_add_f32 v[58:59], v[58:59], v[130:131]
    v_pk_add_f32 v[60:61], v[60:61], v[132:133]
    v_pk_add_f32 v[62:63], v[62:63], v[134:135]
    v_pk_add_f32 v[56:57], v[56:57], v[136:137]
    v_pk_add_f32 v[58:59], v[58:59], v[138:139]
    v_pk_add_f32 v[60:61], v[60:61], v[140:141]
    v_pk_add_f32 v[62:63], v[62:63], v[142:143]
    v_pk_add_f32 v[56:57], v[56:57], v[144:145]
    v_pk_add_f32 v[58:59], v[58:59], v[146:147]
    v_pk_add_f32 v[60:61], v[60:61], v[148:149]
    v_pk_add_f32 v[62:63], v[62:63], v[150:151]
    v_pk_add_f32 v[56:57], v[56:57], v[152:153]
    v_pk_add_f32 v[58:59], v[58:59], v[154:155]
    v_pk_add_f32 v[60:61], v[60:61], v[156:157]
    v_pk_add_f32 v[62:63], v[62:63], v[158:159]
    v_cvt_pk_bf16_f32 v164, v56, v57
    v_cvt_pk_bf16_f32 v165, v58, v59
    v_cvt_pk_bf16_f32 v166, v60, v61
    v_cvt_pk_bf16_f32 v167, v62, v63
    buffer_store_dwordx4 v[164:167], v18, s[56:59], s94 offen
    s_waitcnt lgkmcnt(0)
    v_pk_add_f32 v[64:65], v[64:65], v[208:209]
    v_pk_add_f32 v[66:67], v[66:67], v[210:211]
    v_pk_add_f32 v[68:69], v[68:69], v[212:213]
    v_pk_add_f32 v[70:71], v[70:71], v[214:215]
    v_pk_add_f32 v[64:65], v[64:65], v[216:217]
    v_pk_add_f32 v[66:67], v[66:67], v[218:219]
    v_pk_add_f32 v[68:69], v[68:69], v[220:221]
    v_pk_add_f32 v[70:71], v[70:71], v[222:223]
    v_pk_add_f32 v[64:65], v[64:65], v[224:225]
    v_pk_add_f32 v[66:67], v[66:67], v[226:227]
    v_pk_add_f32 v[68:69], v[68:69], v[228:229]
    v_pk_add_f32 v[70:71], v[70:71], v[230:231]
    v_pk_add_f32 v[64:65], v[64:65], v[232:233]
    v_pk_add_f32 v[66:67], v[66:67], v[234:235]
    v_pk_add_f32 v[68:69], v[68:69], v[236:237]
    v_pk_add_f32 v[70:71], v[70:71], v[238:239]
    v_cvt_pk_bf16_f32 v168, v64, v65
    v_cvt_pk_bf16_f32 v169, v66, v67
    v_cvt_pk_bf16_f32 v170, v68, v69
    v_cvt_pk_bf16_f32 v171, v70, v71
    buffer_store_dwordx4 v[168:171], v19, s[56:59], s94 offen
    s_endpgm
ROLEA:
    s_mov_b32 s61, 2796203
    s_waitcnt lgkmcnt(0)
    v_lshlrev_b32 v203, 4, v0
    v_add_u32 v188, s56, v203
    v_add_u32 v189, s57, v203
    v_add_u32 v190, s58, v203
    v_add_u32 v191, s59, v203
    s_bitcmp1_b32 s52, 0
    s_cselect_b32 s48, s48, s98
    s_cselect_b32 s49, s49, s99
    s_mov_b32 s7, 1966080
    s_cselect_b32 s50, 819200, s7
    s_and_b32 s49, s49, 0xffff
    s_mov_b32 s51, 0x20000
    s_andn2_b32 s96, s52, 1
    v_mov_b32 v185, s53
    v_mov_b32 v186, s54
    v_mov_b32 v187, s55
    s_mov_b32 s56, s100
    s_and_b32 s57, s101, 0xffff
    s_mov_b32 s58, 2621440
    s_mov_b32 s59, 0x20000
    s_mul_i32 s52, s2, 3856
    s_lshr_b32 s52, s52, 16
    s_cmp_ge_u32 s52, 5
    s_cselect_b32 s53, 1, 0
    s_mul_i32 s54, s53, 5
    s_sub_u32 s54, s52, s54
    s_sub_u32 s52, s52, s53
    s_lshl_b32 s52, s52, 8
    s_sub_u32 s53, s52, 256
    s_cmp_ge_u32 s54, 1
    s_cselect_b32 s53, s53, 2146435072
    s_cmp_le_u32 s54, 3
    s_cselect_b32 s52, s52, 2146435072
    v_mov_b32 v201, s53
    v_mov_b32 v202, s52
    v_cmp_gt_u32 vcc, 8, v0
    s_lshr_b32 s54, s3, 1
    s_mul_i32 s54, s54, 348160
    s_and_b32 s55, s3, 1
    s_lshl_b32 s55, s55, 11
    s_add_u32 s54, s54, s55
    s_add_u32 s54, s54, s88
    v_cndmask_b32 v201, v202, v201, vcc
    s_mul_i32 s62, s87, 1536
    s_add_u32 s62, s62, 14114816
    s_lshl_b32 s63, s4, 2
    s_add_u32 s63, s63, s3
    s_lshl_b32 s63, s63, 8
    s_add_u32 s63, s63, 14139392
    s_mul_i32 s7, s3, 5120
    s_add_u32 s92, s92, s7
    s_add_u32 s93, s93, s7
    v_add_u32 v15, s92, v203
    v_add_u32 v16, 4096, v15
    s_add_u32 m0, s60, 36864
    s_mul_hi_u32 s5, s75, s61
    buffer_load_dwordx4 v160, s[28:31], s5 offen offset:0  lds
    buffer_load_dwordx4 v161, s[28:31], s5 offen offset:1024  lds
    buffer_load_dwordx4 v162, s[28:31], s5 offen offset:2048  lds
    buffer_load_dwordx4 v163, s[28:31], s5 offen offset:3072  lds
    s_waitcnt vmcnt(14)
    v_add_u32 v164, s60, v164
    v_add_u32 v165, s60, v165
    v_add_u32 v166, s60, v166
    v_add_u32 v167, s60, v167
    v_mov_b32 v9, v168
    v_add_u32 v10, 65536, v168
    v_add_u32 v11, 131072, v168
    v_mov_b32 v12, v170
    v_add_u32 v13, 65536, v170
    v_add_u32 v14, 131072, v170
    v_mov_b32 v208, v181
    v_mov_b32 v209, v181
    v_mov_b32 v210, v181
    v_mov_b32 v211, v181
    v_add_u32 v1, s54, v171
    v_add_u32 v172, s60, v172
    v_add_u32 v175, v175, v201
    v_mul_lo_u32 v185, v185, v174
    v_add3_u32 v184, v185, v173, s96
    v_add_u32 v185, v184, v186
    v_add_u32 v186, v184, v187
    v_add_u32 v187, v185, v187
    v_add_u32 v176, s60, v176
    v_add_u32 v177, s60, v177
    v_add_u32 v180, s60, v180
    v_cmp_le_u32 vcc, 5, v179
    s_mul_i32 s55, s3, 5
    v_min_u32 v200, 4, v179
    v_add_u32 v200, s55, v200
    v_lshrrev_b32 v202, 2, v200
    v_lshlrev_b32 v202, 5, v202
    v_and_b32 v203, 1, v200
    v_lshl_add_u32 v202, v203, 4, v202
    v_and_b32 v203, 2, v200
    v_lshl_add_u32 v202, v203, 2, v202
    v_add_u32 v173, v202, v178
    v_add_u32 v200, 20, v200
    v_lshrrev_b32 v202, 2, v200
    v_lshlrev_b32 v202, 5, v202
    v_and_b32 v203, 1, v200
    v_lshl_add_u32 v202, v203, 4, v202
    v_and_b32 v203, 2, v200
    v_lshl_add_u32 v202, v203, 2, v202
    v_mov_b32 v203, 320
    v_cndmask_b32 v202, v202, v203, vcc
    v_add_u32 v174, v202, v178
    s_waitcnt vmcnt(9)
    s_cmp_eq_u32 s4, 0
    s_cselect_b32 s7, 0, 2146435072
    s_mov_b64 exec, 1
    buffer_atomic_add v11, off, s[24:27], s7 sc1
    s_mov_b64 exec, -1
    ds_read_b128 a[0:3], v164 offset:0
    ds_read_b128 a[4:7], v165 offset:0
    ds_read_b128 a[8:11], v166 offset:0
    ds_read_b128 a[12:15], v167 offset:0
    ds_read_b128 v[240:243], v164
    ds_read_b128 v[244:247], v165
    ds_read_b128 v[248:251], v166
    ds_read_b128 v[252:255], v167
    s_mov_b32 s7, 0x3f803f80
    s_waitcnt lgkmcnt(0)
    v_dot2c_f32_bf16 v192, s7, v240
    v_dot2c_f32_bf16 v194, v240, v240
    v_dot2c_f32_bf16 v193, s7, v241
    v_dot2c_f32_bf16 v195, v241, v241
    v_dot2c_f32_bf16 v192, s7, v242
    v_dot2c_f32_bf16 v194, v242, v242
    v_dot2c_f32_bf16 v193, s7, v243
    v_dot2c_f32_bf16 v195, v243, v243
    v_dot2c_f32_bf16 v192, s7, v244
    v_dot2c_f32_bf16 v194, v244, v244
    v_dot2c_f32_bf16 v193, s7, v245
    v_dot2c_f32_bf16 v195, v245, v245
    v_dot2c_f32_bf16 v192, s7, v246
    v_dot2c_f32_bf16 v194, v246, v246
    v_dot2c_f32_bf16 v193, s7, v247
    v_dot2c_f32_bf16 v195, v247, v247
    v_dot2c_f32_bf16 v192, s7, v248
    v_dot2c_f32_bf16 v194, v248, v248
    v_dot2c_f32_bf16 v193, s7, v249
    v_dot2c_f32_bf16 v195, v249, v249
    v_dot2c_f32_bf16 v192, s7, v250
    v_dot2c_f32_bf16 v194, v250, v250
    v_dot2c_f32_bf16 v193, s7, v251
    v_dot2c_f32_bf16 v195, v251, v251
    v_dot2c_f32_bf16 v192, s7, v252
    v_dot2c_f32_bf16 v194, v252, v252
    v_dot2c_f32_bf16 v193, s7, v253
    v_dot2c_f32_bf16 v195, v253, v253
    v_dot2c_f32_bf16 v192, s7, v254
    v_dot2c_f32_bf16 v194, v254, v254
    v_dot2c_f32_bf16 v193, s7, v255
    v_dot2c_f32_bf16 v195, v255, v255
    s_nop 2
    v_add_f32 v192, v192, v193
    v_add_f32 v194, v194, v195
    s_nop 1
    v_permlane32_swap_b32 v192, v194
    s_nop 1
    v_add_f32 v197, v192, v194
    s_add_u32 m0, s60, 5120
    s_nop 0
    buffer_load_dwordx4 v2, s[32:35], s65 offen offset:0  lds
    buffer_load_dwordx4 v3, s[32:35], s65 offen offset:1024  lds
    buffer_load_dwordx4 v4, s[32:35], s65 offen offset:2048  lds
    buffer_load_dwordx4 v5, s[32:35], s65 offen offset:3072  lds
    s_add_u32 m0, s60, 9216
    s_nop 0
    buffer_load_dwordx4 v6, s[32:35], s65 offen offset:0  lds
    s_waitcnt vmcnt(10)
    s_barrier
    ds_read_b64_tr_b16 a[160:161], v9 offset:0
    ds_read_b64_tr_b16 a[162:163], v9 offset:1280
    ds_read_b64_tr_b16 a[164:165], v9 offset:64
    ds_read_b64_tr_b16 a[166:167], v9 offset:1344
    ds_read_b64_tr_b16 a[168:169], v9 offset:128
    ds_read_b64_tr_b16 a[170:171], v9 offset:1408
    ds_read_b64_tr_b16 a[172:173], v9 offset:192
    ds_read_b64_tr_b16 a[174:175], v9 offset:1472
    ds_read_b64_tr_b16 a[176:177], v9 offset:256
    ds_read_b64_tr_b16 a[178:179], v9 offset:1536
    ds_read_b64_tr_b16 a[192:193], v9 offset:40960
    ds_read_b64_tr_b16 a[194:195], v9 offset:42240
    ds_read_b64_tr_b16 a[196:197], v9 offset:41024
    ds_read_b64_tr_b16 a[198:199], v9 offset:42304
    ds_read_b64_tr_b16 a[200:201], v9 offset:41088
    ds_read_b64_tr_b16 a[202:203], v9 offset:42368
    ds_read_b64_tr_b16 a[204:205], v9 offset:41152
    ds_read_b64_tr_b16 a[206:207], v9 offset:42432
    ds_read_b64_tr_b16 a[208:209], v9 offset:41216
    ds_read_b64_tr_b16 a[210:211], v9 offset:42496
    s_waitcnt lgkmcnt(10)
    v_mfma_f32_32x32x16_bf16 v[32:47], a[160:163], a[0:3], 0
    s_add_u32 m0, s60, 20480
    s_bitcmp1_b32 s2, 2
    s_cselect_b32 s97, s74, s74
    s_cmp_eq_u32 s86, 2146435072
    s_cselect_b32 s97, s86, s97
    ds_read_b64_tr_b16 a[224:225], v10 offset:16384
    ds_read_b64_tr_b16 a[226:227], v10 offset:17664
    v_mfma_f32_32x32x16_bf16 v[48:63], a[164:167], a[0:3], 0
    ds_read_b64_tr_b16 a[228:229], v10 offset:16448
    ds_read_b64_tr_b16 a[230:231], v10 offset:17728
    buffer_load_dwordx4 v7, s[36:39], s97 offen offset:0 lds
    v_mfma_f32_32x32x16_bf16 v[64:79], a[168:171], a[0:3], 0
    ds_read_b64_tr_b16 a[232:233], v10 offset:16512
    ds_read_b64_tr_b16 a[234:235], v10 offset:17792
    buffer_load_dwordx4 v8, s[36:39], s97 offen offset:1024 lds
    v_mfma_f32_32x32x16_bf16 v[80:95], a[172:175], a[0:3], 0
    ds_read_b64_tr_b16 a[236:237], v10 offset:16576
    ds_read_b64_tr_b16 a[238:239], v10 offset:17856
    buffer_load_dwordx4 v7, s[40:43], s97 offen offset:2048 lds
    v_mfma_f32_32x32x16_bf16 v[96:111], a[176:179], a[0:3], 0
    ds_read_b64_tr_b16 a[240:241], v10 offset:16640
    ds_read_b64_tr_b16 a[242:243], v10 offset:17920
    buffer_load_dwordx4 v8, s[40:43], s97 offen offset:3072 lds
    s_cmp_lg_u32 s3, 0
    s_cbranch_scc1 CSK29
    v_mfma_f32_16x16x32_bf16 v[212:215], v[208:211], a[160:163], 0
    v_mfma_f32_16x16x32_bf16 v[216:219], v[208:211], a[164:167], 0
    s_branch CSE28
CSK29:
    s_cmp_lg_u32 s3, 1
    s_cbranch_scc1 CSK30
    v_mfma_f32_16x16x32_bf16 v[212:215], v[208:211], a[168:171], 0
    v_mfma_f32_16x16x32_bf16 v[216:219], v[208:211], a[172:175], 0
    s_branch CSE28
CSK30:
    s_cmp_lg_u32 s3, 2
    s_cbranch_scc1 CSK31
    v_mfma_f32_16x16x32_bf16 v[212:215], v[208:211], a[176:179], 0
    v_mfma_f32_16x16x32_bf16 v[216:219], v[208:211], a[176:179], 0
    s_branch CSE28
CSK31:
CSE28:
    s_waitcnt lgkmcnt(10)
    v_mfma_f32_32x32x16_bf16 v[32:47], a[192:195], a[4:7], v[32:47]
    s_add_u32 m0, s60, 28672
    s_nop 0
    ds_read_b64_tr_b16 a[160:161], v10 offset:57344
    ds_read_b64_tr_b16 a[162:163], v10 offset:58624
    buffer_load_dwordx4 v184, s[48:51], 0 offen offset:0  lds
    v_mfma_f32_32x32x16_bf16 v[48:63], a[196:199], a[4:7], v[48:63]
    ds_read_b64_tr_b16 a[164:165], v10 offset:57408
    ds_read_b64_tr_b16 a[166:167], v10 offset:58688
    buffer_load_dwordx4 v185, s[48:51], 0 offen offset:1024  lds
    v_mfma_f32_32x32x16_bf16 v[64:79], a[200:203], a[4:7], v[64:79]
    ds_read_b64_tr_b16 a[168:169], v10 offset:57472
    ds_read_b64_tr_b16 a[170:171], v10 offset:58752
    buffer_load_dwordx4 v186, s[48:51], 0 offen offset:2048  lds
    v_mfma_f32_32x32x16_bf16 v[80:95], a[204:207], a[4:7], v[80:95]
    ds_read_b64_tr_b16 a[172:173], v10 offset:57536
    ds_read_b64_tr_b16 a[174:175], v10 offset:58816
    buffer_load_dwordx4 v187, s[48:51], 0 offen offset:3072  lds
    v_mfma_f32_32x32x16_bf16 v[96:111], a[208:211], a[4:7], v[96:111]
    s_add_u32 m0, s60, 10240
    ds_read_b64_tr_b16 a[176:177], v10 offset:57600
    ds_read_b64_tr_b16 a[178:179], v10 offset:58880
    buffer_load_dwordx4 v2, s[32:35], s66 offen offset:0  lds
    s_cmp_lg_u32 s3, 0
    s_cbranch_scc1 CSK33
    v_mfma_f32_16x16x32_bf16 v[212:215], v[208:211], a[192:195], v[212:215]
    v_mfma_f32_16x16x32_bf16 v[216:219], v[208:211], a[196:199], v[216:219]
    s_branch CSE32
CSK33:
    s_cmp_lg_u32 s3, 1
    s_cbranch_scc1 CSK34
    v_mfma_f32_16x16x32_bf16 v[212:215], v[208:211], a[200:203], v[212:215]
    v_mfma_f32_16x16x32_bf16 v[216:219], v[208:211], a[204:207], v[216:219]
    s_branch CSE32
CSK34:
    s_cmp_lg_u32 s3, 2
    s_cbranch_scc1 CSK35
    v_mfma_f32_16x16x32_bf16 v[212:215], v[208:211], a[208:211], v[212:215]
    v_mfma_f32_16x16x32_bf16 v[216:219], v[208:211], a[208:211], v[216:219]
    s_branch CSE32
CSK35:
CSE32:
    s_waitcnt lgkmcnt(10)
    v_mfma_f32_32x32x16_bf16 v[32:47], a[224:227], a[8:11], v[32:47]
    s_waitcnt vmcnt(9)
    s_barrier
    ds_read_b64_tr_b16 a[192:193], v9 offset:5120
    ds_read_b64_tr_b16 a[194:195], v9 offset:6400
    buffer_load_dwordx4 v3, s[32:35], s66 offen offset:1024  lds
    v_mfma_f32_32x32x16_bf16 v[48:63], a[228:231], a[8:11], v[48:63]
    ds_read_b64_tr_b16 a[196:197], v9 offset:5184
    ds_read_b64_tr_b16 a[198:199], v9 offset:6464
    ds_read_b128 a[16:19], v164 offset:4096
    buffer_load_dwordx4 v4, s[32:35], s66 offen offset:2048  lds
    v_mfma_f32_32x32x16_bf16 v[64:79], a[232:235], a[8:11], v[64:79]
    ds_read_b64_tr_b16 a[200:201], v9 offset:5248
    ds_read_b64_tr_b16 a[202:203], v9 offset:6528
    ds_read_b128 a[20:23], v165 offset:4096
    buffer_load_dwordx4 v5, s[32:35], s66 offen offset:3072  lds
    v_mfma_f32_32x32x16_bf16 v[80:95], a[236:239], a[8:11], v[80:95]
    s_add_u32 m0, s60, 14336
    ds_read_b64_tr_b16 a[204:205], v9 offset:5312
    ds_read_b64_tr_b16 a[206:207], v9 offset:6592
    ds_read_b128 a[24:27], v166 offset:4096
    v_mfma_f32_32x32x16_bf16 v[96:111], a[240:243], a[8:11], v[96:111]
    ds_read_b64_tr_b16 a[208:209], v9 offset:5376
    ds_read_b64_tr_b16 a[210:211], v9 offset:6656
    ds_read_b128 a[28:31], v167 offset:4096
    buffer_load_dwordx4 v6, s[32:35], s66 offen offset:0  lds
    s_cmp_lg_u32 s3, 0
    s_cbranch_scc1 CSK37
    v_mfma_f32_16x16x32_bf16 v[212:215], v[208:211], a[224:227], v[212:215]
    v_mfma_f32_16x16x32_bf16 v[216:219], v[208:211], a[228:231], v[216:219]
    s_branch CSE36
CSK37:
    s_cmp_lg_u32 s3, 1
    s_cbranch_scc1 CSK38
    v_mfma_f32_16x16x32_bf16 v[212:215], v[208:211], a[232:235], v[212:215]
    v_mfma_f32_16x16x32_bf16 v[216:219], v[208:211], a[236:239], v[216:219]
    s_branch CSE36
CSK38:
    s_cmp_lg_u32 s3, 2
    s_cbranch_scc1 CSK39
    v_mfma_f32_16x16x32_bf16 v[212:215], v[208:211], a[240:243], v[212:215]
    v_mfma_f32_16x16x32_bf16 v[216:219], v[208:211], a[240:243], v[216:219]
    s_branch CSE36
CSK39:
CSE36:
    s_waitcnt lgkmcnt(14)
    v_mfma_f32_32x32x16_bf16 v[32:47], a[160:163], a[12:15], v[32:47]
    s_add_u32 m0, s60, 15360
    ds_read_b64_tr_b16 a[224:225], v9 offset:46080
    ds_read_b64_tr_b16 a[226:227], v9 offset:47360
    v_mfma_f32_32x32x16_bf16 v[48:63], a[164:167], a[12:15], v[48:63]
    ds_read_b64_tr_b16 a[228:229], v9 offset:46144
    ds_read_b64_tr_b16 a[230:231], v9 offset:47424
    buffer_load_dwordx4 v2, s[32:35], s67 offen offset:0  lds
    v_mfma_f32_32x32x16_bf16 v[64:79], a[168:171], a[12:15], v[64:79]
    ds_read_b64_tr_b16 a[232:233], v9 offset:46208
    ds_read_b64_tr_b16 a[234:235], v9 offset:47488
    v_mfma_f32_32x32x16_bf16 v[80:95], a[172:175], a[12:15], v[80:95]
    ds_read_b64_tr_b16 a[236:237], v9 offset:46272
    ds_read_b64_tr_b16 a[238:239], v9 offset:47552
    buffer_load_dwordx4 v3, s[32:35], s67 offen offset:1024  lds
    v_mfma_f32_32x32x16_bf16 v[96:111], a[176:179], a[12:15], v[96:111]
    ds_read_b64_tr_b16 a[240:241], v9 offset:46336
    ds_read_b64_tr_b16 a[242:243], v9 offset:47616
    s_cmp_lg_u32 s3, 0
    s_cbranch_scc1 CSK41
    v_mfma_f32_16x16x32_bf16 v[212:215], v[208:211], a[160:163], v[212:215]
    v_mfma_f32_16x16x32_bf16 v[216:219], v[208:211], a[164:167], v[216:219]
    s_branch CSE40
CSK41:
    s_cmp_lg_u32 s3, 1
    s_cbranch_scc1 CSK42
    v_mfma_f32_16x16x32_bf16 v[212:215], v[208:211], a[168:171], v[212:215]
    v_mfma_f32_16x16x32_bf16 v[216:219], v[208:211], a[172:175], v[216:219]
    s_branch CSE40
CSK42:
    s_cmp_lg_u32 s3, 2
    s_cbranch_scc1 CSK43
    v_mfma_f32_16x16x32_bf16 v[212:215], v[208:211], a[176:179], v[212:215]
    v_mfma_f32_16x16x32_bf16 v[216:219], v[208:211], a[176:179], v[216:219]
    s_branch CSE40
CSK43:
CSE40:
    s_waitcnt lgkmcnt(10)
    v_mfma_f32_32x32x16_bf16 v[32:47], a[192:195], a[16:19], v[32:47]
    ds_read_b64_tr_b16 a[160:161], v10 offset:21504
    ds_read_b64_tr_b16 a[162:163], v10 offset:22784
    buffer_load_dwordx4 v4, s[32:35], s67 offen offset:2048  lds
    v_mfma_f32_32x32x16_bf16 v[48:63], a[196:199], a[16:19], v[48:63]
    ds_read_b64_tr_b16 a[164:165], v10 offset:21568
    ds_read_b64_tr_b16 a[166:167], v10 offset:22848
    v_mfma_f32_32x32x16_bf16 v[64:79], a[200:203], a[16:19], v[64:79]
    ds_read_b64_tr_b16 a[168:169], v10 offset:21632
    ds_read_b64_tr_b16 a[170:171], v10 offset:22912
    buffer_load_dwordx4 v5, s[32:35], s67 offen offset:3072  lds
    v_mfma_f32_32x32x16_bf16 v[80:95], a[204:207], a[16:19], v[80:95]
    s_add_u32 m0, s60, 19456
    ds_read_b64_tr_b16 a[172:173], v10 offset:21696
    ds_read_b64_tr_b16 a[174:175], v10 offset:22976
    v_mfma_f32_32x32x16_bf16 v[96:111], a[208:211], a[16:19], v[96:111]
    ds_read_b64_tr_b16 a[176:177], v10 offset:21760
    ds_read_b64_tr_b16 a[178:179], v10 offset:23040
    buffer_load_dwordx4 v6, s[32:35], s67 offen offset:0  lds
    s_waitcnt lgkmcnt(10)
    v_mfma_f32_32x32x16_bf16 v[32:47], a[224:227], a[20:23], v[32:47]
    s_add_u32 m0, s60, 32768
    s_mul_hi_u32 s5, s76, s61
    ds_read_b64_tr_b16 a[192:193], v10 offset:62464
    ds_read_b64_tr_b16 a[194:195], v10 offset:63744
    s_waitcnt vmcnt(14)
    v_add_u32 v202, s60, v169
    v_add_u32 v203, s60, v170
    v_mfma_f32_32x32x16_bf16 v[48:63], a[228:231], a[20:23], v[48:63]
    ds_read_b64_tr_b16 a[196:197], v10 offset:62528
    ds_read_b64_tr_b16 a[198:199], v10 offset:63808
    buffer_load_dwordx4 v160, s[28:31], s5 offen offset:0  lds
    ds_read_b64_tr_b16 v[112:113], v202 offset:20480
    ds_read_b64_tr_b16 v[114:115], v202 offset:20992
    v_mfma_f32_32x32x16_bf16 v[64:79], a[232:235], a[20:23], v[64:79]
    ds_read_b64_tr_b16 a[200:201], v10 offset:62592
    ds_read_b64_tr_b16 a[202:203], v10 offset:63872
    ds_read_b64_tr_b16 v[116:117], v203 offset:20480
    ds_read_b64_tr_b16 v[118:119], v203 offset:20992
    ds_read_b64_tr_b16 v[120:121], v202 offset:22528
    ds_read_b64_tr_b16 v[122:123], v202 offset:23040
    ds_read_b64_tr_b16 v[124:125], v203 offset:22528
    ds_read_b64_tr_b16 v[126:127], v203 offset:23040
    v_mfma_f32_32x32x16_bf16 v[80:95], a[236:239], a[20:23], v[80:95]
    ds_read_b64_tr_b16 a[204:205], v10 offset:62656
    ds_read_b64_tr_b16 a[206:207], v10 offset:63936
    buffer_load_dwordx4 v161, s[28:31], s5 offen offset:1024  lds
    v_mfma_f32_32x32x16_bf16 v[96:111], a[240:243], a[20:23], v[96:111]
    ds_read_b64_tr_b16 a[208:209], v10 offset:62720
    ds_read_b64_tr_b16 a[210:211], v10 offset:64000
    s_waitcnt lgkmcnt(15)
    v_mfma_f32_32x32x16_bf16 v[32:47], a[160:163], a[24:27], v[32:47]
    buffer_load_dwordx4 v162, s[28:31], s5 offen offset:2048  lds
    s_nop 0
    buffer_load_dwordx4 v163, s[28:31], s5 offen offset:3072  lds
    s_nop 0
    s_waitcnt vmcnt(0)
    s_barrier
    s_add_u32 m0, s60, 36864
    s_mul_hi_u32 s5, s77, s61
    ds_read_b64_tr_b16 a[224:225], v9 offset:10240
    ds_read_b64_tr_b16 a[226:227], v9 offset:11520
    v_mfma_f32_32x32x16_bf16 v[48:63], a[164:167], a[24:27], v[48:63]
    ds_read_b64_tr_b16 a[228:229], v9 offset:10304
    ds_read_b64_tr_b16 a[230:231], v9 offset:11584
    ds_read_b128 a[32:35], v164 offset:0
    buffer_load_dwordx4 v160, s[28:31], s5 offen offset:0  lds
    v_mfma_f32_32x32x16_bf16 v[64:79], a[168:171], a[24:27], v[64:79]
    ds_read_b64_tr_b16 a[232:233], v9 offset:10368
    ds_read_b64_tr_b16 a[234:235], v9 offset:11648
    ds_read_b128 a[36:39], v165 offset:0
    s_waitcnt lgkmcnt(12)
    v_mfma_f32_16x16x32_bf16 v[128:131], v[208:211], v[112:115], 0
    v_mfma_f32_16x16x32_bf16 v[132:135], v[208:211], v[116:119], 0
    v_mfma_f32_16x16x32_bf16 v[136:139], v[208:211], v[120:123], 0
    v_mfma_f32_16x16x32_bf16 v[140:143], v[208:211], v[124:127], 0
    ds_read_b64_tr_b16 v[240:241], v172 offset:0
    ds_read_b64_tr_b16 v[242:243], v172 offset:1024
    ds_read_b64_tr_b16 v[244:245], v172 offset:32
    ds_read_b64_tr_b16 v[246:247], v172 offset:1056
    ds_read_b64_tr_b16 v[248:249], v172 offset:64
    ds_read_b64_tr_b16 v[250:251], v172 offset:1088
    ds_read_b64_tr_b16 v[252:253], v172 offset:96
    ds_read_b64_tr_b16 v[254:255], v172 offset:1120
    v_mfma_f32_32x32x16_bf16 v[80:95], a[172:175], a[24:27], v[80:95]
    ds_read_b64_tr_b16 a[236:237], v9 offset:10432
    ds_read_b64_tr_b16 a[238:239], v9 offset:11712
    ds_read_b128 a[40:43], v166 offset:0
    buffer_load_dwordx4 v161, s[28:31], s5 offen offset:1024  lds
    v_mfma_f32_32x32x16_bf16 v[96:111], a[176:179], a[24:27], v[96:111]
    ds_read_b64_tr_b16 a[240:241], v9 offset:10496
    ds_read_b64_tr_b16 a[242:243], v9 offset:11776
    ds_read_b128 a[44:47], v167 offset:0
    buffer_load_dwordx4 v162, s[28:31], s5 offen offset:2048  lds
    s_waitcnt lgkmcnt(15)
    v_mfma_f32_32x32x16_bf16 v[32:47], a[192:195], a[28:31], v[32:47]
    ds_read_b64_tr_b16 a[160:161], v9 offset:51200
    ds_read_b64_tr_b16 a[162:163], v9 offset:52480
    buffer_load_dwordx4 v163, s[28:31], s5 offen offset:3072  lds
    v_mfma_f32_32x32x16_bf16 v[48:63], a[196:199], a[28:31], v[48:63]
    s_add_u32 m0, s60, 0
    ds_read_b64_tr_b16 a[164:165], v9 offset:51264
    ds_read_b64_tr_b16 a[166:167], v9 offset:52544
    v_mfma_f32_32x32x16_bf16 v[64:79], a[200:203], a[28:31], v[64:79]
    ds_read_b64_tr_b16 a[168:169], v9 offset:51328
    ds_read_b64_tr_b16 a[170:171], v9 offset:52608
    buffer_load_dwordx4 v2, s[32:35], s69 offen offset:0  lds
    s_waitcnt lgkmcnt(12)
    buffer_load_dword v196, off, s[24:27], 0 sc1
    v_mfma_f32_32x32x16_bf16 v[80:95], a[204:207], a[28:31], v[80:95]
    ds_read_b64_tr_b16 a[172:173], v9 offset:51392
    ds_read_b64_tr_b16 a[174:175], v9 offset:52672
    buffer_store_dwordx4 v[240:243], v188, s[44:47], 0 offen sc1
    v_mfma_f32_32x32x16_bf16 v[96:111], a[208:211], a[28:31], v[96:111]
    ds_read_b64_tr_b16 a[176:177], v9 offset:51456
    ds_read_b64_tr_b16 a[178:179], v9 offset:52736
    buffer_store_dwordx4 v[244:247], v189, s[44:47], 0 offen sc1
    s_waitcnt lgkmcnt(10)
    v_mfma_f32_32x32x16_bf16 v[32:47], a[224:227], a[32:35], v[32:47]
    ds_read_b64_tr_b16 a[192:193], v10 offset:26624
    ds_read_b64_tr_b16 a[194:195], v10 offset:27904
    buffer_store_dwordx4 v[248:251], v190, s[44:47], 0 offen sc1
    buffer_load_dwordx4 v3, s[32:35], s69 offen offset:1024  lds
    v_mfma_f32_32x32x16_bf16 v[48:63], a[228:231], a[32:35], v[48:63]
    ds_read_b64_tr_b16 a[196:197], v10 offset:26688
    ds_read_b64_tr_b16 a[198:199], v10 offset:27968
    buffer_store_dwordx4 v[252:255], v191, s[44:47], 0 offen sc1
    buffer_load_dwordx4 v4, s[32:35], s69 offen offset:2048  lds
    v_mfma_f32_32x32x16_bf16 v[64:79], a[232:235], a[32:35], v[64:79]
    ds_read_b64_tr_b16 a[200:201], v10 offset:26752
    ds_read_b64_tr_b16 a[202:203], v10 offset:28032
    buffer_load_dwordx4 v5, s[32:35], s69 offen offset:3072  lds
    v_mfma_f32_32x32x16_bf16 v[80:95], a[236:239], a[32:35], v[80:95]
    s_add_u32 m0, s60, 4096
    ds_read_b64_tr_b16 a[204:205], v10 offset:26816
    ds_read_b64_tr_b16 a[206:207], v10 offset:28096
    v_mfma_f32_32x32x16_bf16 v[96:111], a[240:243], a[32:35], v[96:111]
    ds_read_b64_tr_b16 a[208:209], v10 offset:26880
    ds_read_b64_tr_b16 a[210:211], v10 offset:28160
    buffer_load_dwordx4 v6, s[32:35], s69 offen offset:0  lds
    s_waitcnt lgkmcnt(10)
    v_mfma_f32_32x32x16_bf16 v[32:47], a[160:163], a[36:39], v[32:47]
    s_add_u32 m0, s60, 20480
    ds_read_b64_tr_b16 a[224:225], v11 offset:2048
    ds_read_b64_tr_b16 a[226:227], v11 offset:3328
    v_mfma_f32_32x32x16_bf16 v[48:63], a[164:167], a[36:39], v[48:63]
    ds_read_b64_tr_b16 a[228:229], v11 offset:2112
    ds_read_b64_tr_b16 a[230:231], v11 offset:3392
    buffer_load_dwordx4 v2, s[32:35], s68 offen offset:0  lds
    v_mfma_f32_32x32x16_bf16 v[64:79], a[168:171], a[36:39], v[64:79]
    ds_read_b64_tr_b16 a[232:233], v11 offset:2176
    ds_read_b64_tr_b16 a[234:235], v11 offset:3456
    v_mfma_f32_32x32x16_bf16 v[80:95], a[172:175], a[36:39], v[80:95]
    ds_read_b64_tr_b16 a[236:237], v11 offset:2240
    ds_read_b64_tr_b16 a[238:239], v11 offset:3520
    buffer_load_dwordx4 v3, s[32:35], s68 offen offset:1024  lds
    v_mfma_f32_32x32x16_bf16 v[96:111], a[176:179], a[36:39], v[96:111]
    ds_read_b64_tr_b16 a[240:241], v11 offset:2304
    ds_read_b64_tr_b16 a[242:243], v11 offset:3584
    s_waitcnt lgkmcnt(10)
    v_mfma_f32_32x32x16_bf16 v[32:47], a[192:195], a[40:43], v[32:47]
    s_waitcnt vmcnt(12)
    s_barrier
    ds_read_b64_tr_b16 a[160:161], v9 offset:15360
    ds_read_b64_tr_b16 a[162:163], v9 offset:16640
    buffer_load_dwordx4 v4, s[32:35], s68 offen offset:2048  lds
    v_mfma_f32_32x32x16_bf16 v[48:63], a[196:199], a[40:43], v[48:63]
    ds_read_b64_tr_b16 a[164:165], v9 offset:15424
    ds_read_b64_tr_b16 a[166:167], v9 offset:16704
    ds_read_b128 a[48:51], v164 offset:4096
    buffer_load_dwordx4 v5, s[32:35], s68 offen offset:3072  lds
    s_waitcnt vmcnt(12)
    v_readfirstlane_b32 s98, v196
    s_cmp_ge_u32 s98, 4194304
    s_cbranch_scc0 SPIN44
RET44:
    v_mfma_f32_32x32x16_bf16 v[64:79], a[200:203], a[40:43], v[64:79]
    s_add_u32 m0, s60, 24576
    ds_read_b64_tr_b16 a[168:169], v9 offset:15488
    ds_read_b64_tr_b16 a[170:171], v9 offset:16768
    ds_read_b128 a[52:55], v165 offset:4096
    s_lshl_b32 s7, s3, 8
    s_add_u32 s7, s7, s62
    s_cmp_eq_u32 s86, 2146435072
    s_cselect_b32 s7, s86, s7
    s_cmp_ge_u32 s3, 3
    s_cselect_b32 s7, 2146435072, s7
    v_cmp_gt_u32 vcc, 32, v0
    v_lshlrev_b32 v30, 2, v0
    s_nop 0
    v_cndmask_b32 v212, v216, v212, vcc
    buffer_atomic_add_f32 v212, v30, s[44:47], s7 offen offset:0
    v_mfma_f32_32x32x16_bf16 v[80:95], a[204:207], a[40:43], v[80:95]
    ds_read_b64_tr_b16 a[172:173], v9 offset:15552
    ds_read_b64_tr_b16 a[174:175], v9 offset:16832
    ds_read_b128 a[56:59], v166 offset:4096
    buffer_load_dwordx4 v6, s[32:35], s68 offen offset:0  lds
    s_cmp_eq_u32 s86, 2146435072
    s_cselect_b32 s7, s86, s62
    v_cndmask_b32 v128, v132, v128, vcc
    v_cndmask_b32 v136, v140, v136, vcc
    buffer_atomic_add_f32 v128, v30, s[44:47], s7 offen offset:1024
    buffer_atomic_add_f32 v136, v30, s[44:47], s7 offen offset:1280
    v_mfma_f32_32x32x16_bf16 v[96:111], a[208:211], a[40:43], v[96:111]
    s_add_u32 m0, s60, 32768
    s_mul_hi_u32 s5, s78, s61
    ds_read_b64_tr_b16 a[176:177], v9 offset:15616
    ds_read_b64_tr_b16 a[178:179], v9 offset:16896
    ds_read_b128 a[60:63], v167 offset:4096
    s_cmp_eq_u32 s85, 2146435072
    s_cselect_b32 s7, s85, s63
    buffer_atomic_add_f32 v197, v30, s[44:47], s7 offen
    s_waitcnt lgkmcnt(14)
    v_mfma_f32_32x32x16_bf16 v[32:47], a[224:227], a[44:47], v[32:47]
    ds_read_b64_tr_b16 a[192:193], v9 offset:56320
    ds_read_b64_tr_b16 a[194:195], v9 offset:57600
    buffer_load_dwordx4 v160, s[28:31], s5 offen offset:0  lds
    v_mfma_f32_32x32x16_bf16 v[48:63], a[228:231], a[44:47], v[48:63]
    ds_read_b64_tr_b16 a[196:197], v9 offset:56384
    ds_read_b64_tr_b16 a[198:199], v9 offset:57664
    v_mfma_f32_32x32x16_bf16 v[64:79], a[232:235], a[44:47], v[64:79]
    ds_read_b64_tr_b16 a[200:201], v9 offset:56448
    ds_read_b64_tr_b16 a[202:203], v9 offset:57728
    buffer_load_dwordx4 v161, s[28:31], s5 offen offset:1024  lds
    v_mfma_f32_32x32x16_bf16 v[80:95], a[236:239], a[44:47], v[80:95]
    ds_read_b64_tr_b16 a[204:205], v9 offset:56512
    ds_read_b64_tr_b16 a[206:207], v9 offset:57792
    v_mfma_f32_32x32x16_bf16 v[96:111], a[240:243], a[44:47], v[96:111]
    ds_read_b64_tr_b16 a[208:209], v9 offset:56576
    ds_read_b64_tr_b16 a[210:211], v9 offset:57856
    buffer_load_dwordx4 v162, s[28:31], s5 offen offset:2048  lds
    s_waitcnt lgkmcnt(10)
    v_mfma_f32_32x32x16_bf16 v[32:47], a[160:163], a[48:51], v[32:47]
    ds_read_b64_tr_b16 a[224:225], v10 offset:31744
    ds_read_b64_tr_b16 a[226:227], v10 offset:33024
    v_mfma_f32_32x32x16_bf16 v[48:63], a[164:167], a[48:51], v[48:63]
    ds_read_b64_tr_b16 a[228:229], v10 offset:31808
    ds_read_b64_tr_b16 a[230:231], v10 offset:33088
    buffer_load_dwordx4 v163, s[28:31], s5 offen offset:3072  lds
    v_mfma_f32_32x32x16_bf16 v[64:79], a[168:171], a[48:51], v[64:79]
    s_add_u32 m0, s60, 5120
    ds_read_b64_tr_b16 a[232:233], v10 offset:31872
    ds_read_b64_tr_b16 a[234:235], v10 offset:33152
    v_mfma_f32_32x32x16_bf16 v[80:95], a[172:175], a[48:51], v[80:95]
    ds_read_b64_tr_b16 a[236:237], v10 offset:31936
    ds_read_b64_tr_b16 a[238:239], v10 offset:33216
    buffer_load_dwordx4 v2, s[32:35], s70 offen offset:0  lds
    v_mfma_f32_32x32x16_bf16 v[96:111], a[176:179], a[48:51], v[96:111]
    ds_read_b64_tr_b16 a[240:241], v10 offset:32000
    ds_read_b64_tr_b16 a[242:243], v10 offset:33280
    s_waitcnt lgkmcnt(10)
    v_mfma_f32_32x32x16_bf16 v[32:47], a[192:195], a[52:55], v[32:47]
    ds_read_b64_tr_b16 a[160:161], v11 offset:7168
    ds_read_b64_tr_b16 a[162:163], v11 offset:8448
    buffer_load_dwordx4 v3, s[32:35], s70 offen offset:1024  lds
    v_mfma_f32_32x32x16_bf16 v[48:63], a[196:199], a[52:55], v[48:63]
    ds_read_b64_tr_b16 a[164:165], v11 offset:7232
    ds_read_b64_tr_b16 a[166:167], v11 offset:8512
    v_mfma_f32_32x32x16_bf16 v[64:79], a[200:203], a[52:55], v[64:79]
    ds_read_b64_tr_b16 a[168:169], v11 offset:7296
    ds_read_b64_tr_b16 a[170:171], v11 offset:8576
    buffer_load_dwordx4 v4, s[32:35], s70 offen offset:2048  lds
    v_mfma_f32_32x32x16_bf16 v[80:95], a[204:207], a[52:55], v[80:95]
    ds_read_b64_tr_b16 a[172:173], v11 offset:7360
    ds_read_b64_tr_b16 a[174:175], v11 offset:8640
    v_mfma_f32_32x32x16_bf16 v[96:111], a[208:211], a[52:55], v[96:111]
    ds_read_b64_tr_b16 a[176:177], v11 offset:7424
    ds_read_b64_tr_b16 a[178:179], v11 offset:8704
    buffer_load_dwordx4 v5, s[32:35], s70 offen offset:3072  lds
    s_waitcnt lgkmcnt(10)
    v_mfma_f32_32x32x16_bf16 v[32:47], a[224:227], a[56:59], v[32:47]
    s_waitcnt vmcnt(4)
    s_barrier
    s_add_u32 m0, s60, 9216
    ds_read_b64_tr_b16 a[192:193], v9 offset:20480
    ds_read_b64_tr_b16 a[194:195], v9 offset:21760
    v_mfma_f32_32x32x16_bf16 v[48:63], a[228:231], a[56:59], v[48:63]
    ds_read_b64_tr_b16 a[196:197], v9 offset:20544
    ds_read_b64_tr_b16 a[198:199], v9 offset:21824
    ds_read_b128 a[64:67], v164 offset:0
    buffer_load_dwordx4 v6, s[32:35], s70 offen offset:0  lds
    v_mfma_f32_32x32x16_bf16 v[64:79], a[232:235], a[56:59], v[64:79]
    s_add_u32 m0, s60, 36864
    s_mul_hi_u32 s5, s79, s61
    ds_read_b64_tr_b16 a[200:201], v9 offset:20608
    ds_read_b64_tr_b16 a[202:203], v9 offset:21888
    ds_read_b128 a[68:71], v165 offset:0
    v_mfma_f32_32x32x16_bf16 v[80:95], a[236:239], a[56:59], v[80:95]
    ds_read_b64_tr_b16 a[204:205], v9 offset:20672
    ds_read_b64_tr_b16 a[206:207], v9 offset:21952
    ds_read_b128 a[72:75], v166 offset:0
    buffer_load_dwordx4 v160, s[28:31], s5 offen offset:0  lds
    v_mfma_f32_32x32x16_bf16 v[96:111], a[240:243], a[56:59], v[96:111]
    ds_read_b64_tr_b16 a[208:209], v9 offset:20736
    ds_read_b64_tr_b16 a[210:211], v9 offset:22016
    ds_read_b128 a[76:79], v167 offset:0
    s_waitcnt lgkmcnt(14)
    v_mfma_f32_32x32x16_bf16 v[32:47], a[160:163], a[60:63], v[32:47]
    ds_read_b64_tr_b16 a[224:225], v9 offset:61440
    ds_read_b64_tr_b16 a[226:227], v9 offset:62720
    buffer_load_dwordx4 v161, s[28:31], s5 offen offset:1024  lds
    v_mfma_f32_32x32x16_bf16 v[48:63], a[164:167], a[60:63], v[48:63]
    ds_read_b64_tr_b16 a[228:229], v9 offset:61504
    ds_read_b64_tr_b16 a[230:231], v9 offset:62784
    v_mfma_f32_32x32x16_bf16 v[64:79], a[168:171], a[60:63], v[64:79]
    ds_read_b64_tr_b16 a[232:233], v9 offset:61568
    ds_read_b64_tr_b16 a[234:235], v9 offset:62848
    buffer_load_dwordx4 v162, s[28:31], s5 offen offset:2048  lds
    v_mfma_f32_32x32x16_bf16 v[80:95], a[172:175], a[60:63], v[80:95]
    ds_read_b64_tr_b16 a[236:237], v9 offset:61632
    ds_read_b64_tr_b16 a[238:239], v9 offset:62912
    v_mfma_f32_32x32x16_bf16 v[96:111], a[176:179], a[60:63], v[96:111]
    ds_read_b64_tr_b16 a[240:241], v9 offset:61696
    ds_read_b64_tr_b16 a[242:243], v9 offset:62976
    buffer_load_dwordx4 v163, s[28:31], s5 offen offset:3072  lds
    s_waitcnt lgkmcnt(10)
    v_mfma_f32_32x32x16_bf16 v[32:47], a[192:195], a[64:67], v[32:47]
    s_add_u32 m0, s60, 10240
    ds_read_b64_tr_b16 a[160:161], v10 offset:36864
    ds_read_b64_tr_b16 a[162:163], v10 offset:38144
    v_mfma_f32_32x32x16_bf16 v[48:63], a[196:199], a[64:67], v[48:63]
    ds_read_b64_tr_b16 a[164:165], v10 offset:36928
    ds_read_b64_tr_b16 a[166:167], v10 offset:38208
    buffer_load_dwordx4 v2, s[32:35], s71 offen offset:0  lds
    v_mfma_f32_32x32x16_bf16 v[64:79], a[200:203], a[64:67], v[64:79]
    ds_read_b64_tr_b16 a[168:169], v10 offset:36992
    ds_read_b64_tr_b16 a[170:171], v10 offset:38272
    v_mfma_f32_32x32x16_bf16 v[80:95], a[204:207], a[64:67], v[80:95]
    ds_read_b64_tr_b16 a[172:173], v10 offset:37056
    ds_read_b64_tr_b16 a[174:175], v10 offset:38336
    buffer_load_dwordx4 v3, s[32:35], s71 offen offset:1024  lds
    v_mfma_f32_32x32x16_bf16 v[96:111], a[208:211], a[64:67], v[96:111]
    ds_read_b64_tr_b16 a[176:177], v10 offset:37120
    ds_read_b64_tr_b16 a[178:179], v10 offset:38400
    s_waitcnt lgkmcnt(10)
    v_mfma_f32_32x32x16_bf16 v[32:47], a[224:227], a[68:71], v[32:47]
    ds_read_b64_tr_b16 a[192:193], v11 offset:12288
    ds_read_b64_tr_b16 a[194:195], v11 offset:13568
    buffer_load_dwordx4 v4, s[32:35], s71 offen offset:2048  lds
    v_mfma_f32_32x32x16_bf16 v[48:63], a[228:231], a[68:71], v[48:63]
    ds_read_b64_tr_b16 a[196:197], v11 offset:12352
    ds_read_b64_tr_b16 a[198:199], v11 offset:13632
    v_mfma_f32_32x32x16_bf16 v[64:79], a[232:235], a[68:71], v[64:79]
    ds_read_b64_tr_b16 a[200:201], v11 offset:12416
    ds_read_b64_tr_b16 a[202:203], v11 offset:13696
    buffer_load_dwordx4 v5, s[32:35], s71 offen offset:3072  lds
    v_mfma_f32_32x32x16_bf16 v[80:95], a[236:239], a[68:71], v[80:95]
    s_add_u32 m0, s60, 14336
    ds_read_b64_tr_b16 a[204:205], v11 offset:12480
    ds_read_b64_tr_b16 a[206:207], v11 offset:13760
    v_mfma_f32_32x32x16_bf16 v[96:111], a[240:243], a[68:71], v[96:111]
    ds_read_b64_tr_b16 a[208:209], v11 offset:12544
    ds_read_b64_tr_b16 a[210:211], v11 offset:13824
    buffer_load_dwordx4 v6, s[32:35], s71 offen offset:0  lds
    s_waitcnt lgkmcnt(10)
    v_mfma_f32_32x32x16_bf16 v[32:47], a[160:163], a[72:75], v[32:47]
    s_waitcnt vmcnt(5)
    s_barrier
    s_add_u32 m0, s60, 32768
    s_mul_hi_u32 s5, s80, s61
    ds_read_b64_tr_b16 a[224:225], v9 offset:0
    ds_read_b64_tr_b16 a[226:227], v9 offset:1280
    s_cmp_eq_u32 s3, 0
    s_cselect_b32 s7, s85, 2146435072
    v_lshlrev_b32 v200, 8, v0
    s_mov_b64 exec, 0xffff
    buffer_atomic_add v11, v200, s[44:47], s7 offen offset:4 sc1
    s_mov_b64 exec, -1
    v_mfma_f32_32x32x16_bf16 v[48:63], a[164:167], a[72:75], v[48:63]
    ds_read_b64_tr_b16 a[228:229], v9 offset:64
    ds_read_b64_tr_b16 a[230:231], v9 offset:1344
    ds_read_b128 a[80:83], v164 offset:4096
    buffer_load_dwordx4 v160, s[28:31], s5 offen offset:0  lds
    s_cmp_eq_u32 s3, 0
    s_cselect_b32 s7, s86, 2146435072
    v_lshlrev_b32 v200, 12, v0
    s_mov_b64 exec, 0xffff
    buffer_atomic_add v11, v200, s[44:47], s7 offen offset:4 sc1
    s_mov_b64 exec, -1
    v_mfma_f32_32x32x16_bf16 v[64:79], a[168:171], a[72:75], v[64:79]
    ds_read_b64_tr_b16 a[232:233], v9 offset:128
    ds_read_b64_tr_b16 a[234:235], v9 offset:1408
    ds_read_b128 a[84:87], v165 offset:4096
    s_mov_b32 s7, 13926400
    s_cmp_lt_u32 s2, 170
    s_cselect_b32 s7, s7, 2146435072
    s_cmp_eq_u32 s3, 0
    s_cselect_b32 s7, s7, 2146435072
    s_mov_b64 exec, 0xffff
    buffer_atomic_add v11, v175, s[44:47], s7 offen offset:0 sc1
    s_mov_b64 exec, -1
    v_mfma_f32_32x32x16_bf16 v[80:95], a[172:175], a[72:75], v[80:95]
    ds_read_b64_tr_b16 a[236:237], v9 offset:192
    ds_read_b64_tr_b16 a[238:239], v9 offset:1472
    ds_read_b128 a[88:91], v166 offset:4096
    buffer_load_dwordx4 v161, s[28:31], s5 offen offset:1024  lds
    v_mfma_f32_32x32x16_bf16 v[96:111], a[176:179], a[72:75], v[96:111]
    ds_read_b64_tr_b16 a[240:241], v9 offset:256
    ds_read_b64_tr_b16 a[242:243], v9 offset:1536
    ds_read_b128 a[92:95], v167 offset:4096
    s_waitcnt lgkmcnt(14)
    v_mfma_f32_32x32x16_bf16 v[32:47], a[192:195], a[76:79], v[32:47]
    ds_read_b64_tr_b16 a[160:161], v9 offset:40960
    ds_read_b64_tr_b16 a[162:163], v9 offset:42240
    buffer_load_dwordx4 v162, s[28:31], s5 offen offset:2048  lds
    v_mfma_f32_32x32x16_bf16 v[48:63], a[196:199], a[76:79], v[48:63]
    ds_read_b64_tr_b16 a[164:165], v9 offset:41024
    ds_read_b64_tr_b16 a[166:167], v9 offset:42304
    v_mfma_f32_32x32x16_bf16 v[64:79], a[200:203], a[76:79], v[64:79]
    ds_read_b64_tr_b16 a[168:169], v9 offset:41088
    ds_read_b64_tr_b16 a[170:171], v9 offset:42368
    buffer_load_dwordx4 v163, s[28:31], s5 offen offset:3072  lds
    v_mfma_f32_32x32x16_bf16 v[80:95], a[204:207], a[76:79], v[80:95]
    s_add_u32 m0, s60, 15360
    ds_read_b64_tr_b16 a[172:173], v9 offset:41152
    ds_read_b64_tr_b16 a[174:175], v9 offset:42432
    v_mfma_f32_32x32x16_bf16 v[96:111], a[208:211], a[76:79], v[96:111]
    ds_read_b64_tr_b16 a[176:177], v9 offset:41216
    ds_read_b64_tr_b16 a[178:179], v9 offset:42496
    buffer_load_dwordx4 v2, s[32:35], s72 offen offset:0  lds
    s_waitcnt lgkmcnt(10)
    v_mfma_f32_32x32x16_bf16 v[32:47], a[224:227], a[80:83], v[32:47]
    ds_read_b64_tr_b16 a[192:193], v10 offset:16384
    ds_read_b64_tr_b16 a[194:195], v10 offset:17664
    v_mfma_f32_32x32x16_bf16 v[48:63], a[228:231], a[80:83], v[48:63]
    ds_read_b64_tr_b16 a[196:197], v10 offset:16448
    ds_read_b64_tr_b16 a[198:199], v10 offset:17728
    buffer_load_dwordx4 v3, s[32:35], s72 offen offset:1024  lds
    v_mfma_f32_32x32x16_bf16 v[64:79], a[232:235], a[80:83], v[64:79]
    ds_read_b64_tr_b16 a[200:201], v10 offset:16512
    ds_read_b64_tr_b16 a[202:203], v10 offset:17792
    v_mfma_f32_32x32x16_bf16 v[80:95], a[236:239], a[80:83], v[80:95]
    ds_read_b64_tr_b16 a[204:205], v10 offset:16576
    ds_read_b64_tr_b16 a[206:207], v10 offset:17856
    buffer_load_dwordx4 v4, s[32:35], s72 offen offset:2048  lds
    v_mfma_f32_32x32x16_bf16 v[96:111], a[240:243], a[80:83], v[96:111]
    ds_read_b64_tr_b16 a[208:209], v10 offset:16640
    ds_read_b64_tr_b16 a[210:211], v10 offset:17920
    s_waitcnt lgkmcnt(10)
    v_mfma_f32_32x32x16_bf16 v[32:47], a[160:163], a[84:87], v[32:47]
    ds_read_b64_tr_b16 a[224:225], v10 offset:57344
    ds_read_b64_tr_b16 a[226:227], v10 offset:58624
    buffer_load_dwordx4 v5, s[32:35], s72 offen offset:3072  lds
    v_mfma_f32_32x32x16_bf16 v[48:63], a[164:167], a[84:87], v[48:63]
    s_add_u32 m0, s60, 19456
    ds_read_b64_tr_b16 a[228:229], v10 offset:57408
    ds_read_b64_tr_b16 a[230:231], v10 offset:58688
    v_mfma_f32_32x32x16_bf16 v[64:79], a[168:171], a[84:87], v[64:79]
    ds_read_b64_tr_b16 a[232:233], v10 offset:57472
    ds_read_b64_tr_b16 a[234:235], v10 offset:58752
    buffer_load_dwordx4 v6, s[32:35], s72 offen offset:0  lds
    v_mfma_f32_32x32x16_bf16 v[80:95], a[172:175], a[84:87], v[80:95]
    s_add_u32 m0, s60, 36864
    s_mul_hi_u32 s5, s81, s61
    ds_read_b64_tr_b16 a[236:237], v10 offset:57536
    ds_read_b64_tr_b16 a[238:239], v10 offset:58816
    v_mfma_f32_32x32x16_bf16 v[96:111], a[176:179], a[84:87], v[96:111]
    ds_read_b64_tr_b16 a[240:241], v10 offset:57600
    ds_read_b64_tr_b16 a[242:243], v10 offset:58880
    buffer_load_dwordx4 v160, s[28:31], s5 offen offset:0  lds
    s_waitcnt lgkmcnt(10)
    v_mfma_f32_32x32x16_bf16 v[32:47], a[192:195], a[88:91], v[32:47]
    s_waitcnt vmcnt(6)
    s_barrier
    ds_read_b64_tr_b16 a[160:161], v9 offset:5120
    ds_read_b64_tr_b16 a[162:163], v9 offset:6400
    v_mfma_f32_32x32x16_bf16 v[48:63], a[196:199], a[88:91], v[48:63]
    ds_read_b64_tr_b16 a[164:165], v9 offset:5184
    ds_read_b64_tr_b16 a[166:167], v9 offset:6464
    ds_read_b128 a[96:99], v164 offset:0
    buffer_load_dwordx4 v161, s[28:31], s5 offen offset:1024  lds
    v_mfma_f32_32x32x16_bf16 v[64:79], a[200:203], a[88:91], v[64:79]
    ds_read_b64_tr_b16 a[168:169], v9 offset:5248
    ds_read_b64_tr_b16 a[170:171], v9 offset:6528
    ds_read_b128 a[100:103], v165 offset:0
    v_mfma_f32_32x32x16_bf16 v[80:95], a[204:207], a[88:91], v[80:95]
    ds_read_b64_tr_b16 a[172:173], v9 offset:5312
    ds_read_b64_tr_b16 a[174:175], v9 offset:6592
    ds_read_b128 a[104:107], v166 offset:0
    buffer_load_dwordx4 v162, s[28:31], s5 offen offset:2048  lds
    v_mfma_f32_32x32x16_bf16 v[96:111], a[208:211], a[88:91], v[96:111]
    ds_read_b64_tr_b16 a[176:177], v9 offset:5376
    ds_read_b64_tr_b16 a[178:179], v9 offset:6656
    ds_read_b128 a[108:111], v167 offset:0
    s_waitcnt lgkmcnt(14)
    v_mfma_f32_32x32x16_bf16 v[32:47], a[224:227], a[92:95], v[32:47]
    ds_read_b64_tr_b16 a[192:193], v9 offset:46080
    ds_read_b64_tr_b16 a[194:195], v9 offset:47360
    buffer_load_dwordx4 v163, s[28:31], s5 offen offset:3072  lds
    v_mfma_f32_32x32x16_bf16 v[48:63], a[228:231], a[92:95], v[48:63]
    s_add_u32 m0, s60, 20480
    ds_read_b64_tr_b16 a[196:197], v9 offset:46144
    ds_read_b64_tr_b16 a[198:199], v9 offset:47424
    v_mfma_f32_32x32x16_bf16 v[64:79], a[232:235], a[92:95], v[64:79]
    ds_read_b64_tr_b16 a[200:201], v9 offset:46208
    ds_read_b64_tr_b16 a[202:203], v9 offset:47488
    buffer_load_dwordx4 v2, s[32:35], s73 offen offset:0  lds
    v_mfma_f32_32x32x16_bf16 v[80:95], a[236:239], a[92:95], v[80:95]
    ds_read_b64_tr_b16 a[204:205], v9 offset:46272
    ds_read_b64_tr_b16 a[206:207], v9 offset:47552
    v_mfma_f32_32x32x16_bf16 v[96:111], a[240:243], a[92:95], v[96:111]
    ds_read_b64_tr_b16 a[208:209], v9 offset:46336
    ds_read_b64_tr_b16 a[210:211], v9 offset:47616
    buffer_load_dwordx4 v3, s[32:35], s73 offen offset:1024  lds
    s_waitcnt lgkmcnt(10)
    v_mfma_f32_32x32x16_bf16 v[32:47], a[160:163], a[96:99], v[32:47]
    ds_read_b64_tr_b16 a[224:225], v10 offset:21504
    ds_read_b64_tr_b16 a[226:227], v10 offset:22784
    v_mfma_f32_32x32x16_bf16 v[48:63], a[164:167], a[96:99], v[48:63]
    ds_read_b64_tr_b16 a[228:229], v10 offset:21568
    ds_read_b64_tr_b16 a[230:231], v10 offset:22848
    buffer_load_dwordx4 v4, s[32:35], s73 offen offset:2048  lds
    v_mfma_f32_32x32x16_bf16 v[64:79], a[168:171], a[96:99], v[64:79]
    ds_read_b64_tr_b16 a[232:233], v10 offset:21632
    ds_read_b64_tr_b16 a[234:235], v10 offset:22912
    v_mfma_f32_32x32x16_bf16 v[80:95], a[172:175], a[96:99], v[80:95]
    ds_read_b64_tr_b16 a[236:237], v10 offset:21696
    ds_read_b64_tr_b16 a[238:239], v10 offset:22976
    buffer_load_dwordx4 v5, s[32:35], s73 offen offset:3072  lds
    v_mfma_f32_32x32x16_bf16 v[96:111], a[176:179], a[96:99], v[96:111]
    s_add_u32 m0, s60, 24576
    ds_read_b64_tr_b16 a[240:241], v10 offset:21760
    ds_read_b64_tr_b16 a[242:243], v10 offset:23040
    s_waitcnt lgkmcnt(10)
    v_mfma_f32_32x32x16_bf16 v[32:47], a[192:195], a[100:103], v[32:47]
    ds_read_b64_tr_b16 a[160:161], v10 offset:62464
    ds_read_b64_tr_b16 a[162:163], v10 offset:63744
    buffer_load_dwordx4 v6, s[32:35], s73 offen offset:0  lds
    v_mfma_f32_32x32x16_bf16 v[48:63], a[196:199], a[100:103], v[48:63]
    s_add_u32 m0, s60, 32768
    s_mul_hi_u32 s5, s82, s61
    ds_read_b64_tr_b16 a[164:165], v10 offset:62528
    ds_read_b64_tr_b16 a[166:167], v10 offset:63808
    v_mfma_f32_32x32x16_bf16 v[64:79], a[200:203], a[100:103], v[64:79]
    ds_read_b64_tr_b16 a[168:169], v10 offset:62592
    ds_read_b64_tr_b16 a[170:171], v10 offset:63872
    buffer_load_dwordx4 v160, s[28:31], s5 offen offset:0  lds
    v_mfma_f32_32x32x16_bf16 v[80:95], a[204:207], a[100:103], v[80:95]
    ds_read_b64_tr_b16 a[172:173], v10 offset:62656
    ds_read_b64_tr_b16 a[174:175], v10 offset:63936
    v_mfma_f32_32x32x16_bf16 v[96:111], a[208:211], a[100:103], v[96:111]
    ds_read_b64_tr_b16 a[176:177], v10 offset:62720
    ds_read_b64_tr_b16 a[178:179], v10 offset:64000
    buffer_load_dwordx4 v161, s[28:31], s5 offen offset:1024  lds
    s_waitcnt lgkmcnt(10)
    v_mfma_f32_32x32x16_bf16 v[32:47], a[224:227], a[104:107], v[32:47]
    s_waitcnt vmcnt(7)
    s_barrier
    ds_read_b64_tr_b16 a[192:193], v9 offset:10240
    ds_read_b64_tr_b16 a[194:195], v9 offset:11520
    v_mfma_f32_32x32x16_bf16 v[48:63], a[228:231], a[104:107], v[48:63]
    ds_read_b64_tr_b16 a[196:197], v9 offset:10304
    ds_read_b64_tr_b16 a[198:199], v9 offset:11584
    ds_read_b128 a[112:115], v164 offset:4096
    buffer_load_dwordx4 v162, s[28:31], s5 offen offset:2048  lds
    v_mfma_f32_32x32x16_bf16 v[64:79], a[232:235], a[104:107], v[64:79]
    ds_read_b64_tr_b16 a[200:201], v9 offset:10368
    ds_read_b64_tr_b16 a[202:203], v9 offset:11648
    ds_read_b128 a[116:119], v165 offset:4096
    v_mfma_f32_32x32x16_bf16 v[80:95], a[236:239], a[104:107], v[80:95]
    ds_read_b64_tr_b16 a[204:205], v9 offset:10432
    ds_read_b64_tr_b16 a[206:207], v9 offset:11712
    ds_read_b128 a[120:123], v166 offset:4096
    buffer_load_dwordx4 v163, s[28:31], s5 offen offset:3072  lds
    v_mfma_f32_32x32x16_bf16 v[96:111], a[240:243], a[104:107], v[96:111]
    s_add_u32 m0, s60, 0
    ds_read_b64_tr_b16 a[208:209], v9 offset:10496
    ds_read_b64_tr_b16 a[210:211], v9 offset:11776
    ds_read_b128 a[124:127], v167 offset:4096
    s_waitcnt lgkmcnt(14)
    v_mfma_f32_32x32x16_bf16 v[32:47], a[160:163], a[108:111], v[32:47]
    ds_read_b64_tr_b16 a[224:225], v9 offset:51200
    ds_read_b64_tr_b16 a[226:227], v9 offset:52480
    buffer_load_dwordx4 v7, s[36:39], s74 offen offset:0  lds
    v_mfma_f32_32x32x16_bf16 v[48:63], a[164:167], a[108:111], v[48:63]
    ds_read_b64_tr_b16 a[228:229], v9 offset:51264
    ds_read_b64_tr_b16 a[230:231], v9 offset:52544
    v_mfma_f32_32x32x16_bf16 v[64:79], a[168:171], a[108:111], v[64:79]
    ds_read_b64_tr_b16 a[232:233], v9 offset:51328
    ds_read_b64_tr_b16 a[234:235], v9 offset:52608
    buffer_load_dwordx4 v8, s[36:39], s74 offen offset:1024  lds
    v_mfma_f32_32x32x16_bf16 v[80:95], a[172:175], a[108:111], v[80:95]
    ds_read_b64_tr_b16 a[236:237], v9 offset:51392
    ds_read_b64_tr_b16 a[238:239], v9 offset:52672
    v_mfma_f32_32x32x16_bf16 v[96:111], a[176:179], a[108:111], v[96:111]
    ds_read_b64_tr_b16 a[240:241], v9 offset:51456
    ds_read_b64_tr_b16 a[242:243], v9 offset:52736
    buffer_load_dwordx4 v7, s[40:43], s74 offen offset:2048  lds
    s_waitcnt lgkmcnt(10)
    v_mfma_f32_32x32x16_bf16 v[32:47], a[192:195], a[112:115], v[32:47]
    ds_read_b64_tr_b16 a[160:161], v10 offset:26624
    ds_read_b64_tr_b16 a[162:163], v10 offset:27904
    v_mfma_f32_32x32x16_bf16 v[48:63], a[196:199], a[112:115], v[48:63]
    ds_read_b64_tr_b16 a[164:165], v10 offset:26688
    ds_read_b64_tr_b16 a[166:167], v10 offset:27968
    buffer_load_dwordx4 v8, s[40:43], s74 offen offset:3072  lds
    v_mfma_f32_32x32x16_bf16 v[64:79], a[200:203], a[112:115], v[64:79]
    s_add_u32 m0, s60, 36864
    s_mul_hi_u32 s5, s83, s61
    ds_read_b64_tr_b16 a[168:169], v10 offset:26752
    ds_read_b64_tr_b16 a[170:171], v10 offset:28032
    v_mfma_f32_32x32x16_bf16 v[80:95], a[204:207], a[112:115], v[80:95]
    ds_read_b64_tr_b16 a[172:173], v10 offset:26816
    ds_read_b64_tr_b16 a[174:175], v10 offset:28096
    buffer_load_dwordx4 v160, s[28:31], s5 offen offset:0  lds
    v_mfma_f32_32x32x16_bf16 v[96:111], a[208:211], a[112:115], v[96:111]
    ds_read_b64_tr_b16 a[176:177], v10 offset:26880
    ds_read_b64_tr_b16 a[178:179], v10 offset:28160
    s_waitcnt lgkmcnt(10)
    v_mfma_f32_32x32x16_bf16 v[32:47], a[224:227], a[116:119], v[32:47]
    ds_read_b64_tr_b16 a[192:193], v11 offset:2048
    ds_read_b64_tr_b16 a[194:195], v11 offset:3328
    buffer_load_dwordx4 v161, s[28:31], s5 offen offset:1024  lds
    v_mfma_f32_32x32x16_bf16 v[48:63], a[228:231], a[116:119], v[48:63]
    ds_read_b64_tr_b16 a[196:197], v11 offset:2112
    ds_read_b64_tr_b16 a[198:199], v11 offset:3392
    v_mfma_f32_32x32x16_bf16 v[64:79], a[232:235], a[116:119], v[64:79]
    ds_read_b64_tr_b16 a[200:201], v11 offset:2176
    ds_read_b64_tr_b16 a[202:203], v11 offset:3456
    buffer_load_dwordx4 v162, s[28:31], s5 offen offset:2048  lds
    v_mfma_f32_32x32x16_bf16 v[80:95], a[236:239], a[116:119], v[80:95]
    ds_read_b64_tr_b16 a[204:205], v11 offset:2240
    ds_read_b64_tr_b16 a[206:207], v11 offset:3520
    v_mfma_f32_32x32x16_bf16 v[96:111], a[240:243], a[116:119], v[96:111]
    ds_read_b64_tr_b16 a[208:209], v11 offset:2304
    ds_read_b64_tr_b16 a[210:211], v11 offset:3584
    buffer_load_dwordx4 v163, s[28:31], s5 offen offset:3072  lds
    s_waitcnt lgkmcnt(10)
    v_mfma_f32_32x32x16_bf16 v[32:47], a[160:163], a[120:123], v[32:47]
    s_waitcnt vmcnt(8)
    s_barrier
    s_add_u32 m0, s60, 4096
    ds_read_b64_tr_b16 a[224:225], v9 offset:15360
    ds_read_b64_tr_b16 a[226:227], v9 offset:16640
    v_mfma_f32_32x32x16_bf16 v[48:63], a[164:167], a[120:123], v[48:63]
    ds_read_b64_tr_b16 a[228:229], v9 offset:15424
    ds_read_b64_tr_b16 a[230:231], v9 offset:16704
    ds_read_b128 a[128:131], v164 offset:0
    buffer_load_dwordx4 v7, s[36:39], s75 offen offset:0  lds
    v_mfma_f32_32x32x16_bf16 v[64:79], a[168:171], a[120:123], v[64:79]
    ds_read_b64_tr_b16 a[232:233], v9 offset:15488
    ds_read_b64_tr_b16 a[234:235], v9 offset:16768
    ds_read_b128 a[132:135], v165 offset:0
    v_mfma_f32_32x32x16_bf16 v[80:95], a[172:175], a[120:123], v[80:95]
    ds_read_b64_tr_b16 a[236:237], v9 offset:15552
    ds_read_b64_tr_b16 a[238:239], v9 offset:16832
    ds_read_b128 a[136:139], v166 offset:0
    buffer_load_dwordx4 v8, s[36:39], s75 offen offset:1024  lds
    v_mfma_f32_32x32x16_bf16 v[96:111], a[176:179], a[120:123], v[96:111]
    ds_read_b64_tr_b16 a[240:241], v9 offset:15616
    ds_read_b64_tr_b16 a[242:243], v9 offset:16896
    ds_read_b128 a[140:143], v167 offset:0
    s_waitcnt lgkmcnt(14)
    v_mfma_f32_32x32x16_bf16 v[32:47], a[192:195], a[124:127], v[32:47]
    ds_read_b64_tr_b16 a[160:161], v9 offset:56320
    ds_read_b64_tr_b16 a[162:163], v9 offset:57600
    buffer_load_dwordx4 v7, s[40:43], s75 offen offset:2048  lds
    v_mfma_f32_32x32x16_bf16 v[48:63], a[196:199], a[124:127], v[48:63]
    ds_read_b64_tr_b16 a[164:165], v9 offset:56384
    ds_read_b64_tr_b16 a[166:167], v9 offset:57664
    v_mfma_f32_32x32x16_bf16 v[64:79], a[200:203], a[124:127], v[64:79]
    ds_read_b64_tr_b16 a[168:169], v9 offset:56448
    ds_read_b64_tr_b16 a[170:171], v9 offset:57728
    buffer_load_dwordx4 v8, s[40:43], s75 offen offset:3072  lds
    v_mfma_f32_32x32x16_bf16 v[80:95], a[204:207], a[124:127], v[80:95]
    ds_read_b64_tr_b16 a[172:173], v9 offset:56512
    ds_read_b64_tr_b16 a[174:175], v9 offset:57792
    v_mfma_f32_32x32x16_bf16 v[96:111], a[208:211], a[124:127], v[96:111]
    ds_read_b64_tr_b16 a[176:177], v9 offset:56576
    ds_read_b64_tr_b16 a[178:179], v9 offset:57856
    s_waitcnt lgkmcnt(10)
    v_mfma_f32_32x32x16_bf16 v[32:47], a[224:227], a[128:131], v[32:47]
    ds_read_b64_tr_b16 a[192:193], v10 offset:31744
    ds_read_b64_tr_b16 a[194:195], v10 offset:33024
    buffer_load_dword v196, off, s[44:47], s91 offset:4 sc1
    v_mfma_f32_32x32x16_bf16 v[48:63], a[228:231], a[128:131], v[48:63]
    ds_read_b64_tr_b16 a[196:197], v10 offset:31808
    ds_read_b64_tr_b16 a[198:199], v10 offset:33088
    v_mfma_f32_32x32x16_bf16 v[64:79], a[232:235], a[128:131], v[64:79]
    ds_read_b64_tr_b16 a[200:201], v10 offset:31872
    ds_read_b64_tr_b16 a[202:203], v10 offset:33152
    v_mfma_f32_32x32x16_bf16 v[80:95], a[236:239], a[128:131], v[80:95]
    ds_read_b64_tr_b16 a[204:205], v10 offset:31936
    ds_read_b64_tr_b16 a[206:207], v10 offset:33216
    v_mfma_f32_32x32x16_bf16 v[96:111], a[240:243], a[128:131], v[96:111]
    ds_read_b64_tr_b16 a[208:209], v10 offset:32000
    ds_read_b64_tr_b16 a[210:211], v10 offset:33280
    s_waitcnt lgkmcnt(10)
    v_mfma_f32_32x32x16_bf16 v[32:47], a[160:163], a[132:135], v[32:47]
    ds_read_b64_tr_b16 a[224:225], v11 offset:7168
    ds_read_b64_tr_b16 a[226:227], v11 offset:8448
    v_mfma_f32_32x32x16_bf16 v[48:63], a[164:167], a[132:135], v[48:63]
    ds_read_b64_tr_b16 a[228:229], v11 offset:7232
    ds_read_b64_tr_b16 a[230:231], v11 offset:8512
    v_mfma_f32_32x32x16_bf16 v[64:79], a[168:171], a[132:135], v[64:79]
    ds_read_b64_tr_b16 a[232:233], v11 offset:7296
    ds_read_b64_tr_b16 a[234:235], v11 offset:8576
    v_mfma_f32_32x32x16_bf16 v[80:95], a[172:175], a[132:135], v[80:95]
    ds_read_b64_tr_b16 a[236:237], v11 offset:7360
    ds_read_b64_tr_b16 a[238:239], v11 offset:8640
    v_mfma_f32_32x32x16_bf16 v[96:111], a[176:179], a[132:135], v[96:111]
    ds_read_b64_tr_b16 a[240:241], v11 offset:7424
    ds_read_b64_tr_b16 a[242:243], v11 offset:8704
    s_waitcnt lgkmcnt(10)
    v_mfma_f32_32x32x16_bf16 v[32:47], a[192:195], a[136:139], v[32:47]
    s_waitcnt vmcnt(5)
    s_barrier
    s_add_u32 m0, s60, 8192
    ds_read_b64_tr_b16 a[160:161], v9 offset:20480
    ds_read_b64_tr_b16 a[162:163], v9 offset:21760
    buffer_load_dwordx4 v7, s[36:39], s76 offen offset:0  lds
    v_mfma_f32_32x32x16_bf16 v[48:63], a[196:199], a[136:139], v[48:63]
    ds_read_b64_tr_b16 a[164:165], v9 offset:20544
    ds_read_b64_tr_b16 a[166:167], v9 offset:21824
    ds_read_b128 a[144:147], v164 offset:4096
    s_sub_u32 s97, s89, 13926400
    s_andn2_b32 s97, s97, 0x1800
    s_add_u32 s97, s97, 13926400
    buffer_load_dword v31, off, s[44:47], s97 offset:0 sc1
    v_mfma_f32_32x32x16_bf16 v[64:79], a[200:203], a[136:139], v[64:79]
    ds_read_b64_tr_b16 a[168:169], v9 offset:20608
    ds_read_b64_tr_b16 a[170:171], v9 offset:21888
    ds_read_b128 a[148:151], v165 offset:4096
    buffer_load_dwordx4 v8, s[36:39], s76 offen offset:1024  lds
    v_mfma_f32_32x32x16_bf16 v[80:95], a[204:207], a[136:139], v[80:95]
    ds_read_b64_tr_b16 a[172:173], v9 offset:20672
    ds_read_b64_tr_b16 a[174:175], v9 offset:21952
    ds_read_b128 a[152:155], v166 offset:4096
    v_mfma_f32_32x32x16_bf16 v[96:111], a[208:211], a[136:139], v[96:111]
    ds_read_b64_tr_b16 a[176:177], v9 offset:20736
    ds_read_b64_tr_b16 a[178:179], v9 offset:22016
    ds_read_b128 a[156:159], v167 offset:4096
    buffer_load_dwordx4 v7, s[40:43], s76 offen offset:2048  lds
    s_waitcnt lgkmcnt(14)
    v_mfma_f32_32x32x16_bf16 v[32:47], a[224:227], a[140:143], v[32:47]
    ds_read_b64_tr_b16 a[192:193], v9 offset:61440
    ds_read_b64_tr_b16 a[194:195], v9 offset:62720
    s_waitcnt vmcnt(4)
    v_readfirstlane_b32 s98, v196
    s_cmp_ge_u32 s98, 2621440
    s_cbranch_scc0 SPIN45
RET45:
    buffer_load_dword v192, v30, s[44:47], s63 offen sc1
    v_mfma_f32_32x32x16_bf16 v[48:63], a[228:231], a[140:143], v[48:63]
    ds_read_b64_tr_b16 a[196:197], v9 offset:61504
    ds_read_b64_tr_b16 a[198:199], v9 offset:62784
    buffer_load_dwordx4 v8, s[40:43], s76 offen offset:3072  lds
    buffer_load_dword v212, v30, s[44:47], s62 offen offset:0 sc1
    v_mfma_f32_32x32x16_bf16 v[64:79], a[232:235], a[140:143], v[64:79]
    ds_read_b64_tr_b16 a[200:201], v9 offset:61568
    ds_read_b64_tr_b16 a[202:203], v9 offset:62848
    buffer_load_dword v216, v30, s[44:47], s62 offen offset:256 sc1
    buffer_load_dword v220, v30, s[44:47], s62 offen offset:512 sc1
    v_mfma_f32_32x32x16_bf16 v[80:95], a[236:239], a[140:143], v[80:95]
    ds_read_b64_tr_b16 a[204:205], v9 offset:61632
    ds_read_b64_tr_b16 a[206:207], v9 offset:62912
    v_mfma_f32_32x32x16_bf16 v[96:111], a[240:243], a[140:143], v[96:111]
    ds_read_b64_tr_b16 a[208:209], v9 offset:61696
    ds_read_b64_tr_b16 a[210:211], v9 offset:62976
    s_waitcnt lgkmcnt(10)
    v_mfma_f32_32x32x16_bf16 v[32:47], a[160:163], a[144:147], v[32:47]
    ds_read_b64_tr_b16 a[224:225], v10 offset:36864
    ds_read_b64_tr_b16 a[226:227], v10 offset:38144
    v_mfma_f32_32x32x16_bf16 v[48:63], a[164:167], a[144:147], v[48:63]
    ds_read_b64_tr_b16 a[228:229], v10 offset:36928
    ds_read_b64_tr_b16 a[230:231], v10 offset:38208
    v_mfma_f32_32x32x16_bf16 v[64:79], a[168:171], a[144:147], v[64:79]
    ds_read_b64_tr_b16 a[232:233], v10 offset:36992
    ds_read_b64_tr_b16 a[234:235], v10 offset:38272
    v_mfma_f32_32x32x16_bf16 v[80:95], a[172:175], a[144:147], v[80:95]
    ds_read_b64_tr_b16 a[236:237], v10 offset:37056
    ds_read_b64_tr_b16 a[238:239], v10 offset:38336
    v_mfma_f32_32x32x16_bf16 v[96:111], a[176:179], a[144:147], v[96:111]
    ds_read_b64_tr_b16 a[240:241], v10 offset:37120
    ds_read_b64_tr_b16 a[242:243], v10 offset:38400
    s_waitcnt lgkmcnt(10)
    v_mfma_f32_32x32x16_bf16 v[32:47], a[192:195], a[148:151], v[32:47]
    ds_read_b64_tr_b16 a[160:161], v11 offset:12288
    ds_read_b64_tr_b16 a[162:163], v11 offset:13568
    s_waitcnt vmcnt(7)
    v_readfirstlane_b32 s98, v31
    s_cmp_ge_u32 s98, 4456448
    s_cbranch_scc0 SPIN46
RET46:
    v_mfma_f32_32x32x16_bf16 v[48:63], a[196:199], a[148:151], v[48:63]
    ds_read_b64_tr_b16 a[164:165], v11 offset:12352
    ds_read_b64_tr_b16 a[166:167], v11 offset:13632
    buffer_load_dwordx4 a[180:183], v15, s[44:47], s8 offen offset:0 sc1
    v_mfma_f32_32x32x16_bf16 v[64:79], a[200:203], a[148:151], v[64:79]
    ds_read_b64_tr_b16 a[168:169], v11 offset:12416
    ds_read_b64_tr_b16 a[170:171], v11 offset:13696
    v_mfma_f32_32x32x16_bf16 v[80:95], a[204:207], a[148:151], v[80:95]
    ds_read_b64_tr_b16 a[172:173], v11 offset:12480
    ds_read_b64_tr_b16 a[174:175], v11 offset:13760
    buffer_load_dwordx4 a[184:187], v15, s[44:47], s8 offen offset:1024 sc1
    v_mfma_f32_32x32x16_bf16 v[96:111], a[208:211], a[148:151], v[96:111]
    ds_read_b64_tr_b16 a[176:177], v11 offset:12544
    ds_read_b64_tr_b16 a[178:179], v11 offset:13824
    v_mov_b32 v9, v169
    v_add_u32 v10, 65536, v169
    v_add_u32 v11, 131072, v169
    s_waitcnt lgkmcnt(10)
    v_mfma_f32_32x32x16_bf16 v[32:47], a[224:227], a[152:155], v[32:47]
    s_barrier
    s_add_u32 m0, s60, 12288
    ds_read_b64_tr_b16 a[192:193], v9 offset:0
    ds_read_b64_tr_b16 a[194:195], v9 offset:512
    buffer_load_dwordx4 v7, s[36:39], s77 offen offset:0  lds
    v_mfma_f32_32x32x16_bf16 v[48:63], a[228:231], a[152:155], v[48:63]
    ds_read_b64_tr_b16 a[196:197], v12 offset:0
    ds_read_b64_tr_b16 a[198:199], v12 offset:512
    v_mfma_f32_32x32x16_bf16 v[64:79], a[232:235], a[152:155], v[64:79]
    ds_read_b64_tr_b16 a[200:201], v9 offset:2048
    ds_read_b64_tr_b16 a[202:203], v9 offset:2560
    buffer_load_dwordx4 v8, s[36:39], s77 offen offset:1024  lds
    v_mfma_f32_32x32x16_bf16 v[80:95], a[236:239], a[152:155], v[80:95]
    ds_read_b64_tr_b16 a[204:205], v12 offset:2048
    ds_read_b64_tr_b16 a[206:207], v12 offset:2560
    v_mfma_f32_32x32x16_bf16 v[96:111], a[240:243], a[152:155], v[96:111]
    buffer_load_dwordx4 v7, s[40:43], s77 offen offset:2048  lds
    s_waitcnt lgkmcnt(8)
    v_mfma_f32_32x32x16_bf16 v[32:47], a[160:163], a[156:159], v[32:47]
    ds_read_b64_tr_b16 a[224:225], v9 offset:40960
    ds_read_b64_tr_b16 a[226:227], v9 offset:41472
    s_waitcnt vmcnt(5)
    v_mov_b32 v193, v192
    s_nop 1
    v_permlane32_swap_b32 v192, v193
    s_nop 1
    v_mfma_f32_32x32x16_bf16 v[48:63], a[164:167], a[156:159], v[48:63]
    ds_read_b64_tr_b16 a[228:229], v12 offset:40960
    ds_read_b64_tr_b16 a[230:231], v12 offset:41472
    buffer_load_dwordx4 v8, s[40:43], s77 offen offset:3072  lds
    v_mul_f32 v192, 0xbacccccd, v192
    v_mfma_f32_32x32x16_bf16 v[64:79], a[168:171], a[156:159], v[64:79]
    ds_read_b64_tr_b16 a[232:233], v9 offset:43008
    ds_read_b64_tr_b16 a[234:235], v9 offset:43520
    v_mul_f32 v193, 0x3acccccd, v193
    v_fma_f32 v193, -v192, v192, v193
    v_max_f32 v193, 0, v193
    v_add_f32 v193, 0x3727c5ac, v193
    v_mfma_f32_32x32x16_bf16 v[80:95], a[172:175], a[156:159], v[80:95]
    ds_read_b64_tr_b16 a[236:237], v12 offset:43008
    ds_read_b64_tr_b16 a[238:239], v12 offset:43520
    buffer_load_dwordx4 a[188:191], v15, s[44:47], s8 offen offset:2048 sc1
    v_rsq_f32 v18, v193
    v_mfma_f32_32x32x16_bf16 v[96:111], a[176:179], a[156:159], v[96:111]
    v_cvt_pk_bf16_f32 v194, v192, v192
    v_mul_f32 v193, v193, v18
    v_mul_f32 v193, 0x358637bd, v193
    v_lshlrev_b32 v195, 16, v194
    v_sub_f32 v195, v192, v195
    v_cvt_pk_bf16_f32 v195, v195, v193
    v_mul_f32 v19, 0x3fb8aa3b, v18
    v_mul_f32 v22, v18, v18
    v_and_b32 v20, 0xffff0000, v195
    v_mov_b32 v23, v22
    v_cmp_gt_u32 vcc, 32, v0
    v_mov_b32 v192, 0
    s_nop 0
    v_cndmask_b32 v24, v192, v194, vcc
    v_cndmask_b32 v25, v192, v195, vcc
    v_cndmask_b32 v26, v194, v192, vcc
    v_cndmask_b32 v27, v195, v192, vcc
    v_cvt_pk_bf16_f32 v215, v212, 1.0
    v_lshlrev_b32 v213, 16, v215
    v_sub_f32 v213, v212, v213
    v_cvt_pk_bf16_f32 v214, v212, v213
    v_cvt_pk_bf16_f32 v219, v216, v182
    v_lshlrev_b32 v217, 16, v219
    v_sub_f32 v217, v216, v217
    v_cvt_pk_bf16_f32 v218, v216, v217
    v_cvt_pk_bf16_f32 v223, v220, 0
    v_lshlrev_b32 v221, 16, v223
    v_sub_f32 v221, v220, v221
    v_cvt_pk_bf16_f32 v222, v220, v221
    v_mov_b32 v2, v176
    v_mov_b32 v3, v173
    v_mov_b32 v4, v174
    v_mov_b32 v5, v180
    v_mov_b32 v6, v177
    s_nop 1
    v_mfma_f32_32x32x8_bf16 v[32:47], v[214:215], v[24:25], v[32:47]
    v_mfma_f32_32x32x8_bf16 v[48:63], v[214:215], v[26:27], v[48:63]
    v_mfma_f32_32x32x8_bf16 v[64:79], v[218:219], v[24:25], v[64:79]
    v_mfma_f32_32x32x8_bf16 v[80:95], v[218:219], v[26:27], v[80:95]
    v_mfma_f32_32x32x8_bf16 v[96:111], v[222:223], v[24:25], v[96:111]
    v_mov_b32 v28, 0x3f803f80
    v_mov_b32 v29, 0x3f803f80
    v_mov_b32 v222, v18
    v_mov_b32 v223, v18
    ds_write_b64 v6, v[28:29]
    s_mul_i32 s7, s3, 1792
    s_add_u32 s95, s95, s7
    v_mov_b32 v220, v19
    v_mov_b32 v221, v19
    s_nop 3
    v_pk_mul_f32 v[212:213], v[32:33], v[220:221]
    v_pk_mul_f32 v[214:215], v[34:35], v[220:221]
    v_pk_mul_f32 v[216:217], v[36:37], v[220:221]
    v_pk_mul_f32 v[218:219], v[38:39], v[220:221]
    v_exp_f32_e64 v212, v212 clamp
    v_max_f32 v32, v20, v32
    v_exp_f32_e64 v213, v213 clamp
    v_max_f32 v33, v20, v33
    v_exp_f32_e64 v214, v214 clamp
    v_max_f32 v34, v20, v34
    v_exp_f32_e64 v215, v215 clamp
    v_max_f32 v35, v20, v35
    v_exp_f32_e64 v216, v216 clamp
    v_max_f32 v36, v20, v36
    v_exp_f32_e64 v217, v217 clamp
    v_max_f32 v37, v20, v37
    v_exp_f32_e64 v218, v218 clamp
    v_max_f32 v38, v20, v38
    v_exp_f32_e64 v219, v219 clamp
    v_max_f32 v39, v20, v39
    v_pk_fma_f32 v[32:33], v[32:33], v[222:223], v[212:213]
    v_pk_fma_f32 v[34:35], v[34:35], v[222:223], v[214:215]
    v_pk_fma_f32 v[36:37], v[36:37], v[222:223], v[216:217]
    v_pk_fma_f32 v[38:39], v[38:39], v[222:223], v[218:219]
    v_cvt_pk_bf16_f32 v32, v32, v33
    v_cvt_pk_bf16_f32 v33, v34, v35
    v_cvt_pk_bf16_f32 v34, v36, v37
    v_cvt_pk_bf16_f32 v35, v38, v39
    ds_write_b128 v2, v[32:35] offset:0
    buffer_load_dwordx4 a[212:215], v15, s[44:47], s8 offen offset:3072 sc1
    buffer_load_dwordx4 a[216:219], v16, s[44:47], s8 offen offset:0 sc1
    buffer_load_dwordx4 a[220:223], v15, s[44:47], s9 offen offset:0 sc1
    v_pk_mul_f32 v[72:73], v[72:73], v[222:223]
    v_pk_mul_f32 v[74:75], v[74:75], v[222:223]
    v_pk_mul_f32 v[76:77], v[76:77], v[222:223]
    v_pk_mul_f32 v[78:79], v[78:79], v[222:223]
    v_cvt_pk_bf16_f32 v72, v72, v73
    v_cvt_pk_bf16_f32 v73, v74, v75
    v_cvt_pk_bf16_f32 v74, v76, v77
    v_cvt_pk_bf16_f32 v75, v78, v79
    ds_write_b128 v2, v[72:75] offset:160
    buffer_load_dwordx4 a[244:247], v15, s[44:47], s9 offen offset:1024 sc1
    v_pk_mul_f32 v[212:213], v[40:41], v[220:221]
    v_pk_mul_f32 v[214:215], v[42:43], v[220:221]
    v_pk_mul_f32 v[216:217], v[44:45], v[220:221]
    v_pk_mul_f32 v[218:219], v[46:47], v[220:221]
    v_exp_f32_e64 v212, v212 clamp
    v_max_f32 v40, v20, v40
    v_exp_f32_e64 v213, v213 clamp
    v_max_f32 v41, v20, v41
    v_exp_f32_e64 v214, v214 clamp
    v_max_f32 v42, v20, v42
    v_exp_f32_e64 v215, v215 clamp
    v_max_f32 v43, v20, v43
    v_exp_f32_e64 v216, v216 clamp
    v_max_f32 v44, v20, v44
    v_exp_f32_e64 v217, v217 clamp
    v_max_f32 v45, v20, v45
    v_exp_f32_e64 v218, v218 clamp
    v_max_f32 v46, v20, v46
    v_exp_f32_e64 v219, v219 clamp
    v_max_f32 v47, v20, v47
    v_pk_fma_f32 v[40:41], v[40:41], v[222:223], v[212:213]
    v_pk_fma_f32 v[42:43], v[42:43], v[222:223], v[214:215]
    v_pk_fma_f32 v[44:45], v[44:45], v[222:223], v[216:217]
    v_pk_fma_f32 v[46:47], v[46:47], v[222:223], v[218:219]
    v_cvt_pk_bf16_f32 v40, v40, v41
    v_cvt_pk_bf16_f32 v41, v42, v43
    v_cvt_pk_bf16_f32 v42, v44, v45
    v_cvt_pk_bf16_f32 v43, v46, v47
    ds_write_b128 v2, v[40:43] offset:32
    buffer_load_dwordx4 a[248:251], v15, s[44:47], s9 offen offset:2048 sc1
    buffer_load_dwordx4 a[252:255], v15, s[44:47], s9 offen offset:3072 sc1
    buffer_load_dwordx4 v[112:115], v16, s[44:47], s9 offen offset:0 sc1
    v_pk_mul_f32 v[80:81], v[80:81], v[222:223]
    v_pk_mul_f32 v[82:83], v[82:83], v[222:223]
    v_pk_mul_f32 v[84:85], v[84:85], v[222:223]
    v_pk_mul_f32 v[86:87], v[86:87], v[222:223]
    v_cvt_pk_bf16_f32 v80, v80, v81
    v_cvt_pk_bf16_f32 v81, v82, v83
    v_cvt_pk_bf16_f32 v82, v84, v85
    v_cvt_pk_bf16_f32 v83, v86, v87
    ds_write_b128 v2, v[80:83] offset:192
    buffer_load_dwordx4 v[116:119], v15, s[44:47], s10 offen offset:0 sc1
    v_pk_mul_f32 v[212:213], v[48:49], v[220:221]
    v_pk_mul_f32 v[214:215], v[50:51], v[220:221]
    v_pk_mul_f32 v[216:217], v[52:53], v[220:221]
    v_pk_mul_f32 v[218:219], v[54:55], v[220:221]
    v_exp_f32_e64 v212, v212 clamp
    v_max_f32 v48, v20, v48
    v_exp_f32_e64 v213, v213 clamp
    v_max_f32 v49, v20, v49
    v_exp_f32_e64 v214, v214 clamp
    v_max_f32 v50, v20, v50
    v_exp_f32_e64 v215, v215 clamp
    v_max_f32 v51, v20, v51
    v_exp_f32_e64 v216, v216 clamp
    v_max_f32 v52, v20, v52
    v_exp_f32_e64 v217, v217 clamp
    v_max_f32 v53, v20, v53
    v_exp_f32_e64 v218, v218 clamp
    v_max_f32 v54, v20, v54
    v_exp_f32_e64 v219, v219 clamp
    v_max_f32 v55, v20, v55
    v_pk_fma_f32 v[48:49], v[48:49], v[222:223], v[212:213]
    v_pk_fma_f32 v[50:51], v[50:51], v[222:223], v[214:215]
    v_pk_fma_f32 v[52:53], v[52:53], v[222:223], v[216:217]
    v_pk_fma_f32 v[54:55], v[54:55], v[222:223], v[218:219]
    v_cvt_pk_bf16_f32 v48, v48, v49
    v_cvt_pk_bf16_f32 v49, v50, v51
    v_cvt_pk_bf16_f32 v50, v52, v53
    v_cvt_pk_bf16_f32 v51, v54, v55
    ds_write_b128 v2, v[48:51] offset:64
    buffer_load_dwordx4 v[120:123], v15, s[44:47], s10 offen offset:1024 sc1
    buffer_load_dwordx4 v[124:127], v15, s[44:47], s10 offen offset:2048 sc1
    buffer_load_dwordx4 v[128:131], v15, s[44:47], s10 offen offset:3072 sc1
    v_pk_mul_f32 v[88:89], v[88:89], v[222:223]
    v_pk_mul_f32 v[90:91], v[90:91], v[222:223]
    v_pk_mul_f32 v[92:93], v[92:93], v[222:223]
    v_pk_mul_f32 v[94:95], v[94:95], v[222:223]
    v_cvt_pk_bf16_f32 v88, v88, v89
    v_cvt_pk_bf16_f32 v89, v90, v91
    v_cvt_pk_bf16_f32 v90, v92, v93
    v_cvt_pk_bf16_f32 v91, v94, v95
    ds_write_b128 v2, v[88:91] offset:224
    buffer_load_dwordx4 v[132:135], v16, s[44:47], s10 offen offset:0 sc1
    v_pk_mul_f32 v[212:213], v[56:57], v[220:221]
    v_pk_mul_f32 v[214:215], v[58:59], v[220:221]
    v_pk_mul_f32 v[216:217], v[60:61], v[220:221]
    v_pk_mul_f32 v[218:219], v[62:63], v[220:221]
    v_exp_f32_e64 v212, v212 clamp
    v_max_f32 v56, v20, v56
    v_exp_f32_e64 v213, v213 clamp
    v_max_f32 v57, v20, v57
    v_exp_f32_e64 v214, v214 clamp
    v_max_f32 v58, v20, v58
    v_exp_f32_e64 v215, v215 clamp
    v_max_f32 v59, v20, v59
    v_exp_f32_e64 v216, v216 clamp
    v_max_f32 v60, v20, v60
    v_exp_f32_e64 v217, v217 clamp
    v_max_f32 v61, v20, v61
    v_exp_f32_e64 v218, v218 clamp
    v_max_f32 v62, v20, v62
    v_exp_f32_e64 v219, v219 clamp
    v_max_f32 v63, v20, v63
    v_pk_fma_f32 v[56:57], v[56:57], v[222:223], v[212:213]
    v_pk_fma_f32 v[58:59], v[58:59], v[222:223], v[214:215]
    v_pk_fma_f32 v[60:61], v[60:61], v[222:223], v[216:217]
    v_pk_fma_f32 v[62:63], v[62:63], v[222:223], v[218:219]
    v_cvt_pk_bf16_f32 v56, v56, v57
    v_cvt_pk_bf16_f32 v57, v58, v59
    v_cvt_pk_bf16_f32 v58, v60, v61
    v_cvt_pk_bf16_f32 v59, v62, v63
    ds_write_b128 v2, v[56:59] offset:96
    buffer_load_dwordx4 v[136:139], v15, s[44:47], s11 offen offset:0 sc1
    buffer_load_dwordx4 v[140:143], v15, s[44:47], s11 offen offset:1024 sc1
    buffer_load_dwordx4 v[228:231], v15, s[44:47], s11 offen offset:2048 sc1
    v_pk_mul_f32 v[96:97], v[96:97], v[222:223]
    v_pk_mul_f32 v[98:99], v[98:99], v[222:223]
    v_pk_mul_f32 v[100:101], v[100:101], v[222:223]
    v_pk_mul_f32 v[102:103], v[102:103], v[222:223]
    v_cvt_pk_bf16_f32 v96, v96, v97
    v_cvt_pk_bf16_f32 v97, v98, v99
    v_cvt_pk_bf16_f32 v98, v100, v101
    v_cvt_pk_bf16_f32 v99, v102, v103
    ds_write_b128 v2, v[96:99] offset:256
    buffer_load_dwordx4 v[232:235], v15, s[44:47], s11 offen offset:3072 sc1
    v_pk_mul_f32 v[212:213], v[64:65], v[220:221]
    v_pk_mul_f32 v[214:215], v[66:67], v[220:221]
    v_pk_mul_f32 v[216:217], v[68:69], v[220:221]
    v_pk_mul_f32 v[218:219], v[70:71], v[220:221]
    v_exp_f32_e64 v212, v212 clamp
    v_max_f32 v64, v20, v64
    v_exp_f32_e64 v213, v213 clamp
    v_max_f32 v65, v20, v65
    v_exp_f32_e64 v214, v214 clamp
    v_max_f32 v66, v20, v66
    v_exp_f32_e64 v215, v215 clamp
    v_max_f32 v67, v20, v67
    v_exp_f32_e64 v216, v216 clamp
    v_max_f32 v68, v20, v68
    v_exp_f32_e64 v217, v217 clamp
    v_max_f32 v69, v20, v69
    v_exp_f32_e64 v218, v218 clamp
    v_max_f32 v70, v20, v70
    v_exp_f32_e64 v219, v219 clamp
    v_max_f32 v71, v20, v71
    v_pk_fma_f32 v[64:65], v[64:65], v[222:223], v[212:213]
    v_pk_fma_f32 v[66:67], v[66:67], v[222:223], v[214:215]
    v_pk_fma_f32 v[68:69], v[68:69], v[222:223], v[216:217]
    v_pk_fma_f32 v[70:71], v[70:71], v[222:223], v[218:219]
    v_cvt_pk_bf16_f32 v64, v64, v65
    v_cvt_pk_bf16_f32 v65, v66, v67
    v_cvt_pk_bf16_f32 v66, v68, v69
    v_cvt_pk_bf16_f32 v67, v70, v71
    ds_write_b128 v2, v[64:67] offset:128
    buffer_load_dwordx4 v[236:239], v16, s[44:47], s11 offen offset:0 sc1
    buffer_load_dwordx4 v[240:243], v15, s[44:47], s12 offen offset:0 sc1
    buffer_load_dwordx4 v[244:247], v15, s[44:47], s12 offen offset:1024 sc1
    v_pk_mul_f32 v[104:105], v[104:105], v[222:223]
    v_pk_mul_f32 v[106:107], v[106:107], v[222:223]
    v_pk_mul_f32 v[108:109], v[108:109], v[222:223]
    v_pk_mul_f32 v[110:111], v[110:111], v[222:223]
    v_cvt_pk_bf16_f32 v104, v104, v105
    v_cvt_pk_bf16_f32 v105, v106, v107
    v_cvt_pk_bf16_f32 v106, v108, v109
    v_cvt_pk_bf16_f32 v107, v110, v111
    ds_write_b128 v2, v[104:107] offset:288
    buffer_load_dwordx4 v[248:251], v15, s[44:47], s12 offen offset:2048 sc1
    s_waitcnt lgkmcnt(0)
    s_barrier
    v_mfma_f32_32x32x16_bf16 v[144:159], a[192:195], a[0:3], 0
    ds_read_b64_tr_b16 a[160:161], v10 offset:16384
    ds_read_b64_tr_b16 a[162:163], v10 offset:16896
    ds_read_b64_tr_b16 v[48:49], v3 offset:0
    ds_read_b64_tr_b16 v[50:51], v3 offset:1344
    ds_read_b64_tr_b16 v[52:53], v4 offset:0
    ds_read_b64_tr_b16 v[54:55], v4 offset:1344
    ds_read_b64_tr_b16 v[56:57], v3 offset:5376
    v_mfma_f32_32x32x16_bf16 v[160:175], a[196:199], a[0:3], 0
    ds_read_b64_tr_b16 a[164:165], v13 offset:16384
    ds_read_b64_tr_b16 a[166:167], v13 offset:16896
    buffer_load_dwordx4 v[252:255], v15, s[44:47], s12 offen offset:3072 sc1
    ds_read_b64_tr_b16 v[58:59], v3 offset:6720
    ds_read_b64_tr_b16 v[60:61], v4 offset:5376
    v_mfma_f32_32x32x16_bf16 v[176:191], a[200:203], a[0:3], 0
    ds_read_b64_tr_b16 a[168:169], v10 offset:18432
    ds_read_b64_tr_b16 a[170:171], v10 offset:18944
    ds_read_b64_tr_b16 v[62:63], v4 offset:6720
    ds_read_b64_tr_b16 v[64:65], v3 offset:40960
    ds_read_b64_tr_b16 v[66:67], v3 offset:42304
    ds_read_b64_tr_b16 v[68:69], v4 offset:40960
    ds_read_b64_tr_b16 v[70:71], v4 offset:42304
    v_mfma_f32_32x32x16_bf16 v[192:207], a[204:207], a[0:3], 0
    ds_read_b64_tr_b16 a[172:173], v13 offset:18432
    ds_read_b64_tr_b16 a[174:175], v13 offset:18944
    ds_read_b64_tr_b16 v[72:73], v3 offset:46336
    ds_read_b64_tr_b16 v[74:75], v3 offset:47680
    ds_read_b64_tr_b16 v[76:77], v4 offset:46336
    ds_read_b64_tr_b16 v[78:79], v4 offset:47680
    v_mfma_f32_32x32x16_bf16 v[144:159], a[224:227], a[4:7], v[144:159]
    ds_read_b64_tr_b16 a[192:193], v10 offset:57344
    ds_read_b64_tr_b16 a[194:195], v10 offset:57856
    buffer_load_dwordx4 a[176:179], v16, s[44:47], s12 offen offset:0 sc1
    v_add_u32 v3, 81920, v3
    v_add_u32 v4, 81920, v4
    v_mfma_f32_32x32x16_bf16 v[160:175], a[228:231], a[4:7], v[160:175]
    ds_read_b64_tr_b16 a[196:197], v13 offset:57344
    ds_read_b64_tr_b16 a[198:199], v13 offset:57856
    ds_read_b64_tr_b16 v[80:81], v3 offset:0
    ds_read_b64_tr_b16 v[82:83], v3 offset:1344
    ds_read_b64_tr_b16 v[84:85], v4 offset:0
    ds_read_b64_tr_b16 v[86:87], v4 offset:1344
    ds_read_b64_tr_b16 v[88:89], v3 offset:5376
    v_mfma_f32_32x32x16_bf16 v[176:191], a[232:235], a[4:7], v[176:191]
    ds_read_b64_tr_b16 a[200:201], v10 offset:59392
    ds_read_b64_tr_b16 a[202:203], v10 offset:59904
    ds_read_b64_tr_b16 v[90:91], v3 offset:6720
    ds_read_b64_tr_b16 v[92:93], v4 offset:5376
    ds_read_b64_tr_b16 v[94:95], v4 offset:6720
    ds_read_b64_tr_b16 v[96:97], v3 offset:40960
    ds_read_b64_tr_b16 v[98:99], v3 offset:42304
    v_mfma_f32_32x32x16_bf16 v[192:207], a[236:239], a[4:7], v[192:207]
    ds_read_b64_tr_b16 a[204:205], v13 offset:59392
    ds_read_b64_tr_b16 a[206:207], v13 offset:59904
    buffer_load_dwordx4 a[208:211], v15, s[44:47], s13 offen offset:0 sc1
    ds_read_b64_tr_b16 v[100:101], v4 offset:40960
    s_waitcnt lgkmcnt(15)
    v_mfma_f32_32x32x16_bf16 v[144:159], a[160:163], a[8:11], v[144:159]
    s_barrier
    s_add_u32 m0, s60, 16384
    ds_read_b64_tr_b16 a[224:225], v9 offset:4096
    ds_read_b64_tr_b16 a[226:227], v9 offset:4608
    buffer_load_dwordx4 v7, s[36:39], s78 offen offset:0  lds
    v_mfma_f32_32x32x16_bf16 v[160:175], a[164:167], a[8:11], v[160:175]
    ds_read_b64_tr_b16 a[228:229], v12 offset:4096
    ds_read_b64_tr_b16 a[230:231], v12 offset:4608
    buffer_load_dword v212, v30, s[44:47], s62 offen offset:1024 sc1
    ds_read_b64_tr_b16 v[102:103], v4 offset:42304
    ds_read_b64_tr_b16 v[104:105], v3 offset:46336
    v_mfma_f32_32x32x16_bf16 v[176:191], a[168:171], a[8:11], v[176:191]
    ds_read_b64_tr_b16 a[232:233], v9 offset:6144
    ds_read_b64_tr_b16 a[234:235], v9 offset:6656
    buffer_load_dwordx4 v8, s[36:39], s78 offen offset:1024  lds
    ds_read_b64_tr_b16 v[106:107], v3 offset:47680
    ds_read_b64_tr_b16 v[108:109], v4 offset:46336
    v_mfma_f32_32x32x16_bf16 v[192:207], a[172:175], a[8:11], v[192:207]
    ds_read_b64_tr_b16 a[236:237], v12 offset:6144
    ds_read_b64_tr_b16 a[238:239], v12 offset:6656
    buffer_load_dword v216, v30, s[44:47], s62 offen offset:1280 sc1
    ds_read_b64_tr_b16 v[110:111], v4 offset:47680
    s_waitcnt lgkmcnt(14)
    v_mfma_f32_32x32x16_bf16 v[144:159], a[192:195], a[12:15], v[144:159]
    ds_read_b64_tr_b16 a[160:161], v9 offset:45056
    ds_read_b64_tr_b16 a[162:163], v9 offset:45568
    buffer_load_dwordx4 v7, s[40:43], s78 offen offset:2048  lds
    v_add_u32 v4, s60, v30
    v_mfma_f32_32x32x16_bf16 v[32:47], v[48:51], v[52:55], 0
    v_mfma_f32_32x32x16_bf16 v[32:47], v[56:59], v[60:63], v[32:47]
    v_mfma_f32_32x32x16_bf16 v[160:175], a[196:199], a[12:15], v[160:175]
    ds_read_b64_tr_b16 a[164:165], v12 offset:45056
    ds_read_b64_tr_b16 a[166:167], v12 offset:45568
    v_mfma_f32_32x32x16_bf16 v[32:47], v[64:67], v[68:71], v[32:47]
    v_mfma_f32_32x32x16_bf16 v[32:47], v[72:75], v[76:79], v[32:47]
    v_mfma_f32_32x32x16_bf16 v[176:191], a[200:203], a[12:15], v[176:191]
    ds_read_b64_tr_b16 a[168:169], v9 offset:47104
    ds_read_b64_tr_b16 a[170:171], v9 offset:47616
    buffer_load_dwordx4 v8, s[40:43], s78 offen offset:3072  lds
    v_mfma_f32_32x32x16_bf16 v[32:47], v[80:83], v[84:87], v[32:47]
    v_mfma_f32_32x32x16_bf16 v[32:47], v[88:91], v[92:95], v[32:47]
    v_mfma_f32_32x32x16_bf16 v[192:207], a[204:207], a[12:15], v[192:207]
    ds_read_b64_tr_b16 a[172:173], v12 offset:47104
    ds_read_b64_tr_b16 a[174:175], v12 offset:47616
    s_waitcnt lgkmcnt(15)
    v_mfma_f32_32x32x16_bf16 v[32:47], v[96:99], v[100:103], v[32:47]
    s_waitcnt lgkmcnt(8)
    v_mfma_f32_32x32x16_bf16 v[32:47], v[104:107], v[108:111], v[32:47]
    v_mfma_f32_32x32x16_bf16 v[144:159], a[224:227], a[16:19], v[144:159]
    ds_read_b64_tr_b16 a[192:193], v10 offset:20480
    ds_read_b64_tr_b16 a[194:195], v10 offset:20992
    v_mfma_f32_32x32x16_bf16 v[160:175], a[228:231], a[16:19], v[160:175]
    ds_read_b64_tr_b16 a[196:197], v13 offset:20480
    ds_read_b64_tr_b16 a[198:199], v13 offset:20992
    buffer_load_dwordx4 a[240:243], v15, s[44:47], s13 offen offset:1024 sc1
    v_mfma_f32_32x32x16_bf16 v[176:191], a[232:235], a[16:19], v[176:191]
    ds_read_b64_tr_b16 a[200:201], v10 offset:22528
    ds_read_b64_tr_b16 a[202:203], v10 offset:23040
    v_mfma_f32_32x32x16_bf16 v[192:207], a[236:239], a[16:19], v[192:207]
    ds_read_b64_tr_b16 a[204:205], v13 offset:22528
    ds_read_b64_tr_b16 a[206:207], v13 offset:23040
    s_waitcnt lgkmcnt(8)
    v_mfma_f32_32x32x16_bf16 v[144:159], a[160:163], a[20:23], v[144:159]
    ds_read_b64_tr_b16 a[224:225], v10 offset:61440
    ds_read_b64_tr_b16 a[226:227], v10 offset:61952
    buffer_load_dwordx4 a[0:3], v15, s[44:47], s13 offen offset:2048 sc1
    ds_write_b128 v5, v[32:35] offset:0
    v_mfma_f32_32x32x16_bf16 v[160:175], a[164:167], a[20:23], v[160:175]
    ds_read_b64_tr_b16 a[228:229], v13 offset:61440
    ds_read_b64_tr_b16 a[230:231], v13 offset:61952
    ds_write_b128 v5, v[36:39] offset:672
    v_mfma_f32_32x32x16_bf16 v[176:191], a[168:171], a[20:23], v[176:191]
    ds_read_b64_tr_b16 a[232:233], v10 offset:63488
    ds_read_b64_tr_b16 a[234:235], v10 offset:64000
    ds_write_b128 v5, v[40:43] offset:1344
    v_mfma_f32_32x32x16_bf16 v[192:207], a[172:175], a[20:23], v[192:207]
    ds_read_b64_tr_b16 a[236:237], v13 offset:63488
    ds_read_b64_tr_b16 a[238:239], v13 offset:64000
    buffer_load_dwordx4 a[4:7], v15, s[44:47], s13 offen offset:3072 sc1
    ds_read_b32 v48, v4 offset:36864
    s_waitcnt lgkmcnt(12)
    v_mfma_f32_32x32x16_bf16 v[144:159], a[192:195], a[24:27], v[144:159]
    s_barrier
    s_add_u32 m0, s60, 0
    ds_read_b64_tr_b16 a[160:161], v9 offset:8192
    ds_read_b64_tr_b16 a[162:163], v9 offset:8704
    buffer_load_dwordx4 v7, s[36:39], s79 offen offset:0  lds
    v_mfma_f32_32x32x16_bf16 v[160:175], a[196:199], a[24:27], v[160:175]
    ds_read_b64_tr_b16 a[164:165], v12 offset:8192
    ds_read_b64_tr_b16 a[166:167], v12 offset:8704
    ds_read_b32 v49, v4 offset:37120
    ds_read_b32 v50, v4 offset:37376
    ds_read_b32 v51, v4 offset:37632
    ds_read_b32 v52, v4 offset:37888
    ds_read_b32 v53, v4 offset:38144
    v_mfma_f32_32x32x16_bf16 v[176:191], a[200:203], a[24:27], v[176:191]
    ds_read_b64_tr_b16 a[168:169], v9 offset:10240
    ds_read_b64_tr_b16 a[170:171], v9 offset:10752
    buffer_load_dwordx4 v8, s[36:39], s79 offen offset:1024  lds
    ds_read_b32 v54, v4 offset:38400
    v_mfma_f32_32x32x16_bf16 v[192:207], a[204:207], a[24:27], v[192:207]
    ds_read_b64_tr_b16 a[172:173], v12 offset:10240
    ds_read_b64_tr_b16 a[174:175], v12 offset:10752
    s_waitcnt lgkmcnt(15)
    v_mfma_f32_32x32x16_bf16 v[144:159], a[224:227], a[28:31], v[144:159]
    ds_read_b64_tr_b16 a[192:193], v9 offset:49152
    ds_read_b64_tr_b16 a[194:195], v9 offset:49664
    buffer_load_dwordx4 v7, s[40:43], s79 offen offset:2048  lds
    v_mfma_f32_32x32x16_bf16 v[160:175], a[228:231], a[28:31], v[160:175]
    ds_read_b64_tr_b16 a[196:197], v12 offset:49152
    ds_read_b64_tr_b16 a[198:199], v12 offset:49664
    v_mfma_f32_32x32x16_bf16 v[176:191], a[232:235], a[28:31], v[176:191]
    ds_read_b64_tr_b16 a[200:201], v9 offset:51200
    ds_read_b64_tr_b16 a[202:203], v9 offset:51712
    buffer_load_dwordx4 v8, s[40:43], s79 offen offset:3072  lds
    s_waitcnt lgkmcnt(8)
    buffer_atomic_add_f32 v48, v30, s[44:47], s95 offen offset:0
    v_mfma_f32_32x32x16_bf16 v[192:207], a[236:239], a[28:31], v[192:207]
    ds_read_b64_tr_b16 a[204:205], v12 offset:51200
    ds_read_b64_tr_b16 a[206:207], v12 offset:51712
    s_waitcnt lgkmcnt(8)
    v_mfma_f32_32x32x16_bf16 v[144:159], a[160:163], a[32:35], v[144:159]
    ds_read_b64_tr_b16 a[224:225], v10 offset:24576
    ds_read_b64_tr_b16 a[226:227], v10 offset:25088
    buffer_atomic_add_f32 v49, v30, s[44:47], s95 offen offset:256
    v_mfma_f32_32x32x16_bf16 v[160:175], a[164:167], a[32:35], v[160:175]
    ds_read_b64_tr_b16 a[228:229], v13 offset:24576
    ds_read_b64_tr_b16 a[230:231], v13 offset:25088
    buffer_load_dwordx4 a[8:11], v16, s[44:47], s13 offen offset:0 sc1
    buffer_atomic_add_f32 v50, v30, s[44:47], s95 offen offset:512
    v_mfma_f32_32x32x16_bf16 v[176:191], a[168:171], a[32:35], v[176:191]
    ds_read_b64_tr_b16 a[232:233], v10 offset:26624
    ds_read_b64_tr_b16 a[234:235], v10 offset:27136
    v_mfma_f32_32x32x16_bf16 v[192:207], a[172:175], a[32:35], v[192:207]
    ds_read_b64_tr_b16 a[236:237], v13 offset:26624
    ds_read_b64_tr_b16 a[238:239], v13 offset:27136
    buffer_atomic_add_f32 v51, v30, s[44:47], s95 offen offset:768
    s_waitcnt lgkmcnt(8)
    v_mfma_f32_32x32x16_bf16 v[144:159], a[192:195], a[36:39], v[144:159]
    ds_read_b64_tr_b16 a[160:161], v11 offset:0
    ds_read_b64_tr_b16 a[162:163], v11 offset:512
    buffer_load_dwordx4 a[12:15], v15, s[44:47], s14 offen offset:0 sc1
    buffer_atomic_add_f32 v52, v30, s[44:47], s95 offen offset:1024
    v_mfma_f32_32x32x16_bf16 v[160:175], a[196:199], a[36:39], v[160:175]
    ds_read_b64_tr_b16 a[164:165], v14 offset:0
    ds_read_b64_tr_b16 a[166:167], v14 offset:512
    v_mfma_f32_32x32x16_bf16 v[176:191], a[200:203], a[36:39], v[176:191]
    ds_read_b64_tr_b16 a[168:169], v11 offset:2048
    ds_read_b64_tr_b16 a[170:171], v11 offset:2560
    buffer_atomic_add_f32 v53, v30, s[44:47], s95 offen offset:1280
    v_mfma_f32_32x32x16_bf16 v[192:207], a[204:207], a[36:39], v[192:207]
    ds_read_b64_tr_b16 a[172:173], v14 offset:2048
    ds_read_b64_tr_b16 a[174:175], v14 offset:2560
    buffer_load_dwordx4 a[16:19], v15, s[44:47], s14 offen offset:1024 sc1
    buffer_atomic_add_f32 v54, v30, s[44:47], s95 offen offset:1536
    s_waitcnt lgkmcnt(8)
    v_mfma_f32_32x32x16_bf16 v[144:159], a[224:227], a[40:43], v[144:159]
    s_waitcnt vmcnt(47)
    s_barrier
    s_add_u32 m0, s60, 4096
    ds_read_b64_tr_b16 a[192:193], v9 offset:12288
    ds_read_b64_tr_b16 a[194:195], v9 offset:12800
    buffer_load_dwordx4 v7, s[36:39], s80 offen offset:0  lds
    v_mfma_f32_32x32x16_bf16 v[160:175], a[228:231], a[40:43], v[160:175]
    ds_read_b64_tr_b16 a[196:197], v12 offset:12288
    ds_read_b64_tr_b16 a[198:199], v12 offset:12800
    v_mfma_f32_32x32x16_bf16 v[176:191], a[232:235], a[40:43], v[176:191]
    ds_read_b64_tr_b16 a[200:201], v9 offset:14336
    ds_read_b64_tr_b16 a[202:203], v9 offset:14848
    buffer_load_dwordx4 v8, s[36:39], s80 offen offset:1024  lds
    v_mfma_f32_32x32x16_bf16 v[192:207], a[236:239], a[40:43], v[192:207]
    ds_read_b64_tr_b16 a[204:205], v12 offset:14336
    ds_read_b64_tr_b16 a[206:207], v12 offset:14848
    s_waitcnt lgkmcnt(8)
    v_mfma_f32_32x32x16_bf16 v[144:159], a[160:163], a[44:47], v[144:159]
    ds_read_b64_tr_b16 a[224:225], v9 offset:53248
    ds_read_b64_tr_b16 a[226:227], v9 offset:53760
    buffer_load_dwordx4 v7, s[40:43], s80 offen offset:2048  lds
    v_mfma_f32_32x32x16_bf16 v[160:175], a[164:167], a[44:47], v[160:175]
    ds_read_b64_tr_b16 a[228:229], v12 offset:53248
    ds_read_b64_tr_b16 a[230:231], v12 offset:53760
    v_mfma_f32_32x32x16_bf16 v[176:191], a[168:171], a[44:47], v[176:191]
    ds_read_b64_tr_b16 a[232:233], v9 offset:55296
    ds_read_b64_tr_b16 a[234:235], v9 offset:55808
    buffer_load_dwordx4 v8, s[40:43], s80 offen offset:3072  lds
    v_mfma_f32_32x32x16_bf16 v[192:207], a[172:175], a[44:47], v[192:207]
    ds_read_b64_tr_b16 a[236:237], v12 offset:55296
    ds_read_b64_tr_b16 a[238:239], v12 offset:55808
    s_waitcnt lgkmcnt(8)
    v_mfma_f32_32x32x16_bf16 v[144:159], a[192:195], a[48:51], v[144:159]
    ds_read_b64_tr_b16 a[160:161], v10 offset:28672
    ds_read_b64_tr_b16 a[162:163], v10 offset:29184
    s_waitcnt vmcnt(23)
    v_cvt_pk_bf16_f32 v215, v212, 0
    v_lshlrev_b32 v213, 16, v215
    v_mfma_f32_32x32x16_bf16 v[160:175], a[196:199], a[48:51], v[160:175]
    ds_read_b64_tr_b16 a[164:165], v13 offset:28672
    ds_read_b64_tr_b16 a[166:167], v13 offset:29184
    v_sub_f32 v213, v212, v213
    v_cvt_pk_bf16_f32 v214, v212, v213
    v_cvt_pk_bf16_f32 v219, v216, 0
    v_mfma_f32_32x32x16_bf16 v[176:191], a[200:203], a[48:51], v[176:191]
    ds_read_b64_tr_b16 a[168:169], v10 offset:30720
    ds_read_b64_tr_b16 a[170:171], v10 offset:31232
    v_lshlrev_b32 v217, 16, v219
    v_sub_f32 v217, v216, v217
    v_cvt_pk_bf16_f32 v218, v216, v217
    v_mfma_f32_32x32x16_bf16 v[192:207], a[204:207], a[48:51], v[192:207]
    ds_read_b64_tr_b16 a[172:173], v13 offset:30720
    ds_read_b64_tr_b16 a[174:175], v13 offset:31232
    s_waitcnt lgkmcnt(8)
    v_mfma_f32_32x32x16_bf16 v[144:159], a[224:227], a[52:55], v[144:159]
    ds_read_b64_tr_b16 a[192:193], v11 offset:4096
    ds_read_b64_tr_b16 a[194:195], v11 offset:4608
    v_mfma_f32_32x32x8_bf16 v[144:159], v[214:215], v[24:25], v[144:159]
    v_mfma_f32_32x32x16_bf16 v[160:175], a[228:231], a[52:55], v[160:175]
    ds_read_b64_tr_b16 a[196:197], v14 offset:4096
    ds_read_b64_tr_b16 a[198:199], v14 offset:4608
    v_mfma_f32_32x32x8_bf16 v[160:175], v[214:215], v[26:27], v[160:175]
    v_mfma_f32_32x32x16_bf16 v[176:191], a[232:235], a[52:55], v[176:191]
    ds_read_b64_tr_b16 a[200:201], v11 offset:6144
    ds_read_b64_tr_b16 a[202:203], v11 offset:6656
    v_mfma_f32_32x32x8_bf16 v[176:191], v[218:219], v[24:25], v[176:191]
    v_mfma_f32_32x32x16_bf16 v[192:207], a[236:239], a[52:55], v[192:207]
    ds_read_b64_tr_b16 a[204:205], v14 offset:6144
    ds_read_b64_tr_b16 a[206:207], v14 offset:6656
    v_mfma_f32_32x32x8_bf16 v[192:207], v[218:219], v[26:27], v[192:207]
    s_waitcnt lgkmcnt(8)
    v_mfma_f32_32x32x16_bf16 v[144:159], a[160:163], a[56:59], v[144:159]
    s_waitcnt vmcnt(4)
    s_barrier
    s_add_u32 m0, s60, 8192
    ds_read_b64_tr_b16 a[224:225], v9 offset:16384
    ds_read_b64_tr_b16 a[226:227], v9 offset:16896
    buffer_load_dwordx4 v7, s[36:39], s81 offen offset:0  lds
    v_mfma_f32_32x32x16_bf16 v[160:175], a[164:167], a[56:59], v[160:175]
    ds_read_b64_tr_b16 a[228:229], v12 offset:16384
    ds_read_b64_tr_b16 a[230:231], v12 offset:16896
    s_lshl_b32 s5, s87, 8
    s_add_u32 s5, s5, 13992192
    s_cmp_eq_u32 s3, 0
    s_cselect_b32 s7, s5, 2146435072
    v_lshlrev_b32 v3, 12, v0
    s_mov_b64 exec, 0xffff
    buffer_atomic_add v11, v3, s[44:47], s7 offen offset:0 sc1
    s_mov_b64 exec, -1
    v_mfma_f32_32x32x16_bf16 v[176:191], a[168:171], a[56:59], v[176:191]
    ds_read_b64_tr_b16 a[232:233], v9 offset:18432
    ds_read_b64_tr_b16 a[234:235], v9 offset:18944
    buffer_load_dwordx4 v8, s[36:39], s81 offen offset:1024  lds
    v_mfma_f32_32x32x16_bf16 v[192:207], a[172:175], a[56:59], v[192:207]
    ds_read_b64_tr_b16 a[236:237], v12 offset:18432
    ds_read_b64_tr_b16 a[238:239], v12 offset:18944
    s_waitcnt lgkmcnt(8)
    v_mfma_f32_32x32x16_bf16 v[144:159], a[192:195], a[60:63], v[144:159]
    ds_read_b64_tr_b16 a[160:161], v9 offset:57344
    ds_read_b64_tr_b16 a[162:163], v9 offset:57856
    buffer_load_dwordx4 v7, s[40:43], s81 offen offset:2048  lds
    v_mfma_f32_32x32x16_bf16 v[160:175], a[196:199], a[60:63], v[160:175]
    ds_read_b64_tr_b16 a[164:165], v12 offset:57344
    ds_read_b64_tr_b16 a[166:167], v12 offset:57856
    v_mfma_f32_32x32x16_bf16 v[176:191], a[200:203], a[60:63], v[176:191]
    ds_read_b64_tr_b16 a[168:169], v9 offset:59392
    ds_read_b64_tr_b16 a[170:171], v9 offset:59904
    buffer_load_dwordx4 v8, s[40:43], s81 offen offset:3072  lds
    v_mfma_f32_32x32x16_bf16 v[192:207], a[204:207], a[60:63], v[192:207]
    ds_read_b64_tr_b16 a[172:173], v12 offset:59392
    ds_read_b64_tr_b16 a[174:175], v12 offset:59904
    s_waitcnt lgkmcnt(8)
    v_mfma_f32_32x32x16_bf16 v[144:159], a[224:227], a[64:67], v[144:159]
    ds_read_b64_tr_b16 a[192:193], v10 offset:32768
    ds_read_b64_tr_b16 a[194:195], v10 offset:33280
    buffer_load_dwordx4 a[20:23], v15, s[44:47], s14 offen offset:2048 sc1
    v_mfma_f32_32x32x16_bf16 v[160:175], a[228:231], a[64:67], v[160:175]
    ds_read_b64_tr_b16 a[196:197], v13 offset:32768
    ds_read_b64_tr_b16 a[198:199], v13 offset:33280
    v_mfma_f32_32x32x16_bf16 v[176:191], a[232:235], a[64:67], v[176:191]
    ds_read_b64_tr_b16 a[200:201], v10 offset:34816
    ds_read_b64_tr_b16 a[202:203], v10 offset:35328
    buffer_load_dwordx4 a[24:27], v15, s[44:47], s14 offen offset:3072 sc1
    v_mfma_f32_32x32x16_bf16 v[192:207], a[236:239], a[64:67], v[192:207]
    ds_read_b64_tr_b16 a[204:205], v13 offset:34816
    ds_read_b64_tr_b16 a[206:207], v13 offset:35328
    s_waitcnt lgkmcnt(8)
    v_mfma_f32_32x32x16_bf16 v[144:159], a[160:163], a[68:71], v[144:159]
    ds_read_b64_tr_b16 a[224:225], v11 offset:8192
    ds_read_b64_tr_b16 a[226:227], v11 offset:8704
    buffer_load_dwordx4 a[28:31], v16, s[44:47], s14 offen offset:0 sc1
    v_mfma_f32_32x32x16_bf16 v[160:175], a[164:167], a[68:71], v[160:175]
    ds_read_b64_tr_b16 a[228:229], v14 offset:8192
    ds_read_b64_tr_b16 a[230:231], v14 offset:8704
    v_mfma_f32_32x32x16_bf16 v[176:191], a[168:171], a[68:71], v[176:191]
    ds_read_b64_tr_b16 a[232:233], v11 offset:10240
    ds_read_b64_tr_b16 a[234:235], v11 offset:10752
    buffer_load_dwordx4 a[32:35], v15, s[44:47], s15 offen offset:0 sc1
    v_mfma_f32_32x32x16_bf16 v[192:207], a[172:175], a[68:71], v[192:207]
    ds_read_b64_tr_b16 a[236:237], v14 offset:10240
    ds_read_b64_tr_b16 a[238:239], v14 offset:10752
    s_waitcnt lgkmcnt(8)
    v_mfma_f32_32x32x16_bf16 v[144:159], a[192:195], a[72:75], v[144:159]
    s_barrier
    s_add_u32 m0, s60, 12288
    ds_read_b64_tr_b16 a[160:161], v9 offset:0
    ds_read_b64_tr_b16 a[162:163], v9 offset:512
    buffer_load_dwordx4 v7, s[36:39], s82 offen offset:0  lds
    v_mfma_f32_32x32x16_bf16 v[160:175], a[196:199], a[72:75], v[160:175]
    ds_read_b64_tr_b16 a[164:165], v12 offset:0
    ds_read_b64_tr_b16 a[166:167], v12 offset:512
    v_mfma_f32_32x32x16_bf16 v[176:191], a[200:203], a[72:75], v[176:191]
    ds_read_b64_tr_b16 a[168:169], v9 offset:2048
    ds_read_b64_tr_b16 a[170:171], v9 offset:2560
    buffer_load_dwordx4 v8, s[36:39], s82 offen offset:1024  lds
    v_mfma_f32_32x32x16_bf16 v[192:207], a[204:207], a[72:75], v[192:207]
    ds_read_b64_tr_b16 a[172:173], v12 offset:2048
    ds_read_b64_tr_b16 a[174:175], v12 offset:2560
    s_waitcnt lgkmcnt(8)
    v_mfma_f32_32x32x16_bf16 v[144:159], a[224:227], a[76:79], v[144:159]
    ds_read_b64_tr_b16 a[192:193], v9 offset:40960
    ds_read_b64_tr_b16 a[194:195], v9 offset:41472
    buffer_load_dwordx4 v7, s[40:43], s82 offen offset:2048  lds
    v_mfma_f32_32x32x16_bf16 v[160:175], a[228:231], a[76:79], v[160:175]
    ds_read_b64_tr_b16 a[196:197], v12 offset:40960
    ds_read_b64_tr_b16 a[198:199], v12 offset:41472
    v_mfma_f32_32x32x16_bf16 v[176:191], a[232:235], a[76:79], v[176:191]
    ds_read_b64_tr_b16 a[200:201], v9 offset:43008
    ds_read_b64_tr_b16 a[202:203], v9 offset:43520
    buffer_load_dwordx4 v8, s[40:43], s82 offen offset:3072  lds
    v_mfma_f32_32x32x16_bf16 v[192:207], a[236:239], a[76:79], v[192:207]
    ds_read_b64_tr_b16 a[204:205], v12 offset:43008
    ds_read_b64_tr_b16 a[206:207], v12 offset:43520
    s_waitcnt lgkmcnt(8)
    v_mfma_f32_32x32x16_bf16 v[144:159], a[160:163], a[80:83], v[144:159]
    ds_read_b64_tr_b16 a[224:225], v10 offset:16384
    ds_read_b64_tr_b16 a[226:227], v10 offset:16896
    buffer_load_dwordx4 a[36:39], v15, s[44:47], s15 offen offset:1024 sc1
    v_mfma_f32_32x32x16_bf16 v[160:175], a[164:167], a[80:83], v[160:175]
    ds_read_b64_tr_b16 a[228:229], v13 offset:16384
    ds_read_b64_tr_b16 a[230:231], v13 offset:16896
    v_mfma_f32_32x32x16_bf16 v[176:191], a[168:171], a[80:83], v[176:191]
    ds_read_b64_tr_b16 a[232:233], v10 offset:18432
    ds_read_b64_tr_b16 a[234:235], v10 offset:18944
    buffer_load_dwordx4 a[40:43], v15, s[44:47], s15 offen offset:2048 sc1
    v_mfma_f32_32x32x16_bf16 v[192:207], a[172:175], a[80:83], v[192:207]
    ds_read_b64_tr_b16 a[236:237], v13 offset:18432
    ds_read_b64_tr_b16 a[238:239], v13 offset:18944
    s_waitcnt lgkmcnt(8)
    v_mfma_f32_32x32x16_bf16 v[144:159], a[192:195], a[84:87], v[144:159]
    ds_read_b64_tr_b16 a[160:161], v10 offset:57344
    ds_read_b64_tr_b16 a[162:163], v10 offset:57856
    buffer_load_dwordx4 a[44:47], v15, s[44:47], s15 offen offset:3072 sc1
    v_mfma_f32_32x32x16_bf16 v[160:175], a[196:199], a[84:87], v[160:175]
    ds_read_b64_tr_b16 a[164:165], v13 offset:57344
    ds_read_b64_tr_b16 a[166:167], v13 offset:57856
    v_mfma_f32_32x32x16_bf16 v[176:191], a[200:203], a[84:87], v[176:191]
    ds_read_b64_tr_b16 a[168:169], v10 offset:59392
    ds_read_b64_tr_b16 a[170:171], v10 offset:59904
    buffer_load_dwordx4 v[80:83], v16, s[44:47], s15 offen offset:0 sc1
    v_mfma_f32_32x32x16_bf16 v[192:207], a[204:207], a[84:87], v[192:207]
    ds_read_b64_tr_b16 a[172:173], v13 offset:59392
    ds_read_b64_tr_b16 a[174:175], v13 offset:59904
    s_waitcnt lgkmcnt(8)
    v_mfma_f32_32x32x16_bf16 v[144:159], a[224:227], a[88:91], v[144:159]
    s_waitcnt vmcnt(17)
    s_barrier
    s_add_u32 m0, s60, 16384
    ds_read_b64_tr_b16 a[192:193], v9 offset:4096
    ds_read_b64_tr_b16 a[194:195], v9 offset:4608
    buffer_load_dwordx4 v7, s[36:39], s83 offen offset:0  lds
    v_mfma_f32_32x32x16_bf16 v[160:175], a[228:231], a[88:91], v[160:175]
    ds_read_b64_tr_b16 a[196:197], v12 offset:4096
    ds_read_b64_tr_b16 a[198:199], v12 offset:4608
    v_mfma_f32_32x32x16_bf16 v[176:191], a[232:235], a[88:91], v[176:191]
    ds_read_b64_tr_b16 a[200:201], v9 offset:6144
    ds_read_b64_tr_b16 a[202:203], v9 offset:6656
    buffer_load_dwordx4 v8, s[36:39], s83 offen offset:1024  lds
    v_mfma_f32_32x32x16_bf16 v[192:207], a[236:239], a[88:91], v[192:207]
    ds_read_b64_tr_b16 a[204:205], v12 offset:6144
    ds_read_b64_tr_b16 a[206:207], v12 offset:6656
    s_waitcnt lgkmcnt(8)
    v_mfma_f32_32x32x16_bf16 v[144:159], a[160:163], a[92:95], v[144:159]
    ds_read_b64_tr_b16 a[224:225], v9 offset:45056
    ds_read_b64_tr_b16 a[226:227], v9 offset:45568
    buffer_load_dwordx4 v7, s[40:43], s83 offen offset:2048  lds
    v_mfma_f32_32x32x16_bf16 v[160:175], a[164:167], a[92:95], v[160:175]
    ds_read_b64_tr_b16 a[228:229], v12 offset:45056
    ds_read_b64_tr_b16 a[230:231], v12 offset:45568
    v_mfma_f32_32x32x16_bf16 v[176:191], a[168:171], a[92:95], v[176:191]
    ds_read_b64_tr_b16 a[232:233], v9 offset:47104
    ds_read_b64_tr_b16 a[234:235], v9 offset:47616
    buffer_load_dwordx4 v8, s[40:43], s83 offen offset:3072  lds
    v_mfma_f32_32x32x16_bf16 v[192:207], a[172:175], a[92:95], v[192:207]
    ds_read_b64_tr_b16 a[236:237], v12 offset:47104
    ds_read_b64_tr_b16 a[238:239], v12 offset:47616
    s_waitcnt lgkmcnt(8)
    v_mfma_f32_32x32x16_bf16 v[144:159], a[192:195], a[96:99], v[144:159]
    ds_read_b64_tr_b16 a[160:161], v10 offset:20480
    ds_read_b64_tr_b16 a[162:163], v10 offset:20992
    buffer_load_dwordx4 v[84:87], v15, s[44:47], s16 offen offset:0 sc1
    v_mfma_f32_32x32x16_bf16 v[160:175], a[196:199], a[96:99], v[160:175]
    ds_read_b64_tr_b16 a[164:165], v13 offset:20480
    ds_read_b64_tr_b16 a[166:167], v13 offset:20992
    v_mfma_f32_32x32x16_bf16 v[176:191], a[200:203], a[96:99], v[176:191]
    ds_read_b64_tr_b16 a[168:169], v10 offset:22528
    ds_read_b64_tr_b16 a[170:171], v10 offset:23040
    buffer_load_dwordx4 v[88:91], v15, s[44:47], s16 offen offset:1024 sc1
    v_mfma_f32_32x32x16_bf16 v[192:207], a[204:207], a[96:99], v[192:207]
    ds_read_b64_tr_b16 a[172:173], v13 offset:22528
    ds_read_b64_tr_b16 a[174:175], v13 offset:23040
    s_waitcnt lgkmcnt(8)
    v_mfma_f32_32x32x16_bf16 v[144:159], a[224:227], a[100:103], v[144:159]
    ds_read_b64_tr_b16 a[192:193], v10 offset:61440
    ds_read_b64_tr_b16 a[194:195], v10 offset:61952
    buffer_load_dwordx4 v[92:95], v15, s[44:47], s16 offen offset:2048 sc1
    v_mfma_f32_32x32x16_bf16 v[160:175], a[228:231], a[100:103], v[160:175]
    ds_read_b64_tr_b16 a[196:197], v13 offset:61440
    ds_read_b64_tr_b16 a[198:199], v13 offset:61952
    v_mfma_f32_32x32x16_bf16 v[176:191], a[232:235], a[100:103], v[176:191]
    ds_read_b64_tr_b16 a[200:201], v10 offset:63488
    ds_read_b64_tr_b16 a[202:203], v10 offset:64000
    buffer_load_dwordx4 v[96:99], v15, s[44:47], s16 offen offset:3072 sc1
    v_mfma_f32_32x32x16_bf16 v[192:207], a[236:239], a[100:103], v[192:207]
    ds_read_b64_tr_b16 a[204:205], v13 offset:63488
    ds_read_b64_tr_b16 a[206:207], v13 offset:64000
    s_waitcnt lgkmcnt(8)
    v_mfma_f32_32x32x16_bf16 v[144:159], a[160:163], a[104:107], v[144:159]
    s_waitcnt vmcnt(20)
    s_barrier
    ds_read_b64_tr_b16 a[224:225], v9 offset:8192
    ds_read_b64_tr_b16 a[226:227], v9 offset:8704
    buffer_load_dwordx4 v[100:103], v16, s[44:47], s16 offen offset:0 sc1
    v_mfma_f32_32x32x16_bf16 v[160:175], a[164:167], a[104:107], v[160:175]
    ds_read_b64_tr_b16 a[228:229], v12 offset:8192
    ds_read_b64_tr_b16 a[230:231], v12 offset:8704
    v_mfma_f32_32x32x16_bf16 v[176:191], a[168:171], a[104:107], v[176:191]
    ds_read_b64_tr_b16 a[232:233], v9 offset:10240
    ds_read_b64_tr_b16 a[234:235], v9 offset:10752
    buffer_load_dwordx4 v[104:107], v15, s[44:47], s17 offen offset:0 sc1
    v_mfma_f32_32x32x16_bf16 v[192:207], a[172:175], a[104:107], v[192:207]
    ds_read_b64_tr_b16 a[236:237], v12 offset:10240
    ds_read_b64_tr_b16 a[238:239], v12 offset:10752
    s_waitcnt lgkmcnt(8)
    v_mfma_f32_32x32x16_bf16 v[144:159], a[192:195], a[108:111], v[144:159]
    ds_read_b64_tr_b16 a[160:161], v9 offset:49152
    ds_read_b64_tr_b16 a[162:163], v9 offset:49664
    buffer_load_dwordx4 v[108:111], v15, s[44:47], s17 offen offset:1024 sc1
    v_mfma_f32_32x32x16_bf16 v[160:175], a[196:199], a[108:111], v[160:175]
    ds_read_b64_tr_b16 a[164:165], v12 offset:49152
    ds_read_b64_tr_b16 a[166:167], v12 offset:49664
    v_mfma_f32_32x32x16_bf16 v[176:191], a[200:203], a[108:111], v[176:191]
    ds_read_b64_tr_b16 a[168:169], v9 offset:51200
    ds_read_b64_tr_b16 a[170:171], v9 offset:51712
    buffer_load_dwordx4 a[48:51], v15, s[44:47], s17 offen offset:2048 sc1
    v_mfma_f32_32x32x16_bf16 v[192:207], a[204:207], a[108:111], v[192:207]
    ds_read_b64_tr_b16 a[172:173], v12 offset:51200
    ds_read_b64_tr_b16 a[174:175], v12 offset:51712
    s_waitcnt lgkmcnt(8)
    v_mfma_f32_32x32x16_bf16 v[144:159], a[224:227], a[112:115], v[144:159]
    ds_read_b64_tr_b16 a[192:193], v10 offset:24576
    ds_read_b64_tr_b16 a[194:195], v10 offset:25088
    buffer_load_dwordx4 a[52:55], v15, s[44:47], s17 offen offset:3072 sc1
    v_mfma_f32_32x32x16_bf16 v[160:175], a[228:231], a[112:115], v[160:175]
    ds_read_b64_tr_b16 a[196:197], v13 offset:24576
    ds_read_b64_tr_b16 a[198:199], v13 offset:25088
    v_mfma_f32_32x32x16_bf16 v[176:191], a[232:235], a[112:115], v[176:191]
    ds_read_b64_tr_b16 a[200:201], v10 offset:26624
    ds_read_b64_tr_b16 a[202:203], v10 offset:27136
    buffer_load_dwordx4 a[56:59], v16, s[44:47], s17 offen offset:0 sc1
    v_mfma_f32_32x32x16_bf16 v[192:207], a[236:239], a[112:115], v[192:207]
    ds_read_b64_tr_b16 a[204:205], v13 offset:26624
    ds_read_b64_tr_b16 a[206:207], v13 offset:27136
    s_waitcnt lgkmcnt(8)
    v_mfma_f32_32x32x16_bf16 v[144:159], a[160:163], a[116:119], v[144:159]
    ds_read_b64_tr_b16 a[224:225], v11 offset:0
    ds_read_b64_tr_b16 a[226:227], v11 offset:512
    s_getpc_b64 s[100:101]
PC2A:
    s_sub_u32 s100, s100, PC2A - LTAB - 5120
    s_subb_u32 s101, s101, 0
    v_lshlrev_b32 v7, 4, v0
    global_load_dwordx4 v[220:223], v7, s[100:101] offset:0
    global_load_dwordx4 v[224:227], v7, s[100:101] offset:1024
    global_load_dwordx4 v[208:211], v7, s[100:101] offset:2048
    v_mfma_f32_32x32x16_bf16 v[160:175], a[164:167], a[116:119], v[160:175]
    ds_read_b64_tr_b16 a[228:229], v14 offset:0
    ds_read_b64_tr_b16 a[230:231], v14 offset:512
    buffer_load_dwordx4 a[60:63], v15, s[44:47], s18 offen offset:0 sc1
    v_mfma_f32_32x32x16_bf16 v[176:191], a[168:171], a[116:119], v[176:191]
    ds_read_b64_tr_b16 a[232:233], v11 offset:2048
    ds_read_b64_tr_b16 a[234:235], v11 offset:2560
    v_mfma_f32_32x32x16_bf16 v[192:207], a[172:175], a[116:119], v[192:207]
    ds_read_b64_tr_b16 a[236:237], v14 offset:2048
    ds_read_b64_tr_b16 a[238:239], v14 offset:2560
    buffer_load_dwordx4 a[64:67], v15, s[44:47], s18 offen offset:1024 sc1
    s_waitcnt lgkmcnt(8)
    v_mfma_f32_32x32x16_bf16 v[144:159], a[192:195], a[120:123], v[144:159]
    s_waitcnt vmcnt(23)
    s_barrier
    ds_read_b64_tr_b16 a[160:161], v9 offset:12288
    ds_read_b64_tr_b16 a[162:163], v9 offset:12800
    v_mfma_f32_32x32x16_bf16 v[160:175], a[196:199], a[120:123], v[160:175]
    ds_read_b64_tr_b16 a[164:165], v12 offset:12288
    ds_read_b64_tr_b16 a[166:167], v12 offset:12800
    buffer_load_dwordx4 a[68:71], v15, s[44:47], s18 offen offset:2048 sc1
    v_mfma_f32_32x32x16_bf16 v[176:191], a[200:203], a[120:123], v[176:191]
    ds_read_b64_tr_b16 a[168:169], v9 offset:14336
    ds_read_b64_tr_b16 a[170:171], v9 offset:14848
    v_mfma_f32_32x32x16_bf16 v[192:207], a[204:207], a[120:123], v[192:207]
    ds_read_b64_tr_b16 a[172:173], v12 offset:14336
    ds_read_b64_tr_b16 a[174:175], v12 offset:14848
    buffer_load_dwordx4 a[72:75], v15, s[44:47], s18 offen offset:3072 sc1
    s_waitcnt lgkmcnt(8)
    v_mfma_f32_32x32x16_bf16 v[144:159], a[224:227], a[124:127], v[144:159]
    ds_read_b64_tr_b16 a[192:193], v9 offset:53248
    ds_read_b64_tr_b16 a[194:195], v9 offset:53760
    buffer_load_dword v6, off, s[44:47], s89 offset:4 sc1
    v_mfma_f32_32x32x16_bf16 v[160:175], a[228:231], a[124:127], v[160:175]
    ds_read_b64_tr_b16 a[196:197], v12 offset:53248
    ds_read_b64_tr_b16 a[198:199], v12 offset:53760
    buffer_load_dwordx4 a[76:79], v16, s[44:47], s18 offen offset:0 sc1
    v_mfma_f32_32x32x16_bf16 v[176:191], a[232:235], a[124:127], v[176:191]
    ds_read_b64_tr_b16 a[200:201], v9 offset:55296
    ds_read_b64_tr_b16 a[202:203], v9 offset:55808
    v_mfma_f32_32x32x16_bf16 v[192:207], a[236:239], a[124:127], v[192:207]
    ds_read_b64_tr_b16 a[204:205], v12 offset:55296
    ds_read_b64_tr_b16 a[206:207], v12 offset:55808
    buffer_load_dwordx4 a[80:83], v15, s[44:47], s19 offen offset:0 sc1
    s_waitcnt lgkmcnt(8)
    v_mfma_f32_32x32x16_bf16 v[144:159], a[160:163], a[128:131], v[144:159]
    ds_read_b64_tr_b16 a[224:225], v10 offset:28672
    ds_read_b64_tr_b16 a[226:227], v10 offset:29184
    v_mfma_f32_32x32x16_bf16 v[160:175], a[164:167], a[128:131], v[160:175]
    ds_read_b64_tr_b16 a[228:229], v13 offset:28672
    ds_read_b64_tr_b16 a[230:231], v13 offset:29184
    buffer_load_dwordx4 a[84:87], v15, s[44:47], s19 offen offset:1024 sc1
    v_mfma_f32_32x32x16_bf16 v[176:191], a[168:171], a[128:131], v[176:191]
    ds_read_b64_tr_b16 a[232:233], v10 offset:30720
    ds_read_b64_tr_b16 a[234:235], v10 offset:31232
    v_mfma_f32_32x32x16_bf16 v[192:207], a[172:175], a[128:131], v[192:207]
    ds_read_b64_tr_b16 a[236:237], v13 offset:30720
    ds_read_b64_tr_b16 a[238:239], v13 offset:31232
    buffer_load_dwordx4 a[88:91], v15, s[44:47], s19 offen offset:2048 sc1
    s_waitcnt lgkmcnt(8)
    v_mfma_f32_32x32x16_bf16 v[144:159], a[192:195], a[132:135], v[144:159]
    ds_read_b64_tr_b16 a[160:161], v11 offset:4096
    ds_read_b64_tr_b16 a[162:163], v11 offset:4608
    v_mfma_f32_32x32x16_bf16 v[160:175], a[196:199], a[132:135], v[160:175]
    ds_read_b64_tr_b16 a[164:165], v14 offset:4096
    ds_read_b64_tr_b16 a[166:167], v14 offset:4608
    buffer_load_dwordx4 a[92:95], v15, s[44:47], s19 offen offset:3072 sc1
    v_mfma_f32_32x32x16_bf16 v[176:191], a[200:203], a[132:135], v[176:191]
    ds_read_b64_tr_b16 a[168:169], v11 offset:6144
    ds_read_b64_tr_b16 a[170:171], v11 offset:6656
    v_mfma_f32_32x32x16_bf16 v[192:207], a[204:207], a[132:135], v[192:207]
    ds_read_b64_tr_b16 a[172:173], v14 offset:6144
    ds_read_b64_tr_b16 a[174:175], v14 offset:6656
    buffer_load_dwordx4 a[96:99], v16, s[44:47], s19 offen offset:0 sc1
    s_waitcnt lgkmcnt(8)
    v_mfma_f32_32x32x16_bf16 v[144:159], a[224:227], a[136:139], v[144:159]
    s_waitcnt vmcnt(24)
    s_barrier
    ds_read_b64_tr_b16 a[192:193], v9 offset:16384
    ds_read_b64_tr_b16 a[194:195], v9 offset:16896
    v_mfma_f32_32x32x16_bf16 v[160:175], a[228:231], a[136:139], v[160:175]
    ds_read_b64_tr_b16 a[196:197], v12 offset:16384
    ds_read_b64_tr_b16 a[198:199], v12 offset:16896
    buffer_load_dwordx4 a[100:103], v15, s[44:47], s20 offen offset:0 sc1
    v_mfma_f32_32x32x16_bf16 v[176:191], a[232:235], a[136:139], v[176:191]
    ds_read_b64_tr_b16 a[200:201], v9 offset:18432
    ds_read_b64_tr_b16 a[202:203], v9 offset:18944
    v_mfma_f32_32x32x16_bf16 v[192:207], a[236:239], a[136:139], v[192:207]
    ds_read_b64_tr_b16 a[204:205], v12 offset:18432
    ds_read_b64_tr_b16 a[206:207], v12 offset:18944
    buffer_load_dwordx4 a[104:107], v15, s[44:47], s20 offen offset:1024 sc1
    s_waitcnt lgkmcnt(8)
    v_mfma_f32_32x32x16_bf16 v[144:159], a[160:163], a[140:143], v[144:159]
    ds_read_b64_tr_b16 a[224:225], v9 offset:57344
    ds_read_b64_tr_b16 a[226:227], v9 offset:57856
    v_mfma_f32_32x32x16_bf16 v[160:175], a[164:167], a[140:143], v[160:175]
    ds_read_b64_tr_b16 a[228:229], v12 offset:57344
    ds_read_b64_tr_b16 a[230:231], v12 offset:57856
    buffer_load_dwordx4 a[108:111], v15, s[44:47], s20 offen offset:2048 sc1
    v_mfma_f32_32x32x16_bf16 v[176:191], a[168:171], a[140:143], v[176:191]
    ds_read_b64_tr_b16 a[232:233], v9 offset:59392
    ds_read_b64_tr_b16 a[234:235], v9 offset:59904
    v_mfma_f32_32x32x16_bf16 v[192:207], a[172:175], a[140:143], v[192:207]
    ds_read_b64_tr_b16 a[236:237], v12 offset:59392
    ds_read_b64_tr_b16 a[238:239], v12 offset:59904
    buffer_load_dwordx4 a[112:115], v15, s[44:47], s20 offen offset:3072 sc1
    s_waitcnt lgkmcnt(8)
    v_mfma_f32_32x32x16_bf16 v[144:159], a[192:195], a[144:147], v[144:159]
    ds_read_b64_tr_b16 a[160:161], v10 offset:32768
    ds_read_b64_tr_b16 a[162:163], v10 offset:33280
    s_waitcnt vmcnt(10)
    v_readfirstlane_b32 s98, v6
    s_cmp_ge_u32 s98, 1048576
    s_cbranch_scc0 SPIN47
RET47:
    v_lshlrev_b32 v6, 4, v0
    v_add_u32 v6, s93, v6
    s_add_u32 s7, s3, 0
    s_and_b32 s7, s7, 3
    s_lshl_b32 s7, s7, 10
    v_add_u32 v2, s7, v6
    s_add_u32 s7, s3, 1
    s_and_b32 s7, s7, 3
    s_lshl_b32 s7, s7, 10
    v_add_u32 v3, s7, v6
    s_add_u32 s7, s3, 2
    s_and_b32 s7, s7, 3
    s_lshl_b32 s7, s7, 10
    v_add_u32 v4, s7, v6
    s_add_u32 s7, s3, 3
    s_and_b32 s7, s7, 3
    s_lshl_b32 s7, s7, 10
    v_add_u32 v5, s7, v6
    v_mfma_f32_32x32x16_bf16 v[160:175], a[196:199], a[144:147], v[160:175]
    ds_read_b64_tr_b16 a[164:165], v13 offset:32768
    ds_read_b64_tr_b16 a[166:167], v13 offset:33280
    buffer_load_dwordx4 v[32:35], v2, s[44:47], s8 offen sc1
    v_mfma_f32_32x32x16_bf16 v[176:191], a[200:203], a[144:147], v[176:191]
    ds_read_b64_tr_b16 a[168:169], v10 offset:34816
    ds_read_b64_tr_b16 a[170:171], v10 offset:35328
    buffer_load_dwordx4 v[36:39], v3, s[44:47], s8 offen sc1
    v_mfma_f32_32x32x16_bf16 v[192:207], a[204:207], a[144:147], v[192:207]
    ds_read_b64_tr_b16 a[172:173], v13 offset:34816
    ds_read_b64_tr_b16 a[174:175], v13 offset:35328
    buffer_load_dwordx4 v[40:43], v4, s[44:47], s8 offen sc1
    s_waitcnt lgkmcnt(8)
    v_mfma_f32_32x32x16_bf16 v[144:159], a[224:227], a[148:151], v[144:159]
    ds_read_b64_tr_b16 a[192:193], v11 offset:8192
    ds_read_b64_tr_b16 a[194:195], v11 offset:8704
    buffer_load_dwordx4 v[44:47], v5, s[44:47], s8 offen sc1
    v_mfma_f32_32x32x16_bf16 v[160:175], a[228:231], a[148:151], v[160:175]
    ds_read_b64_tr_b16 a[196:197], v14 offset:8192
    ds_read_b64_tr_b16 a[198:199], v14 offset:8704
    buffer_load_dwordx4 v[48:51], v2, s[44:47], s9 offen sc1
    v_mfma_f32_32x32x16_bf16 v[176:191], a[232:235], a[148:151], v[176:191]
    ds_read_b64_tr_b16 a[200:201], v11 offset:10240
    ds_read_b64_tr_b16 a[202:203], v11 offset:10752
    buffer_load_dwordx4 v[52:55], v3, s[44:47], s9 offen sc1
    v_mfma_f32_32x32x16_bf16 v[192:207], a[236:239], a[148:151], v[192:207]
    ds_read_b64_tr_b16 a[204:205], v14 offset:10240
    ds_read_b64_tr_b16 a[206:207], v14 offset:10752
    buffer_load_dwordx4 v[56:59], v4, s[44:47], s9 offen sc1
    s_waitcnt lgkmcnt(8)
    v_mfma_f32_32x32x16_bf16 v[144:159], a[160:163], a[152:155], v[144:159]
    buffer_load_dwordx4 v[60:63], v5, s[44:47], s9 offen sc1
    v_mfma_f32_32x32x16_bf16 v[160:175], a[164:167], a[152:155], v[160:175]
    buffer_load_dwordx4 v[64:67], v2, s[44:47], s10 offen sc1
    v_mfma_f32_32x32x16_bf16 v[176:191], a[168:171], a[152:155], v[176:191]
    buffer_load_dwordx4 v[68:71], v3, s[44:47], s10 offen sc1
    v_mfma_f32_32x32x16_bf16 v[192:207], a[172:175], a[152:155], v[192:207]
    buffer_load_dwordx4 v[72:75], v4, s[44:47], s10 offen sc1
    s_waitcnt lgkmcnt(0)
    v_mfma_f32_32x32x16_bf16 v[144:159], a[192:195], a[156:159], v[144:159]
    buffer_load_dwordx4 v[76:79], v5, s[44:47], s10 offen sc1
    v_mfma_f32_32x32x16_bf16 v[160:175], a[196:199], a[156:159], v[160:175]
    v_mfma_f32_32x32x16_bf16 v[176:191], a[200:203], a[156:159], v[176:191]
    buffer_load_dwordx4 a[116:119], v16, s[44:47], s20 offen offset:0 sc1
    v_mfma_f32_32x32x16_bf16 v[192:207], a[204:207], a[156:159], v[192:207]
    s_mul_i32 s4, s87, 5120
    s_add_u32 s4, s4, 163840
    s_nop 9
    v_pk_mul_f32 v[144:145], v[144:145], v[176:177]
    v_pk_mul_f32 v[146:147], v[146:147], v[178:179]
    v_pk_mul_f32 v[148:149], v[148:149], v[180:181]
    v_pk_mul_f32 v[150:151], v[150:151], v[182:183]
    v_pk_mul_f32 v[144:145], v[144:145], v[22:23]
    v_pk_mul_f32 v[146:147], v[146:147], v[22:23]
    v_pk_mul_f32 v[148:149], v[148:149], v[22:23]
    v_pk_mul_f32 v[150:151], v[150:151], v[22:23]
    v_cvt_pk_bf16_f32 v176, v144, v145
    v_cvt_pk_bf16_f32 v177, v146, v147
    v_cvt_pk_bf16_f32 v178, v148, v149
    v_cvt_pk_bf16_f32 v179, v150, v151
    buffer_store_dwordx4 v[176:179], v1, s[44:47], s4 offen offset:0 sc1
    v_pk_mul_f32 v[152:153], v[152:153], v[184:185]
    v_pk_mul_f32 v[154:155], v[154:155], v[186:187]
    v_pk_mul_f32 v[156:157], v[156:157], v[188:189]
    v_pk_mul_f32 v[158:159], v[158:159], v[190:191]
    v_pk_mul_f32 v[152:153], v[152:153], v[22:23]
    v_pk_mul_f32 v[154:155], v[154:155], v[22:23]
    v_pk_mul_f32 v[156:157], v[156:157], v[22:23]
    v_pk_mul_f32 v[158:159], v[158:159], v[22:23]
    v_cvt_pk_bf16_f32 v184, v152, v153
    v_cvt_pk_bf16_f32 v185, v154, v155
    v_cvt_pk_bf16_f32 v186, v156, v157
    v_cvt_pk_bf16_f32 v187, v158, v159
    buffer_store_dwordx4 v[184:187], v1, s[44:47], s4 offen offset:512 sc1
    s_add_u32 s4, s4, 5120
    v_pk_mul_f32 v[160:161], v[160:161], v[192:193]
    v_pk_mul_f32 v[162:163], v[162:163], v[194:195]
    v_pk_mul_f32 v[164:165], v[164:165], v[196:197]
    v_pk_mul_f32 v[166:167], v[166:167], v[198:199]
    v_pk_mul_f32 v[160:161], v[160:161], v[22:23]
    v_pk_mul_f32 v[162:163], v[162:163], v[22:23]
    v_pk_mul_f32 v[164:165], v[164:165], v[22:23]
    v_pk_mul_f32 v[166:167], v[166:167], v[22:23]
    v_cvt_pk_bf16_f32 v192, v160, v161
    v_cvt_pk_bf16_f32 v193, v162, v163
    v_cvt_pk_bf16_f32 v194, v164, v165
    v_cvt_pk_bf16_f32 v195, v166, v167
    buffer_store_dwordx4 v[192:195], v1, s[44:47], s4 offen offset:0 sc1
    v_pk_mul_f32 v[168:169], v[168:169], v[200:201]
    v_pk_mul_f32 v[170:171], v[170:171], v[202:203]
    v_pk_mul_f32 v[172:173], v[172:173], v[204:205]
    v_pk_mul_f32 v[174:175], v[174:175], v[206:207]
    v_pk_mul_f32 v[168:169], v[168:169], v[22:23]
    v_pk_mul_f32 v[170:171], v[170:171], v[22:23]
    v_pk_mul_f32 v[172:173], v[172:173], v[22:23]
    v_pk_mul_f32 v[174:175], v[174:175], v[22:23]
    v_cvt_pk_bf16_f32 v200, v168, v169
    v_cvt_pk_bf16_f32 v201, v170, v171
    v_cvt_pk_bf16_f32 v202, v172, v173
    v_cvt_pk_bf16_f32 v203, v174, v175
    buffer_store_dwordx4 v[200:203], v1, s[44:47], s4 offen offset:512 sc1
    v_mov_b32 v17, v220
    v_mov_b32 v18, v221
    v_mov_b32 v19, v222
    v_mov_b32 v20, v223
    v_mov_b32 v21, v224
    v_mov_b32 v24, v225
    v_mov_b32 v25, v226
    s_mul_i32 s7, s3, 20480
    s_add_u32 s94, s94, s7
    s_add_u32 s7, s3, 0
    s_and_b32 s7, s7, 3
    s_mul_i32 s7, s7, 20608
    s_add_u32 s7, s7, 0
    v_add_u32 v9, s7, v25
    s_add_u32 s7, s3, 1
    s_and_b32 s7, s7, 3
    s_mul_i32 s7, s7, 20608
    s_add_u32 s7, s7, 5152
    v_add_u32 v10, s7, v25
    s_add_u32 s7, s3, 2
    s_and_b32 s7, s7, 3
    s_mul_i32 s7, s7, 20608
    s_add_u32 s7, s7, 10304
    v_add_u32 v12, s7, v25
    s_add_u32 s7, s3, 3
    s_and_b32 s7, s7, 3
    s_mul_i32 s7, s7, 20608
    s_add_u32 s7, s7, 15456
    v_add_u32 v13, s7, v25
    s_mul_i32 s7, s3, 20608
    v_add_u32 v20, s7, v20
    v_add_u32 v21, s7, v21
    v_add_u32 v24, s7, v24
    s_waitcnt vmcnt(13)
    v_mfma_f32_16x16x32_bf16 a[160:163], a[180:183], v[32:35], 0
    buffer_load_dwordx4 a[120:123], v15, s[44:47], s21 offen offset:0 sc1
    v_mfma_f32_16x16x32_bf16 a[196:199], a[180:183], v[36:39], 0
    buffer_load_dwordx4 a[124:127], v15, s[44:47], s21 offen offset:1024 sc1
    v_mfma_f32_16x16x32_bf16 a[232:235], a[180:183], v[40:43], 0
    buffer_load_dwordx4 v[208:211], v15, s[44:47], s21 offen offset:2048 sc1
    v_mfma_f32_16x16x32_bf16 a[140:143], a[180:183], v[44:47], 0
    buffer_load_dwordx4 v[212:215], v15, s[44:47], s21 offen offset:3072 sc1
    v_mfma_f32_16x16x32_bf16 a[164:167], a[184:187], v[32:35], 0
    buffer_load_dwordx4 v[216:219], v16, s[44:47], s21 offen offset:0 sc1
    v_mfma_f32_16x16x32_bf16 a[200:203], a[184:187], v[36:39], 0
    v_mfma_f32_16x16x32_bf16 a[236:239], a[184:187], v[40:43], 0
    v_mfma_f32_16x16x32_bf16 a[144:147], a[184:187], v[44:47], 0
    v_mfma_f32_16x16x32_bf16 a[168:171], a[188:191], v[32:35], 0
    v_mfma_f32_16x16x32_bf16 a[204:207], a[188:191], v[36:39], 0
    v_mfma_f32_16x16x32_bf16 a[128:131], a[188:191], v[40:43], 0
    v_mfma_f32_16x16x32_bf16 a[148:151], a[188:191], v[44:47], 0
    v_mfma_f32_16x16x32_bf16 a[172:175], a[212:215], v[32:35], 0
    v_mfma_f32_16x16x32_bf16 a[224:227], a[212:215], v[36:39], 0
    v_mfma_f32_16x16x32_bf16 a[132:135], a[212:215], v[40:43], 0
    v_mfma_f32_16x16x32_bf16 a[152:155], a[212:215], v[44:47], 0
    v_mfma_f32_16x16x32_bf16 a[192:195], a[216:219], v[32:35], 0
    v_mfma_f32_16x16x32_bf16 a[228:231], a[216:219], v[36:39], 0
    v_mfma_f32_16x16x32_bf16 a[136:139], a[216:219], v[40:43], 0
    v_mfma_f32_16x16x32_bf16 a[156:159], a[216:219], v[44:47], 0
    s_waitcnt vmcnt(14)
    v_mfma_f32_16x16x32_bf16 a[160:163], a[220:223], v[48:51], a[160:163]
    buffer_load_dwordx4 v[32:35], v2, s[44:47], s11 offen sc1
    v_mfma_f32_16x16x32_bf16 a[196:199], a[220:223], v[52:55], a[196:199]
    buffer_load_dwordx4 v[36:39], v3, s[44:47], s11 offen sc1
    v_mfma_f32_16x16x32_bf16 a[232:235], a[220:223], v[56:59], a[232:235]
    buffer_load_dwordx4 v[40:43], v4, s[44:47], s11 offen sc1
    v_mfma_f32_16x16x32_bf16 a[140:143], a[220:223], v[60:63], a[140:143]
    buffer_load_dwordx4 v[44:47], v5, s[44:47], s11 offen sc1
    v_mfma_f32_16x16x32_bf16 a[164:167], a[244:247], v[48:51], a[164:167]
    buffer_load_dwordx4 v[220:223], v15, s[44:47], s22 offen offset:0 sc1
    v_mfma_f32_16x16x32_bf16 a[200:203], a[244:247], v[52:55], a[200:203]
    buffer_load_dwordx4 v[224:227], v15, s[44:47], s22 offen offset:1024 sc1
    v_mfma_f32_16x16x32_bf16 a[236:239], a[244:247], v[56:59], a[236:239]
    v_mfma_f32_16x16x32_bf16 a[144:147], a[244:247], v[60:63], a[144:147]
    v_mfma_f32_16x16x32_bf16 a[168:171], a[248:251], v[48:51], a[168:171]
    v_mfma_f32_16x16x32_bf16 a[204:207], a[248:251], v[52:55], a[204:207]
    v_mfma_f32_16x16x32_bf16 a[128:131], a[248:251], v[56:59], a[128:131]
    v_mfma_f32_16x16x32_bf16 a[148:151], a[248:251], v[60:63], a[148:151]
    v_mfma_f32_16x16x32_bf16 a[172:175], a[252:255], v[48:51], a[172:175]
    v_mfma_f32_16x16x32_bf16 a[224:227], a[252:255], v[52:55], a[224:227]
    v_mfma_f32_16x16x32_bf16 a[132:135], a[252:255], v[56:59], a[132:135]
    v_mfma_f32_16x16x32_bf16 a[152:155], a[252:255], v[60:63], a[152:155]
    v_mfma_f32_16x16x32_bf16 a[192:195], v[112:115], v[48:51], a[192:195]
    v_mfma_f32_16x16x32_bf16 a[228:231], v[112:115], v[52:55], a[228:231]
    v_mfma_f32_16x16x32_bf16 a[136:139], v[112:115], v[56:59], a[136:139]
    v_mfma_f32_16x16x32_bf16 a[156:159], v[112:115], v[60:63], a[156:159]
    s_waitcnt vmcnt(11)
    s_barrier
    s_cmp_eq_u32 s3, 0
    s_cselect_b32 s7, s90, 2146435072
    v_lshlrev_b32 v31, 8, v0
    s_mov_b64 exec, 0xffff
    buffer_atomic_add v11, v31, s[44:47], s7 offen offset:8 sc1
    s_mov_b64 exec, -1
    v_mfma_f32_16x16x32_bf16 a[160:163], v[116:119], v[64:67], a[160:163]
    buffer_load_dwordx4 v[48:51], v2, s[44:47], s12 offen sc1
    v_mfma_f32_16x16x32_bf16 a[196:199], v[116:119], v[68:71], a[196:199]
    buffer_load_dwordx4 v[52:55], v3, s[44:47], s12 offen sc1
    v_mfma_f32_16x16x32_bf16 a[232:235], v[116:119], v[72:75], a[232:235]
    buffer_load_dwordx4 v[56:59], v4, s[44:47], s12 offen sc1
    v_mfma_f32_16x16x32_bf16 a[140:143], v[116:119], v[76:79], a[140:143]
    buffer_load_dwordx4 v[60:63], v5, s[44:47], s12 offen sc1
    v_mfma_f32_16x16x32_bf16 a[164:167], v[120:123], v[64:67], a[164:167]
    buffer_load_dwordx4 v[144:147], v17, s[28:31], s94 offen
    v_mfma_f32_16x16x32_bf16 a[200:203], v[120:123], v[68:71], a[200:203]
    buffer_load_dwordx4 v[148:151], v18, s[28:31], s94 offen
    v_mfma_f32_16x16x32_bf16 a[236:239], v[120:123], v[72:75], a[236:239]
    buffer_load_dwordx4 v[152:155], v19, s[28:31], s94 offen
    v_mfma_f32_16x16x32_bf16 a[144:147], v[120:123], v[76:79], a[144:147]
    buffer_load_dwordx4 v[156:159], v15, s[44:47], s22 offen offset:2048 sc1
    v_mfma_f32_16x16x32_bf16 a[168:171], v[124:127], v[64:67], a[168:171]
    buffer_load_dwordx4 v[160:163], v15, s[44:47], s22 offen offset:3072 sc1
    v_mfma_f32_16x16x32_bf16 a[204:207], v[124:127], v[68:71], a[204:207]
    buffer_load_dwordx4 v[164:167], v16, s[44:47], s22 offen offset:0 sc1
    v_mfma_f32_16x16x32_bf16 a[128:131], v[124:127], v[72:75], a[128:131]
    buffer_load_dwordx4 v[168:171], v15, s[44:47], s23 offen offset:0 sc1
    v_mfma_f32_16x16x32_bf16 a[148:151], v[124:127], v[76:79], a[148:151]
    buffer_load_dwordx4 v[172:175], v15, s[44:47], s23 offen offset:1024 sc1
    v_mfma_f32_16x16x32_bf16 a[172:175], v[128:131], v[64:67], a[172:175]
    v_mfma_f32_16x16x32_bf16 a[224:227], v[128:131], v[68:71], a[224:227]
    v_mfma_f32_16x16x32_bf16 a[132:135], v[128:131], v[72:75], a[132:135]
    v_mfma_f32_16x16x32_bf16 a[152:155], v[128:131], v[76:79], a[152:155]
    v_mfma_f32_16x16x32_bf16 a[192:195], v[132:135], v[64:67], a[192:195]
    v_mfma_f32_16x16x32_bf16 a[228:231], v[132:135], v[68:71], a[228:231]
    v_mfma_f32_16x16x32_bf16 a[136:139], v[132:135], v[72:75], a[136:139]
    v_mfma_f32_16x16x32_bf16 a[156:159], v[132:135], v[76:79], a[156:159]
    s_waitcnt vmcnt(15)
    v_mfma_f32_16x16x32_bf16 a[160:163], v[136:139], v[32:35], a[160:163]
    buffer_load_dwordx4 v[64:67], v2, s[44:47], s13 offen sc1
    v_mfma_f32_16x16x32_bf16 a[196:199], v[136:139], v[36:39], a[196:199]
    buffer_load_dwordx4 v[68:71], v3, s[44:47], s13 offen sc1
    v_mfma_f32_16x16x32_bf16 a[232:235], v[136:139], v[40:43], a[232:235]
    buffer_load_dwordx4 v[72:75], v4, s[44:47], s13 offen sc1
    v_mfma_f32_16x16x32_bf16 a[140:143], v[136:139], v[44:47], a[140:143]
    buffer_load_dwordx4 v[76:79], v5, s[44:47], s13 offen sc1
    v_mfma_f32_16x16x32_bf16 a[164:167], v[140:143], v[32:35], a[164:167]
    buffer_load_dwordx4 v[176:179], v15, s[44:47], s23 offen offset:2048 sc1
    v_mfma_f32_16x16x32_bf16 a[200:203], v[140:143], v[36:39], a[200:203]
    buffer_load_dwordx4 v[180:183], v15, s[44:47], s23 offen offset:3072 sc1
    v_mfma_f32_16x16x32_bf16 a[236:239], v[140:143], v[40:43], a[236:239]
    buffer_load_dwordx4 v[184:187], v16, s[44:47], s23 offen offset:0 sc1
    v_mfma_f32_16x16x32_bf16 a[144:147], v[140:143], v[44:47], a[144:147]
    buffer_load_dwordx4 v[188:191], v15, s[44:47], s84 offen offset:0 sc1
    v_mfma_f32_16x16x32_bf16 a[168:171], v[228:231], v[32:35], a[168:171]
    buffer_load_dwordx4 v[192:195], v15, s[44:47], s84 offen offset:1024 sc1
    v_mfma_f32_16x16x32_bf16 a[204:207], v[228:231], v[36:39], a[204:207]
    v_mfma_f32_16x16x32_bf16 a[128:131], v[228:231], v[40:43], a[128:131]
    v_mfma_f32_16x16x32_bf16 a[148:151], v[228:231], v[44:47], a[148:151]
    v_mfma_f32_16x16x32_bf16 a[172:175], v[232:235], v[32:35], a[172:175]
    v_mfma_f32_16x16x32_bf16 a[224:227], v[232:235], v[36:39], a[224:227]
    v_mfma_f32_16x16x32_bf16 a[132:135], v[232:235], v[40:43], a[132:135]
    v_mfma_f32_16x16x32_bf16 a[152:155], v[232:235], v[44:47], a[152:155]
    v_mfma_f32_16x16x32_bf16 a[192:195], v[236:239], v[32:35], a[192:195]
    v_mfma_f32_16x16x32_bf16 a[228:231], v[236:239], v[36:39], a[228:231]
    v_mfma_f32_16x16x32_bf16 a[136:139], v[236:239], v[40:43], a[136:139]
    v_mfma_f32_16x16x32_bf16 a[156:159], v[236:239], v[44:47], a[156:159]
    s_waitcnt vmcnt(17)
    v_mfma_f32_16x16x32_bf16 a[160:163], v[240:243], v[48:51], a[160:163]
    buffer_load_dword v22, off, s[44:47], s89 offset:8 sc1
    v_mfma_f32_16x16x32_bf16 a[196:199], v[240:243], v[52:55], a[196:199]
    buffer_load_dwordx4 v[32:35], v2, s[44:47], s14 offen sc1
    v_mfma_f32_16x16x32_bf16 a[232:235], v[240:243], v[56:59], a[232:235]
    buffer_load_dwordx4 v[36:39], v3, s[44:47], s14 offen sc1
    v_mfma_f32_16x16x32_bf16 a[140:143], v[240:243], v[60:63], a[140:143]
    buffer_load_dwordx4 v[40:43], v4, s[44:47], s14 offen sc1
    v_mfma_f32_16x16x32_bf16 a[164:167], v[244:247], v[48:51], a[164:167]
    buffer_load_dwordx4 v[44:47], v5, s[44:47], s14 offen sc1
    v_mfma_f32_16x16x32_bf16 a[200:203], v[244:247], v[52:55], a[200:203]
    buffer_load_dwordx4 v[196:199], v15, s[44:47], s84 offen offset:2048 sc1
    v_mfma_f32_16x16x32_bf16 a[236:239], v[244:247], v[56:59], a[236:239]
    buffer_load_dwordx4 v[200:203], v15, s[44:47], s84 offen offset:3072 sc1
    v_mfma_f32_16x16x32_bf16 a[144:147], v[244:247], v[60:63], a[144:147]
    buffer_load_dwordx4 v[204:207], v16, s[44:47], s84 offen offset:0 sc1
    v_mfma_f32_16x16x32_bf16 a[168:171], v[248:251], v[48:51], a[168:171]
    v_mfma_f32_16x16x32_bf16 a[204:207], v[248:251], v[52:55], a[204:207]
    v_mfma_f32_16x16x32_bf16 a[128:131], v[248:251], v[56:59], a[128:131]
    v_mfma_f32_16x16x32_bf16 a[148:151], v[248:251], v[60:63], a[148:151]
    v_mfma_f32_16x16x32_bf16 a[172:175], v[252:255], v[48:51], a[172:175]
    v_mfma_f32_16x16x32_bf16 a[224:227], v[252:255], v[52:55], a[224:227]
    v_mfma_f32_16x16x32_bf16 a[132:135], v[252:255], v[56:59], a[132:135]
    v_mfma_f32_16x16x32_bf16 a[152:155], v[252:255], v[60:63], a[152:155]
    v_mfma_f32_16x16x32_bf16 a[192:195], a[176:179], v[48:51], a[192:195]
    v_mfma_f32_16x16x32_bf16 a[228:231], a[176:179], v[52:55], a[228:231]
    v_mfma_f32_16x16x32_bf16 a[136:139], a[176:179], v[56:59], a[136:139]
    v_mfma_f32_16x16x32_bf16 a[156:159], a[176:179], v[60:63], a[156:159]
    s_waitcnt vmcnt(13)
    v_mfma_f32_16x16x32_bf16 a[160:163], a[208:211], v[64:67], a[160:163]
    buffer_load_dwordx4 v[48:51], v2, s[44:47], s15 offen sc1
    v_mfma_f32_16x16x32_bf16 a[196:199], a[208:211], v[68:71], a[196:199]
    buffer_load_dwordx4 v[52:55], v3, s[44:47], s15 offen sc1
    v_mfma_f32_16x16x32_bf16 a[232:235], a[208:211], v[72:75], a[232:235]
    buffer_load_dwordx4 v[56:59], v4, s[44:47], s15 offen sc1
    v_mfma_f32_16x16x32_bf16 a[140:143], a[208:211], v[76:79], a[140:143]
    buffer_load_dwordx4 v[60:63], v5, s[44:47], s15 offen sc1
    v_mfma_f32_16x16x32_bf16 a[164:167], a[240:243], v[64:67], a[164:167]
    v_mfma_f32_16x16x32_bf16 a[200:203], a[240:243], v[68:71], a[200:203]
    v_mfma_f32_16x16x32_bf16 a[236:239], a[240:243], v[72:75], a[236:239]
    v_mfma_f32_16x16x32_bf16 a[144:147], a[240:243], v[76:79], a[144:147]
    v_mfma_f32_16x16x32_bf16 a[168:171], a[0:3], v[64:67], a[168:171]
    v_mfma_f32_16x16x32_bf16 a[204:207], a[0:3], v[68:71], a[204:207]
    v_mfma_f32_16x16x32_bf16 a[128:131], a[0:3], v[72:75], a[128:131]
    v_mfma_f32_16x16x32_bf16 a[148:151], a[0:3], v[76:79], a[148:151]
    v_mfma_f32_16x16x32_bf16 a[172:175], a[4:7], v[64:67], a[172:175]
    v_mfma_f32_16x16x32_bf16 a[224:227], a[4:7], v[68:71], a[224:227]
    v_mfma_f32_16x16x32_bf16 a[132:135], a[4:7], v[72:75], a[132:135]
    v_mfma_f32_16x16x32_bf16 a[152:155], a[4:7], v[76:79], a[152:155]
    v_mfma_f32_16x16x32_bf16 a[192:195], a[8:11], v[64:67], a[192:195]
    v_mfma_f32_16x16x32_bf16 a[228:231], a[8:11], v[68:71], a[228:231]
    v_mfma_f32_16x16x32_bf16 a[136:139], a[8:11], v[72:75], a[136:139]
    v_mfma_f32_16x16x32_bf16 a[156:159], a[8:11], v[76:79], a[156:159]
    s_waitcnt vmcnt(11)
    v_readfirstlane_b32 s98, v22
    s_cmp_ge_u32 s98, 1048576
    s_cbranch_scc0 SPIN48
RET48:
    s_waitcnt vmcnt(7)
    v_mfma_f32_16x16x32_bf16 a[160:163], a[12:15], v[32:35], a[160:163]
    buffer_load_dwordx4 v[240:243], v2, s[44:47], s16 offen sc1
    v_mfma_f32_16x16x32_bf16 a[196:199], a[12:15], v[36:39], a[196:199]
    buffer_load_dwordx4 v[244:247], v3, s[44:47], s16 offen sc1
    v_mfma_f32_16x16x32_bf16 a[232:235], a[12:15], v[40:43], a[232:235]
    buffer_load_dwordx4 v[248:251], v4, s[44:47], s16 offen sc1
    v_mfma_f32_16x16x32_bf16 a[140:143], a[12:15], v[44:47], a[140:143]
    buffer_load_dwordx4 v[252:255], v5, s[44:47], s16 offen sc1
    v_mfma_f32_16x16x32_bf16 a[164:167], a[16:19], v[32:35], a[164:167]
    buffer_load_dwordx4 a[176:179], v2, s[44:47], s17 offen sc1
    v_mfma_f32_16x16x32_bf16 a[200:203], a[16:19], v[36:39], a[200:203]
    buffer_load_dwordx4 a[208:211], v3, s[44:47], s17 offen sc1
    v_mfma_f32_16x16x32_bf16 a[236:239], a[16:19], v[40:43], a[236:239]
    buffer_load_dwordx4 a[240:243], v4, s[44:47], s17 offen sc1
    v_mfma_f32_16x16x32_bf16 a[144:147], a[16:19], v[44:47], a[144:147]
    buffer_load_dwordx4 a[0:3], v5, s[44:47], s17 offen sc1
    v_mfma_f32_16x16x32_bf16 a[168:171], a[20:23], v[32:35], a[168:171]
    v_mfma_f32_16x16x32_bf16 a[204:207], a[20:23], v[36:39], a[204:207]
    v_mfma_f32_16x16x32_bf16 a[128:131], a[20:23], v[40:43], a[128:131]
    v_mfma_f32_16x16x32_bf16 a[148:151], a[20:23], v[44:47], a[148:151]
    v_mfma_f32_16x16x32_bf16 a[172:175], a[24:27], v[32:35], a[172:175]
    v_mfma_f32_16x16x32_bf16 a[224:227], a[24:27], v[36:39], a[224:227]
    v_mfma_f32_16x16x32_bf16 a[132:135], a[24:27], v[40:43], a[132:135]
    v_mfma_f32_16x16x32_bf16 a[152:155], a[24:27], v[44:47], a[152:155]
    v_mfma_f32_16x16x32_bf16 a[192:195], a[28:31], v[32:35], a[192:195]
    v_mfma_f32_16x16x32_bf16 a[228:231], a[28:31], v[36:39], a[228:231]
    v_mfma_f32_16x16x32_bf16 a[136:139], a[28:31], v[40:43], a[136:139]
    v_mfma_f32_16x16x32_bf16 a[156:159], a[28:31], v[44:47], a[156:159]
    s_waitcnt vmcnt(8)
    v_mfma_f32_16x16x32_bf16 a[160:163], a[32:35], v[48:51], a[160:163]
    buffer_load_dword v22, off, s[44:47], s89 offset:12 sc1
    v_mfma_f32_16x16x32_bf16 a[196:199], a[32:35], v[52:55], a[196:199]
    buffer_load_dwordx4 a[4:7], v2, s[44:47], s18 offen sc1
    v_mfma_f32_16x16x32_bf16 a[232:235], a[32:35], v[56:59], a[232:235]
    buffer_load_dwordx4 a[8:11], v3, s[44:47], s18 offen sc1
    v_mfma_f32_16x16x32_bf16 a[140:143], a[32:35], v[60:63], a[140:143]
    buffer_load_dwordx4 a[12:15], v4, s[44:47], s18 offen sc1
    v_mfma_f32_16x16x32_bf16 a[164:167], a[36:39], v[48:51], a[164:167]
    buffer_load_dwordx4 a[16:19], v5, s[44:47], s18 offen sc1
    v_mfma_f32_16x16x32_bf16 a[200:203], a[36:39], v[52:55], a[200:203]
    v_mfma_f32_16x16x32_bf16 a[236:239], a[36:39], v[56:59], a[236:239]
    v_mfma_f32_16x16x32_bf16 a[144:147], a[36:39], v[60:63], a[144:147]
    v_mfma_f32_16x16x32_bf16 a[168:171], a[40:43], v[48:51], a[168:171]
    v_mfma_f32_16x16x32_bf16 a[204:207], a[40:43], v[52:55], a[204:207]
    v_mfma_f32_16x16x32_bf16 a[128:131], a[40:43], v[56:59], a[128:131]
    v_mfma_f32_16x16x32_bf16 a[148:151], a[40:43], v[60:63], a[148:151]
    v_mfma_f32_16x16x32_bf16 a[172:175], a[44:47], v[48:51], a[172:175]
    v_mfma_f32_16x16x32_bf16 a[224:227], a[44:47], v[52:55], a[224:227]
    v_mfma_f32_16x16x32_bf16 a[132:135], a[44:47], v[56:59], a[132:135]
    v_mfma_f32_16x16x32_bf16 a[152:155], a[44:47], v[60:63], a[152:155]
    v_mfma_f32_16x16x32_bf16 a[192:195], v[80:83], v[48:51], a[192:195]
    v_mfma_f32_16x16x32_bf16 a[228:231], v[80:83], v[52:55], a[228:231]
    v_mfma_f32_16x16x32_bf16 a[136:139], v[80:83], v[56:59], a[136:139]
    v_mfma_f32_16x16x32_bf16 a[156:159], v[80:83], v[60:63], a[156:159]
    s_waitcnt vmcnt(9)
    v_mfma_f32_16x16x32_bf16 a[160:163], v[84:87], v[240:243], a[160:163]
    buffer_load_dwordx4 a[20:23], v2, s[44:47], s19 offen sc1
    v_mfma_f32_16x16x32_bf16 a[196:199], v[84:87], v[244:247], a[196:199]
    buffer_load_dwordx4 a[24:27], v3, s[44:47], s19 offen sc1
    v_mfma_f32_16x16x32_bf16 a[232:235], v[84:87], v[248:251], a[232:235]
    buffer_load_dwordx4 a[28:31], v4, s[44:47], s19 offen sc1
    v_mfma_f32_16x16x32_bf16 a[140:143], v[84:87], v[252:255], a[140:143]
    buffer_load_dwordx4 a[32:35], v5, s[44:47], s19 offen sc1
    v_mfma_f32_16x16x32_bf16 a[164:167], v[88:91], v[240:243], a[164:167]
    v_mfma_f32_16x16x32_bf16 a[200:203], v[88:91], v[244:247], a[200:203]
    v_mfma_f32_16x16x32_bf16 a[236:239], v[88:91], v[248:251], a[236:239]
    v_mfma_f32_16x16x32_bf16 a[144:147], v[88:91], v[252:255], a[144:147]
    v_mfma_f32_16x16x32_bf16 a[168:171], v[92:95], v[240:243], a[168:171]
    v_mfma_f32_16x16x32_bf16 a[204:207], v[92:95], v[244:247], a[204:207]
    v_mfma_f32_16x16x32_bf16 a[128:131], v[92:95], v[248:251], a[128:131]
    v_mfma_f32_16x16x32_bf16 a[148:151], v[92:95], v[252:255], a[148:151]
    v_mfma_f32_16x16x32_bf16 a[172:175], v[96:99], v[240:243], a[172:175]
    v_mfma_f32_16x16x32_bf16 a[224:227], v[96:99], v[244:247], a[224:227]
    v_mfma_f32_16x16x32_bf16 a[132:135], v[96:99], v[248:251], a[132:135]
    v_mfma_f32_16x16x32_bf16 a[152:155], v[96:99], v[252:255], a[152:155]
    v_mfma_f32_16x16x32_bf16 a[192:195], v[100:103], v[240:243], a[192:195]
    v_mfma_f32_16x16x32_bf16 a[228:231], v[100:103], v[244:247], a[228:231]
    v_mfma_f32_16x16x32_bf16 a[136:139], v[100:103], v[248:251], a[136:139]
    v_mfma_f32_16x16x32_bf16 a[156:159], v[100:103], v[252:255], a[156:159]
    s_waitcnt vmcnt(8)
    v_readfirstlane_b32 s98, v22
    s_cmp_ge_u32 s98, 1048576
    s_cbranch_scc0 SPIN49
RET49:
    v_mfma_f32_16x16x32_bf16 a[160:163], v[104:107], a[176:179], a[160:163]
    buffer_load_dwordx4 a[36:39], v2, s[44:47], s20 offen sc1
    v_mfma_f32_16x16x32_bf16 a[196:199], v[104:107], a[208:211], a[196:199]
    buffer_load_dwordx4 a[40:43], v3, s[44:47], s20 offen sc1
    v_mfma_f32_16x16x32_bf16 a[232:235], v[104:107], a[240:243], a[232:235]
    buffer_load_dwordx4 a[44:47], v4, s[44:47], s20 offen sc1
    v_mfma_f32_16x16x32_bf16 a[140:143], v[104:107], a[0:3], a[140:143]
    buffer_load_dwordx4 v[80:83], v5, s[44:47], s20 offen sc1
    v_mfma_f32_16x16x32_bf16 a[164:167], v[108:111], a[176:179], a[164:167]
    buffer_load_dwordx4 v[84:87], v2, s[44:47], s21 offen sc1
    v_mfma_f32_16x16x32_bf16 a[200:203], v[108:111], a[208:211], a[200:203]
    buffer_load_dwordx4 v[88:91], v3, s[44:47], s21 offen sc1
    v_mfma_f32_16x16x32_bf16 a[236:239], v[108:111], a[240:243], a[236:239]
    buffer_load_dwordx4 v[92:95], v4, s[44:47], s21 offen sc1
    v_mfma_f32_16x16x32_bf16 a[144:147], v[108:111], a[0:3], a[144:147]
    buffer_load_dwordx4 v[96:99], v5, s[44:47], s21 offen sc1
    v_mfma_f32_16x16x32_bf16 a[168:171], a[48:51], a[176:179], a[168:171]
    v_mfma_f32_16x16x32_bf16 a[204:207], a[48:51], a[208:211], a[204:207]
    v_mfma_f32_16x16x32_bf16 a[128:131], a[48:51], a[240:243], a[128:131]
    v_mfma_f32_16x16x32_bf16 a[148:151], a[48:51], a[0:3], a[148:151]
    v_mfma_f32_16x16x32_bf16 a[172:175], a[52:55], a[176:179], a[172:175]
    v_mfma_f32_16x16x32_bf16 a[224:227], a[52:55], a[208:211], a[224:227]
    v_mfma_f32_16x16x32_bf16 a[132:135], a[52:55], a[240:243], a[132:135]
    v_mfma_f32_16x16x32_bf16 a[152:155], a[52:55], a[0:3], a[152:155]
    v_mfma_f32_16x16x32_bf16 a[192:195], a[56:59], a[176:179], a[192:195]
    v_mfma_f32_16x16x32_bf16 a[228:231], a[56:59], a[208:211], a[228:231]
    v_mfma_f32_16x16x32_bf16 a[136:139], a[56:59], a[240:243], a[136:139]
    v_mfma_f32_16x16x32_bf16 a[156:159], a[56:59], a[0:3], a[156:159]
    s_waitcnt vmcnt(12)
    v_mfma_f32_16x16x32_bf16 a[160:163], a[60:63], a[4:7], a[160:163]
    buffer_load_dwordx4 v[100:103], v2, s[44:47], s22 offen sc1
    v_mfma_f32_16x16x32_bf16 a[196:199], a[60:63], a[8:11], a[196:199]
    buffer_load_dwordx4 v[104:107], v3, s[44:47], s22 offen sc1
    v_mfma_f32_16x16x32_bf16 a[232:235], a[60:63], a[12:15], a[232:235]
    buffer_load_dwordx4 v[108:111], v4, s[44:47], s22 offen sc1
    v_mfma_f32_16x16x32_bf16 a[140:143], a[60:63], a[16:19], a[140:143]
    buffer_load_dwordx4 a[48:51], v5, s[44:47], s22 offen sc1
    v_mfma_f32_16x16x32_bf16 a[164:167], a[64:67], a[4:7], a[164:167]
    v_mfma_f32_16x16x32_bf16 a[200:203], a[64:67], a[8:11], a[200:203]
    v_mfma_f32_16x16x32_bf16 a[236:239], a[64:67], a[12:15], a[236:239]
    v_mfma_f32_16x16x32_bf16 a[144:147], a[64:67], a[16:19], a[144:147]
    v_mfma_f32_16x16x32_bf16 a[168:171], a[68:71], a[4:7], a[168:171]
    v_mfma_f32_16x16x32_bf16 a[204:207], a[68:71], a[8:11], a[204:207]
    v_mfma_f32_16x16x32_bf16 a[128:131], a[68:71], a[12:15], a[128:131]
    v_mfma_f32_16x16x32_bf16 a[148:151], a[68:71], a[16:19], a[148:151]
    v_mfma_f32_16x16x32_bf16 a[172:175], a[72:75], a[4:7], a[172:175]
    v_mfma_f32_16x16x32_bf16 a[224:227], a[72:75], a[8:11], a[224:227]
    v_mfma_f32_16x16x32_bf16 a[132:135], a[72:75], a[12:15], a[132:135]
    v_mfma_f32_16x16x32_bf16 a[152:155], a[72:75], a[16:19], a[152:155]
    v_mfma_f32_16x16x32_bf16 a[192:195], a[76:79], a[4:7], a[192:195]
    v_mfma_f32_16x16x32_bf16 a[228:231], a[76:79], a[8:11], a[228:231]
    v_mfma_f32_16x16x32_bf16 a[136:139], a[76:79], a[12:15], a[136:139]
    v_mfma_f32_16x16x32_bf16 a[156:159], a[76:79], a[16:19], a[156:159]
    s_waitcnt vmcnt(12)
    v_mfma_f32_16x16x32_bf16 a[160:163], a[80:83], a[20:23], a[160:163]
    buffer_load_dwordx4 a[52:55], v2, s[44:47], s23 offen sc1
    v_mfma_f32_16x16x32_bf16 a[196:199], a[80:83], a[24:27], a[196:199]
    buffer_load_dwordx4 a[56:59], v3, s[44:47], s23 offen sc1
    v_mfma_f32_16x16x32_bf16 a[232:235], a[80:83], a[28:31], a[232:235]
    buffer_load_dwordx4 a[60:63], v4, s[44:47], s23 offen sc1
    v_mfma_f32_16x16x32_bf16 a[140:143], a[80:83], a[32:35], a[140:143]
    buffer_load_dwordx4 a[64:67], v5, s[44:47], s23 offen sc1
    v_mfma_f32_16x16x32_bf16 a[164:167], a[84:87], a[20:23], a[164:167]
    v_mfma_f32_16x16x32_bf16 a[200:203], a[84:87], a[24:27], a[200:203]
    v_mfma_f32_16x16x32_bf16 a[236:239], a[84:87], a[28:31], a[236:239]
    v_mfma_f32_16x16x32_bf16 a[144:147], a[84:87], a[32:35], a[144:147]
    v_mfma_f32_16x16x32_bf16 a[168:171], a[88:91], a[20:23], a[168:171]
    v_mfma_f32_16x16x32_bf16 a[204:207], a[88:91], a[24:27], a[204:207]
    v_mfma_f32_16x16x32_bf16 a[128:131], a[88:91], a[28:31], a[128:131]
    v_mfma_f32_16x16x32_bf16 a[148:151], a[88:91], a[32:35], a[148:151]
    v_mfma_f32_16x16x32_bf16 a[172:175], a[92:95], a[20:23], a[172:175]
    v_mfma_f32_16x16x32_bf16 a[224:227], a[92:95], a[24:27], a[224:227]
    v_mfma_f32_16x16x32_bf16 a[132:135], a[92:95], a[28:31], a[132:135]
    v_mfma_f32_16x16x32_bf16 a[152:155], a[92:95], a[32:35], a[152:155]
    v_mfma_f32_16x16x32_bf16 a[192:195], a[96:99], a[20:23], a[192:195]
    v_mfma_f32_16x16x32_bf16 a[228:231], a[96:99], a[24:27], a[228:231]
    v_mfma_f32_16x16x32_bf16 a[136:139], a[96:99], a[28:31], a[136:139]
    v_mfma_f32_16x16x32_bf16 a[156:159], a[96:99], a[32:35], a[156:159]
    s_mov_b32 s5, 0xffff0000
    s_waitcnt vmcnt(12)
    v_mfma_f32_16x16x32_bf16 a[160:163], a[100:103], a[36:39], a[160:163]
    buffer_load_dwordx4 a[68:71], v2, s[44:47], s84 offen sc1
    v_mfma_f32_16x16x32_bf16 a[196:199], a[100:103], a[40:43], a[196:199]
    buffer_load_dwordx4 a[72:75], v3, s[44:47], s84 offen sc1
    v_mfma_f32_16x16x32_bf16 a[232:235], a[100:103], a[44:47], a[232:235]
    buffer_load_dwordx4 a[76:79], v4, s[44:47], s84 offen sc1
    v_mfma_f32_16x16x32_bf16 a[140:143], a[100:103], v[80:83], a[140:143]
    buffer_load_dwordx4 a[80:83], v5, s[44:47], s84 offen sc1
    v_mfma_f32_16x16x32_bf16 a[164:167], a[104:107], a[36:39], a[164:167]
    v_lshlrev_b32 v48, 16, v144
    v_and_b32 v49, s5, v144
    v_mfma_f32_16x16x32_bf16 a[200:203], a[104:107], a[40:43], a[200:203]
    v_lshlrev_b32 v50, 16, v145
    v_and_b32 v51, s5, v145
    v_mfma_f32_16x16x32_bf16 a[236:239], a[104:107], a[44:47], a[236:239]
    v_lshlrev_b32 v52, 16, v146
    v_and_b32 v53, s5, v146
    v_mfma_f32_16x16x32_bf16 a[144:147], a[104:107], v[80:83], a[144:147]
    v_lshlrev_b32 v54, 16, v147
    v_and_b32 v55, s5, v147
    v_mfma_f32_16x16x32_bf16 a[168:171], a[108:111], a[36:39], a[168:171]
    v_lshlrev_b32 v56, 16, v148
    v_and_b32 v57, s5, v148
    v_mfma_f32_16x16x32_bf16 a[204:207], a[108:111], a[40:43], a[204:207]
    v_lshlrev_b32 v58, 16, v149
    v_and_b32 v59, s5, v149
    v_mfma_f32_16x16x32_bf16 a[128:131], a[108:111], a[44:47], a[128:131]
    v_lshlrev_b32 v60, 16, v150
    v_and_b32 v61, s5, v150
    v_mfma_f32_16x16x32_bf16 a[148:151], a[108:111], v[80:83], a[148:151]
    v_lshlrev_b32 v62, 16, v151
    v_and_b32 v63, s5, v151
    v_mfma_f32_16x16x32_bf16 a[172:175], a[112:115], a[36:39], a[172:175]
    v_lshlrev_b32 v64, 16, v152
    v_and_b32 v65, s5, v152
    v_mfma_f32_16x16x32_bf16 a[224:227], a[112:115], a[40:43], a[224:227]
    v_lshlrev_b32 v66, 16, v153
    v_and_b32 v67, s5, v153
    v_mfma_f32_16x16x32_bf16 a[132:135], a[112:115], a[44:47], a[132:135]
    v_lshlrev_b32 v68, 16, v154
    v_and_b32 v69, s5, v154
    v_mfma_f32_16x16x32_bf16 a[152:155], a[112:115], v[80:83], a[152:155]
    v_lshlrev_b32 v70, 16, v155
    v_and_b32 v71, s5, v155
    v_mfma_f32_16x16x32_bf16 a[192:195], a[116:119], a[36:39], a[192:195]
    v_mfma_f32_16x16x32_bf16 a[228:231], a[116:119], a[40:43], a[228:231]
    v_mfma_f32_16x16x32_bf16 a[136:139], a[116:119], a[44:47], a[136:139]
    v_mfma_f32_16x16x32_bf16 a[156:159], a[116:119], v[80:83], a[156:159]
    s_waitcnt vmcnt(12)
    v_mfma_f32_16x16x32_bf16 a[160:163], a[120:123], v[84:87], a[160:163]
    v_mfma_f32_16x16x32_bf16 a[196:199], a[120:123], v[88:91], a[196:199]
    v_mfma_f32_16x16x32_bf16 a[232:235], a[120:123], v[92:95], a[232:235]
    v_mfma_f32_16x16x32_bf16 a[140:143], a[120:123], v[96:99], a[140:143]
    v_mfma_f32_16x16x32_bf16 a[164:167], a[124:127], v[84:87], a[164:167]
    v_mfma_f32_16x16x32_bf16 a[200:203], a[124:127], v[88:91], a[200:203]
    v_mfma_f32_16x16x32_bf16 a[236:239], a[124:127], v[92:95], a[236:239]
    v_mfma_f32_16x16x32_bf16 a[144:147], a[124:127], v[96:99], a[144:147]
    v_mfma_f32_16x16x32_bf16 a[168:171], v[208:211], v[84:87], a[168:171]
    v_mfma_f32_16x16x32_bf16 a[204:207], v[208:211], v[88:91], a[204:207]
    v_mfma_f32_16x16x32_bf16 a[128:131], v[208:211], v[92:95], a[128:131]
    v_mfma_f32_16x16x32_bf16 a[148:151], v[208:211], v[96:99], a[148:151]
    v_mfma_f32_16x16x32_bf16 a[172:175], v[212:215], v[84:87], a[172:175]
    v_mfma_f32_16x16x32_bf16 a[224:227], v[212:215], v[88:91], a[224:227]
    v_mfma_f32_16x16x32_bf16 a[132:135], v[212:215], v[92:95], a[132:135]
    v_mfma_f32_16x16x32_bf16 a[152:155], v[212:215], v[96:99], a[152:155]
    v_mfma_f32_16x16x32_bf16 a[192:195], v[216:219], v[84:87], a[192:195]
    v_mfma_f32_16x16x32_bf16 a[228:231], v[216:219], v[88:91], a[228:231]
    v_mfma_f32_16x16x32_bf16 a[136:139], v[216:219], v[92:95], a[136:139]
    v_mfma_f32_16x16x32_bf16 a[156:159], v[216:219], v[96:99], a[156:159]
    s_waitcnt vmcnt(8)
    s_waitcnt vmcnt(4)
    s_waitcnt vmcnt(0)
    v_mfma_f32_16x16x32_bf16 a[196:199], v[220:223], v[104:107], a[196:199]
    v_mfma_f32_16x16x32_bf16 a[196:199], v[168:171], a[56:59], a[196:199]
    v_mfma_f32_16x16x32_bf16 a[196:199], v[188:191], a[72:75], a[196:199]
    v_mfma_f32_16x16x32_bf16 a[200:203], v[224:227], v[104:107], a[200:203]
    v_mfma_f32_16x16x32_bf16 a[200:203], v[172:175], a[56:59], a[200:203]
    v_mfma_f32_16x16x32_bf16 a[200:203], v[192:195], a[72:75], a[200:203]
    v_mfma_f32_16x16x32_bf16 a[204:207], v[156:159], v[104:107], a[204:207]
    v_mfma_f32_16x16x32_bf16 a[204:207], v[176:179], a[56:59], a[204:207]
    v_mfma_f32_16x16x32_bf16 a[204:207], v[196:199], a[72:75], a[204:207]
    v_mfma_f32_16x16x32_bf16 a[224:227], v[160:163], v[104:107], a[224:227]
    v_mfma_f32_16x16x32_bf16 a[224:227], v[180:183], a[56:59], a[224:227]
    ds_write_b128 v10, a[196:199] offset:0
    v_mfma_f32_16x16x32_bf16 a[224:227], v[200:203], a[72:75], a[224:227]
    v_mfma_f32_16x16x32_bf16 a[228:231], v[164:167], v[104:107], a[228:231]
    v_mfma_f32_16x16x32_bf16 a[228:231], v[184:187], a[56:59], a[228:231]
    ds_write_b128 v10, a[200:203] offset:32
    v_mfma_f32_16x16x32_bf16 a[228:231], v[204:207], a[72:75], a[228:231]
    v_mfma_f32_16x16x32_bf16 a[232:235], v[220:223], v[108:111], a[232:235]
    v_mfma_f32_16x16x32_bf16 a[232:235], v[168:171], a[60:63], a[232:235]
    ds_write_b128 v10, a[204:207] offset:64
    v_mfma_f32_16x16x32_bf16 a[232:235], v[188:191], a[76:79], a[232:235]
    v_mfma_f32_16x16x32_bf16 a[236:239], v[224:227], v[108:111], a[236:239]
    v_mfma_f32_16x16x32_bf16 a[236:239], v[172:175], a[60:63], a[236:239]
    ds_write_b128 v10, a[224:227] offset:96
    v_mfma_f32_16x16x32_bf16 a[236:239], v[192:195], a[76:79], a[236:239]
    v_mfma_f32_16x16x32_bf16 a[128:131], v[156:159], v[108:111], a[128:131]
    v_mfma_f32_16x16x32_bf16 a[128:131], v[176:179], a[60:63], a[128:131]
    ds_write_b128 v10, a[228:231] offset:128
    v_mfma_f32_16x16x32_bf16 a[128:131], v[196:199], a[76:79], a[128:131]
    v_mfma_f32_16x16x32_bf16 a[132:135], v[160:163], v[108:111], a[132:135]
    v_mfma_f32_16x16x32_bf16 a[132:135], v[180:183], a[60:63], a[132:135]
    ds_write_b128 v12, a[232:235] offset:0
    v_mfma_f32_16x16x32_bf16 a[132:135], v[200:203], a[76:79], a[132:135]
    v_mfma_f32_16x16x32_bf16 a[136:139], v[164:167], v[108:111], a[136:139]
    v_mfma_f32_16x16x32_bf16 a[136:139], v[184:187], a[60:63], a[136:139]
    ds_write_b128 v12, a[236:239] offset:32
    v_mfma_f32_16x16x32_bf16 a[136:139], v[204:207], a[76:79], a[136:139]
    v_mfma_f32_16x16x32_bf16 a[140:143], v[220:223], a[48:51], a[140:143]
    v_mfma_f32_16x16x32_bf16 a[140:143], v[168:171], a[64:67], a[140:143]
    ds_write_b128 v12, a[128:131] offset:64
    v_mfma_f32_16x16x32_bf16 a[140:143], v[188:191], a[80:83], a[140:143]
    v_mfma_f32_16x16x32_bf16 a[144:147], v[224:227], a[48:51], a[144:147]
    v_mfma_f32_16x16x32_bf16 a[144:147], v[172:175], a[64:67], a[144:147]
    ds_write_b128 v12, a[132:135] offset:96
    v_mfma_f32_16x16x32_bf16 a[144:147], v[192:195], a[80:83], a[144:147]
    v_mfma_f32_16x16x32_bf16 a[148:151], v[156:159], a[48:51], a[148:151]
    v_mfma_f32_16x16x32_bf16 a[148:151], v[176:179], a[64:67], a[148:151]
    ds_write_b128 v12, a[136:139] offset:128
    v_mfma_f32_16x16x32_bf16 a[148:151], v[196:199], a[80:83], a[148:151]
    v_mfma_f32_16x16x32_bf16 a[152:155], v[160:163], a[48:51], a[152:155]
    v_mfma_f32_16x16x32_bf16 a[152:155], v[180:183], a[64:67], a[152:155]
    ds_write_b128 v13, a[140:143] offset:0
    v_mfma_f32_16x16x32_bf16 a[152:155], v[200:203], a[80:83], a[152:155]
    v_mfma_f32_16x16x32_bf16 a[156:159], v[164:167], a[48:51], a[156:159]
    v_mfma_f32_16x16x32_bf16 a[156:159], v[184:187], a[64:67], a[156:159]
    ds_write_b128 v13, a[144:147] offset:32
    v_mfma_f32_16x16x32_bf16 a[156:159], v[204:207], a[80:83], a[156:159]
    v_mfma_f32_16x16x32_bf16 a[160:163], v[220:223], v[100:103], a[160:163]
    v_mfma_f32_16x16x32_bf16 a[160:163], v[168:171], a[52:55], a[160:163]
    ds_write_b128 v13, a[148:151] offset:64
    v_mfma_f32_16x16x32_bf16 a[160:163], v[188:191], a[68:71], a[160:163]
    v_mfma_f32_16x16x32_bf16 a[164:167], v[224:227], v[100:103], a[164:167]
    v_mfma_f32_16x16x32_bf16 a[164:167], v[172:175], a[52:55], a[164:167]
    ds_write_b128 v13, a[152:155] offset:96
    v_mfma_f32_16x16x32_bf16 a[164:167], v[192:195], a[68:71], a[164:167]
    v_mfma_f32_16x16x32_bf16 a[168:171], v[156:159], v[100:103], a[168:171]
    v_mfma_f32_16x16x32_bf16 a[168:171], v[176:179], a[52:55], a[168:171]
    ds_write_b128 v13, a[156:159] offset:128
    v_mfma_f32_16x16x32_bf16 a[168:171], v[196:199], a[68:71], a[168:171]
    v_mfma_f32_16x16x32_bf16 a[172:175], v[160:163], v[100:103], a[172:175]
    v_mfma_f32_16x16x32_bf16 a[172:175], v[180:183], a[52:55], a[172:175]
    ds_write_b128 v9, a[160:163] offset:0
    v_mfma_f32_16x16x32_bf16 a[172:175], v[200:203], a[68:71], a[172:175]
    v_mfma_f32_16x16x32_bf16 a[192:195], v[164:167], v[100:103], a[192:195]
    v_mfma_f32_16x16x32_bf16 a[192:195], v[184:187], a[52:55], a[192:195]
    ds_write_b128 v9, a[164:167] offset:32
    v_mfma_f32_16x16x32_bf16 a[192:195], v[204:207], a[68:71], a[192:195]
    s_nop 3
    ds_write_b128 v9, a[168:171] offset:64
    ds_write_b128 v9, a[172:175] offset:96
    s_nop 2
    ds_write_b128 v9, a[192:195] offset:128
    s_waitcnt lgkmcnt(0)
    s_barrier
    ds_read_b128 v[80:83], v20 offset:0
    ds_read_b128 v[84:87], v20 offset:2576
    ds_read_b128 v[88:91], v20 offset:5152
    ds_read_b128 v[92:95], v20 offset:7728
    ds_read_b128 v[96:99], v20 offset:10304
    ds_read_b128 v[100:103], v20 offset:12880
    ds_read_b128 v[104:107], v20 offset:15456
    ds_read_b128 v[108:111], v20 offset:18032
    ds_read_b128 v[112:115], v21 offset:0
    ds_read_b128 v[116:119], v21 offset:2576
    ds_read_b128 v[120:123], v21 offset:5152
    ds_read_b128 v[124:127], v21 offset:7728
    ds_read_b128 v[128:131], v21 offset:10304
    ds_read_b128 v[132:135], v21 offset:12880
    ds_read_b128 v[136:139], v21 offset:15456
    ds_read_b128 v[140:143], v21 offset:18032
    s_waitcnt lgkmcnt(8)
    ds_read_b128 v[208:211], v24 offset:0
    ds_read_b128 v[212:215], v24 offset:2576
    ds_read_b128 v[216:219], v24 offset:5152
    ds_read_b128 v[220:223], v24 offset:7728
    ds_read_b128 v[224:227], v24 offset:10304
    ds_read_b128 v[228:231], v24 offset:12880
    ds_read_b128 v[232:235], v24 offset:15456
    ds_read_b128 v[236:239], v24 offset:18032
    v_pk_add_f32 v[48:49], v[48:49], v[80:81]
    v_pk_add_f32 v[50:51], v[50:51], v[82:83]
    v_pk_add_f32 v[52:53], v[52:53], v[84:85]
    v_pk_add_f32 v[54:55], v[54:55], v[86:87]
    v_pk_add_f32 v[48:49], v[48:49], v[88:89]
    v_pk_add_f32 v[50:51], v[50:51], v[90:91]
    v_pk_add_f32 v[52:53], v[52:53], v[92:93]
    v_pk_add_f32 v[54:55], v[54:55], v[94:95]
    v_pk_add_f32 v[48:49], v[48:49], v[96:97]
    v_pk_add_f32 v[50:51], v[50:51], v[98:99]
    v_pk_add_f32 v[52:53], v[52:53], v[100:101]
    v_pk_add_f32 v[54:55], v[54:55], v[102:103]
    v_pk_add_f32 v[48:49], v[48:49], v[104:105]
    v_pk_add_f32 v[50:51], v[50:51], v[106:107]
    v_pk_add_f32 v[52:53], v[52:53], v[108:109]
    v_pk_add_f32 v[54:55], v[54:55], v[110:111]
    v_cvt_pk_bf16_f32 v144, v48, v49
    v_cvt_pk_bf16_f32 v145, v50, v51
    v_cvt_pk_bf16_f32 v146, v52, v53
    v_cvt_pk_bf16_f32 v147, v54, v55
    buffer_store_dwordx4 v[144:147], v17, s[56:59], s94 offen
    s_waitcnt lgkmcnt(8)
    v_pk_add_f32 v[56:57], v[56:57], v[112:113]
    v_pk_add_f32 v[58:59], v[58:59], v[114:115]
    v_pk_add_f32 v[60:61], v[60:61], v[116:117]
    v_pk_add_f32 v[62:63], v[62:63], v[118:119]
    v_pk_add_f32 v[56:57], v[56:57], v[120:121]
    v_pk_add_f32 v[58:59], v[58:59], v[122:123]
    v_pk_add_f32 v[60:61], v[60:61], v[124:125]
    v_pk_add_f32 v[62:63], v[62:63], v[126:127]
    v_pk_add_f32 v[56:57], v[56:57], v[128:129]
    v_pk_add_f32 v[58:59], v[58:59], v[130:131]
    v_pk_add_f32 v[60:61], v[60:61], v[132:133]
    v_pk_add_f32 v[62:63], v[62:63], v[134:135]
    v_pk_add_f32 v[56:57], v[56:57], v[136:137]
    v_pk_add_f32 v[58:59], v[58:59], v[138:139]
    v_pk_add_f32 v[60:61], v[60:61], v[140:141]
    v_pk_add_f32 v[62:63], v[62:63], v[142:143]
    v_cvt_pk_bf16_f32 v148, v56, v57
    v_cvt_pk_bf16_f32 v149, v58, v59
    v_cvt_pk_bf16_f32 v150, v60, v61
    v_cvt_pk_bf16_f32 v151, v62, v63
    buffer_store_dwordx4 v[148:151], v18, s[56:59], s94 offen
    s_waitcnt lgkmcnt(0)
    v_pk_add_f32 v[64:65], v[64:65], v[208:209]
    v_pk_add_f32 v[66:67], v[66:67], v[210:211]
    v_pk_add_f32 v[68:69], v[68:69], v[212:213]
    v_pk_add_f32 v[70:71], v[70:71], v[214:215]
    v_pk_add_f32 v[64:65], v[64:65], v[216:217]
    v_pk_add_f32 v[66:67], v[66:67], v[218:219]
    v_pk_add_f32 v[68:69], v[68:69], v[220:221]
    v_pk_add_f32 v[70:71], v[70:71], v[222:223]
    v_pk_add_f32 v[64:65], v[64:65], v[224:225]
    v_pk_add_f32 v[66:67], v[66:67], v[226:227]
    v_pk_add_f32 v[68:69], v[68:69], v[228:229]
    v_pk_add_f32 v[70:71], v[70:71], v[230:231]
    v_pk_add_f32 v[64:65], v[64:65], v[232:233]
    v_pk_add_f32 v[66:67], v[66:67], v[234:235]
    v_pk_add_f32 v[68:69], v[68:69], v[236:237]
    v_pk_add_f32 v[70:71], v[70:71], v[238:239]
    v_cvt_pk_bf16_f32 v152, v64, v65
    v_cvt_pk_bf16_f32 v153, v66, v67
    v_cvt_pk_bf16_f32 v154, v68, v69
    v_cvt_pk_bf16_f32 v155, v70, v71
    buffer_store_dwordx4 v[152:155], v19, s[56:59], s94 offen
    s_endpgm
DONE:
    s_endpgm
SPIN21:
    s_mov_b32 s99, 0
SPL21:
    s_sleep 16
    buffer_load_dword v196, off, s[24:27], 0 offset:0 sc1
    s_waitcnt vmcnt(0)
    v_readfirstlane_b32 s98, v196
    s_cmp_ge_u32 s98, 4194304
    s_cbranch_scc1 RET21
    s_add_u32 s99, s99, 1
    s_cmp_lt_u32 s99, 200000
    s_cbranch_scc1 SPL21
    s_branch RET21
SPIN22:
    s_mov_b32 s99, 0
SPL22:
    s_sleep 2
    buffer_load_dword v31, off, s[44:47], s97 offset:0 sc1
    s_waitcnt vmcnt(0)
    v_readfirstlane_b32 s98, v31
    s_cmp_ge_u32 s98, 4456448
    s_cbranch_scc1 RET22
    s_add_u32 s99, s99, 1
    s_cmp_lt_u32 s99, 200000
    s_cbranch_scc1 SPL22
    s_branch RET22
SPIN23:
    s_mov_b32 s99, 0
SPL23:
    s_sleep 2
    buffer_load_dword v196, off, s[44:47], s91 offset:4 sc1
    s_waitcnt vmcnt(0)
    v_readfirstlane_b32 s98, v196
    s_cmp_ge_u32 s98, 2621440
    s_cbranch_scc1 RET23
    s_add_u32 s99, s99, 1
    s_cmp_lt_u32 s99, 200000
    s_cbranch_scc1 SPL23
    s_branch RET23
SPIN24:
    s_mov_b32 s99, 0
SPL24:
    s_sleep 2
    buffer_load_dword v8, off, s[44:47], s91 offset:0 sc1
    s_waitcnt vmcnt(0)
    v_readfirstlane_b32 s98, v8
    s_cmp_ge_u32 s98, 2097152
    s_cbranch_scc1 RET24
    s_add_u32 s99, s99, 1
    s_cmp_lt_u32 s99, 200000
    s_cbranch_scc1 SPL24
    s_branch RET24
SPIN25:
    s_mov_b32 s99, 0
SPL25:
    s_sleep 2
    buffer_load_dword v6, off, s[44:47], s89 offset:4 sc1
    s_waitcnt vmcnt(0)
    v_readfirstlane_b32 s98, v6
    s_cmp_ge_u32 s98, 1048576
    s_cbranch_scc1 RET25
    s_add_u32 s99, s99, 1
    s_cmp_lt_u32 s99, 200000
    s_cbranch_scc1 SPL25
    s_branch RET25
SPIN26:
    s_mov_b32 s99, 0
SPL26:
    s_sleep 2
    buffer_load_dword v22, off, s[44:47], s89 offset:8 sc1
    s_waitcnt vmcnt(0)
    v_readfirstlane_b32 s98, v22
    s_cmp_ge_u32 s98, 1048576
    s_cbranch_scc1 RET26
    s_add_u32 s99, s99, 1
    s_cmp_lt_u32 s99, 200000
    s_cbranch_scc1 SPL26
    s_branch RET26
SPIN27:
    s_mov_b32 s99, 0
SPL27:
    s_sleep 2
    buffer_load_dword v22, off, s[44:47], s89 offset:12 sc1
    s_waitcnt vmcnt(0)
    v_readfirstlane_b32 s98, v22
    s_cmp_ge_u32 s98, 1048576
    s_cbranch_scc1 RET27
    s_add_u32 s99, s99, 1
    s_cmp_lt_u32 s99, 200000
    s_cbranch_scc1 SPL27
    s_branch RET27
SPIN44:
    s_mov_b32 s99, 0
SPL44:
    s_sleep 16
    buffer_load_dword v196, off, s[24:27], 0 offset:0 sc1
    s_waitcnt vmcnt(0)
    v_readfirstlane_b32 s98, v196
    s_cmp_ge_u32 s98, 4194304
    s_cbranch_scc1 RET44
    s_add_u32 s99, s99, 1
    s_cmp_lt_u32 s99, 200000
    s_cbranch_scc1 SPL44
    s_branch RET44
SPIN45:
    s_mov_b32 s99, 0
SPL45:
    s_sleep 2
    buffer_load_dword v196, off, s[44:47], s91 offset:4 sc1
    s_waitcnt vmcnt(0)
    v_readfirstlane_b32 s98, v196
    s_cmp_ge_u32 s98, 2621440
    s_cbranch_scc1 RET45
    s_add_u32 s99, s99, 1
    s_cmp_lt_u32 s99, 200000
    s_cbranch_scc1 SPL45
    s_branch RET45
SPIN46:
    s_mov_b32 s99, 0
SPL46:
    s_sleep 2
    buffer_load_dword v31, off, s[44:47], s97 offset:0 sc1
    s_waitcnt vmcnt(0)
    v_readfirstlane_b32 s98, v31
    s_cmp_ge_u32 s98, 4456448
    s_cbranch_scc1 RET46
    s_add_u32 s99, s99, 1
    s_cmp_lt_u32 s99, 200000
    s_cbranch_scc1 SPL46
    s_branch RET46
SPIN47:
    s_mov_b32 s99, 0
SPL47:
    s_sleep 2
    buffer_load_dword v6, off, s[44:47], s89 offset:4 sc1
    s_waitcnt vmcnt(0)
    v_readfirstlane_b32 s98, v6
    s_cmp_ge_u32 s98, 1048576
    s_cbranch_scc1 RET47
    s_add_u32 s99, s99, 1
    s_cmp_lt_u32 s99, 200000
    s_cbranch_scc1 SPL47
    s_branch RET47
SPIN48:
    s_mov_b32 s99, 0
SPL48:
    s_sleep 2
    buffer_load_dword v22, off, s[44:47], s89 offset:8 sc1
    s_waitcnt vmcnt(0)
    v_readfirstlane_b32 s98, v22
    s_cmp_ge_u32 s98, 1048576
    s_cbranch_scc1 RET48
    s_add_u32 s99, s99, 1
    s_cmp_lt_u32 s99, 200000
    s_cbranch_scc1 SPL48
    s_branch RET48
SPIN49:
    s_mov_b32 s99, 0
SPL49:
    s_sleep 2
    buffer_load_dword v22, off, s[44:47], s89 offset:12 sc1
    s_waitcnt vmcnt(0)
    v_readfirstlane_b32 s98, v22
    s_cmp_ge_u32 s98, 1048576
    s_cbranch_scc1 RET49
    s_add_u32 s99, s99, 1
    s_cmp_lt_u32 s99, 200000
    s_cbranch_scc1 SPL49
    s_branch RET49
CODE_END:
.section .rodata,"a"
.p2align 6
.amdhsa_kernel parallel_sum__linear_attn_block__glu_gated_bilinear__prompt_kernel
  .amdhsa_next_free_vgpr 512
  .amdhsa_next_free_sgpr 102
  .amdhsa_accum_offset 256
  .amdhsa_group_segment_fixed_size 0
  .amdhsa_kernarg_size 80
  .amdhsa_user_sgpr_count 2
  .amdhsa_user_sgpr_kernarg_segment_ptr 1
  .amdhsa_system_sgpr_workgroup_id_x 1
.end_amdhsa_kernel
```
